```python
import torch

def _softmax(x, axis=-1):
    return torch.softmax(x, dim=axis)
def _gelu(x):
    return torch.nn.functional.gelu(x, approximate="tanh")
def _silu(x):
    return torch.nn.functional.silu(x)
def _sigmoid(x):
    return torch.sigmoid(x)
def _layernorm(x, axis=-1, eps=1e-5):
    m = x.mean(dim=axis, keepdim=True)
    v = x.var(dim=axis, keepdim=True, unbiased=False)
    return (x - m) / torch.sqrt(v + eps)
def _scatter_add(tgt, idx, src, axis=0):
    return tgt.clone().index_add_(axis, idx, src)
def _segment_sum(src, seg, n):
    out = torch.zeros((n,) + src.shape[1:], dtype=src.dtype)
    return out.index_add_(0, seg, src)
def _pad(x, pw):
    flat = tuple(v for pair in reversed(pw) for v in pair)
    return torch.nn.functional.pad(x, flat)

kernel_name = 'gated_mix__ssm_conv_s5__linear_attn_block__prompt'

def setup_inputs():

    _w = (lambda a: (lambda t: t.to(torch.bfloat16) if t.is_floating_point() else t)(torch.as_tensor(a)))
    def _A_setup():
        B, S, D = 1, 2048, 1024
        P = D
        Lambda_re = -0.5 * (lambda _x: torch.exp(torch.as_tensor(_x)))((lambda *s: torch.randn(*s, dtype=torch.bfloat16) * 0.4)(P))
        Lambda_im = (lambda *s: torch.randn(*s, dtype=torch.bfloat16) * 0.8)(P) * 1.0
        B_re = (lambda *s: torch.randn(*s, dtype=torch.bfloat16) * 0.4)(P, D) * (D ** -0.5)
        B_im = (lambda *s: torch.randn(*s, dtype=torch.bfloat16) * 0.4)(P, D) * (D ** -0.5)
        C_re = (lambda *s: torch.randn(*s, dtype=torch.bfloat16) * 0.4)(D, P) * (P ** -0.5)
        C_im = (lambda *s: torch.randn(*s, dtype=torch.bfloat16) * 0.4)(D, P) * (P ** -0.5)
        log_dt = (lambda *s: torch.randn(*s, dtype=torch.bfloat16) * 0.4)(P) * 0.3 - 2.0
        Dskip = (lambda *s: torch.randn(*s, dtype=torch.bfloat16) * 0.05)(D)
        return {
            "x": _w((lambda *s: torch.randn(*s, dtype=torch.bfloat16) * 0.05)(B, S, D)),
            "Lambda_re": _w(Lambda_re),
            "Lambda_im": _w(Lambda_im),
            "B_re": _w(B_re),
            "B_im": _w(B_im),
            "C_re": _w(C_re),
            "C_im": _w(C_im),
            "log_dt": _w(log_dt),
            "Dskip": _w(Dskip),
        }
    _A_in = _A_setup()

    def _B_setup():
        B, S, D = 1, 2048, 1024
        return {
            "x": _w((lambda *s: torch.randn(*s, dtype=torch.bfloat16) * 0.05)(B, S, D)),
            "wqkv": _w((lambda *s: torch.randn(*s, dtype=torch.bfloat16) * 0.8)(D, 3 * D)),
            "wo": _w((lambda *s: torch.randn(*s, dtype=torch.bfloat16) * 0.05)(D, D)),
        }
    _B_in = _B_setup()

    return {
        "A_x": _A_in["x"],
        "A_Lambda_re": _A_in["Lambda_re"],
        "A_Lambda_im": _A_in["Lambda_im"],
        "A_B_re": _A_in["B_re"],
        "A_B_im": _A_in["B_im"],
        "A_C_re": _A_in["C_re"],
        "A_C_im": _A_in["C_im"],
        "A_log_dt": _A_in["log_dt"],
        "A_Dskip": _A_in["Dskip"],
        "B_x": _B_in["x"],
        "B_wqkv": _B_in["wqkv"],
        "B_wo": _B_in["wo"],
        "gate_w": _w((lambda *s: torch.randn(*s, dtype=torch.bfloat16) * 0.05)(1024) * 16.0),
    }

def reference(A_x, A_Lambda_re, A_Lambda_im, A_B_re, A_B_im, A_C_re, A_C_im, A_log_dt, A_Dskip, B_x, B_wqkv, B_wo, gate_w):
    def _A_ref(x, Lambda_re, Lambda_im, B_re, B_im, C_re, C_im, log_dt, Dskip):
        Bsz, L, H = x.shape
        Lam = Lambda_re + 1j * Lambda_im
        Bmat = B_re + 1j * B_im
        Cmat = C_re + 1j * C_im
        dt = torch.exp(log_dt)
        Lam_bar = torch.exp(dt * Lam)
        B_bar = ((Lam_bar - 1.0) / Lam)[:, None] * Bmat
        Bu = torch.einsum("bld,pd->blp", x + 0j, B_bar)
        h = torch.zeros_like(Bu[:, 0, :])
        hs = []
        for t in range(L):
            h = Lam_bar[None, :] * h + Bu[:, t, :]
            hs.append(h)
        hseq = torch.stack(hs, 1)
        y = 2.0 * torch.einsum("blp,dp->bld", hseq, Cmat).real + x * Dskip[None, None, :]
        return y

    def _B_ref(x, wqkv, wo):
        B, S, D = x.shape
        H = 32; Dh = D // H
        qkv = (lambda x, *d: x.permute(*d))((x @ wqkv).reshape(B, S, 3, H, Dh), 2, 0, 3, 1, 4)
        q, k, v = qkv[0], qkv[1], qkv[2]
        phi = lambda t: torch.where(t > 0, t + 1, torch.exp(t)) + 1e-6
        pq, pk = phi(q), phi(k)
        kv = torch.einsum("bhsd,bhse->bhde", pk, v)
        z = torch.einsum("bhsd->bhd", pk)
        num = torch.einsum("bhqd,bhde->bhqe", pq, kv)
        den = torch.einsum("bhqd,bhd->bhq", pq, z)[..., None] + 1e-6
        o = num / den
        return (lambda x, *d: x.permute(*d))(o, 0, 2, 1, 3).reshape(B, S, D) @ wo

    x = A_x
    g = _sigmoid((x * gate_w).sum(-1, keepdims=True))
    a = _A_ref(x, A_Lambda_re, A_Lambda_im, A_B_re, A_B_im, A_C_re, A_C_im, A_log_dt, A_Dskip)
    b = _B_ref(x, B_wqkv, B_wo)
    return g * a + (1 - g) * b
```

```asm
; @launch grid=(256,1,1) block=(512,1,1) lds=163840
.amdgcn_target "amdgcn-amd-amdhsa--gfx950"
.text
.globl gated_mix__ssm_conv_s5__linear_attn_block__prompt_kernel
.p2align 8
.type gated_mix__ssm_conv_s5__linear_attn_block__prompt_kernel,@function
gated_mix__ssm_conv_s5__linear_attn_block__prompt_kernel:
    s_cmp_ge_u32 s2, 256
    s_cbranch_scc1 L_end
    s_load_dwordx2 s[4:5], s[0:1], 0
    s_mov_b32 s6, 4194304
    s_mov_b32 s7, 0x20000
    s_load_dwordx2 s[8:9], s[0:1], 24
    s_mov_b32 s10, 2097152
    s_mov_b32 s11, 0x20000
    s_load_dwordx2 s[12:13], s[0:1], 32
    s_mov_b32 s14, 2097152
    s_mov_b32 s15, 0x20000
    s_load_dwordx2 s[16:17], s[0:1], 80
    s_mov_b32 s18, 6291456
    s_mov_b32 s19, 0x20000
    s_load_dwordx2 s[20:21], s[0:1], 120
    s_mov_b32 s22, 268435456
    s_mov_b32 s23, 0x20000
    v_lshrrev_b32 v1, 6, v0
    s_nop 0
    v_readfirstlane_b32 s24, v1
    s_and_b32 s25, s2, 7
    s_mov_b32 s3, s25
    s_lshr_b32 s31, s2, 3
    s_add_u32 s31, s31, 0
    s_and_b32 s31, s31, 31
    s_and_b32 s27, s31, 1
    s_lshr_b32 s26, s31, 1
    s_and_b32 s32, s26, 7
    s_lshr_b32 s33, s31, 4
    s_lshl_b32 s34, s3, 1
    s_add_u32 s33, s33, s34
    s_cmp_eq_u32 s27, 1
    s_cselect_b32 s25, s32, s25
    s_cselect_b32 s26, s33, s26
    s_cmp_ge_u32 s24, 4
    s_cbranch_scc1 L_helper
    s_mov_b32 s70, 0
    s_load_dwordx2 s[60:61], s[0:1], 40
    s_load_dwordx2 s[62:63], s[0:1], 48
    s_load_dwordx2 s[64:65], s[0:1], 88
    s_load_dwordx2 s[84:85], s[0:1], 96
    s_mov_b32 s86, 2048
    s_mov_b32 s87, 0x20000
    s_setprio 2
    s_cmp_eq_u32 s27, 1
    s_cbranch_scc1 L_consB
    v_and_b32 v20, 63, v0
    v_lshrrev_b32 v21, 4, v20
    v_and_b32 v22, 15, v20
    v_bfe_u32 v23, v20, 1, 3
    v_xor_b32 v23, v23, v21
    v_lshlrev_b32 v23, 4, v23
    v_lshlrev_b32 v24, 7, v22
    v_add_u32 v24, v24, v23
    s_lshl_b32 s32, s24, 13
    v_xor_b32 v25, 0, v24
    v_add_u32 v1, s32, v25
    v_mov_b32 v3, v25
    v_xor_b32 v25, 64, v24
    v_add_u32 v2, s32, v25
    v_mov_b32 v4, v25
    v_bfe_u32 v25, v20, 2, 2
    v_lshlrev_b32 v26, 3, v21
    v_add_u32 v26, v26, v25
    v_and_b32 v27, 3, v20
    v_lshlrev_b32 v28, 6, v26
    v_and_b32 v30, 1, v21
    v_lshlrev_b32 v30, 5, v30
    v_add_u32 v28, v28, v30
    v_lshlrev_b32 v29, 3, v27
    v_add_u32 v28, v28, v29
    v_xor_b32 v7, 0, v28
    v_xor_b32 v8, 32, v28
    v_mov_b32 v96, 0
    v_mov_b32 v97, 0
    v_mov_b32 v98, 0
    v_mov_b32 v99, 0
    v_mov_b32 v100, 0
    v_mov_b32 v101, 0
    v_mov_b32 v102, 0
    v_mov_b32 v103, 0
    v_mov_b32 v104, 0
    v_mov_b32 v105, 0
    v_mov_b32 v106, 0
    v_mov_b32 v107, 0
    v_mov_b32 v108, 0
    v_mov_b32 v109, 0
    v_mov_b32 v110, 0
    v_mov_b32 v111, 0
    v_mov_b32 v112, 0
    v_mov_b32 v113, 0
    v_mov_b32 v114, 0
    v_mov_b32 v115, 0
    v_mov_b32 v116, 0
    v_mov_b32 v117, 0
    v_mov_b32 v118, 0
    v_mov_b32 v119, 0
    v_mov_b32 v120, 0
    v_mov_b32 v121, 0
    v_mov_b32 v122, 0
    v_mov_b32 v123, 0
    v_mov_b32 v124, 0
    v_mov_b32 v125, 0
    v_mov_b32 v126, 0
    v_mov_b32 v127, 0
    v_mov_b32 v128, 0
    v_mov_b32 v129, 0
    v_mov_b32 v130, 0
    v_mov_b32 v131, 0
    v_mov_b32 v132, 0
    v_mov_b32 v133, 0
    v_mov_b32 v134, 0
    v_mov_b32 v135, 0
    v_mov_b32 v136, 0
    v_mov_b32 v137, 0
    v_mov_b32 v138, 0
    v_mov_b32 v139, 0
    v_mov_b32 v140, 0
    v_mov_b32 v141, 0
    v_mov_b32 v142, 0
    v_mov_b32 v143, 0
    v_mov_b32 v144, 0
    v_mov_b32 v145, 0
    v_mov_b32 v146, 0
    v_mov_b32 v147, 0
    v_mov_b32 v148, 0
    v_mov_b32 v149, 0
    v_mov_b32 v150, 0
    v_mov_b32 v151, 0
    v_mov_b32 v152, 0
    v_mov_b32 v153, 0
    v_mov_b32 v154, 0
    v_mov_b32 v155, 0
    v_mov_b32 v156, 0
    v_mov_b32 v157, 0
    v_mov_b32 v158, 0
    v_mov_b32 v159, 0
    v_mov_b32 v160, 0
    v_mov_b32 v161, 0
    v_mov_b32 v162, 0
    v_mov_b32 v163, 0
    v_mov_b32 v164, 0
    v_mov_b32 v165, 0
    v_mov_b32 v166, 0
    v_mov_b32 v167, 0
    v_mov_b32 v168, 0
    v_mov_b32 v169, 0
    v_mov_b32 v170, 0
    v_mov_b32 v171, 0
    v_mov_b32 v172, 0
    v_mov_b32 v173, 0
    v_mov_b32 v174, 0
    v_mov_b32 v175, 0
    v_mov_b32 v176, 0
    v_mov_b32 v177, 0
    v_mov_b32 v178, 0
    v_mov_b32 v179, 0
    v_mov_b32 v180, 0
    v_mov_b32 v181, 0
    v_mov_b32 v182, 0
    v_mov_b32 v183, 0
    v_mov_b32 v184, 0
    v_mov_b32 v185, 0
    v_mov_b32 v186, 0
    v_mov_b32 v187, 0
    v_mov_b32 v188, 0
    v_mov_b32 v189, 0
    v_mov_b32 v190, 0
    v_mov_b32 v191, 0
    v_mov_b32 v192, 0
    v_mov_b32 v193, 0
    v_mov_b32 v194, 0
    v_mov_b32 v195, 0
    v_mov_b32 v196, 0
    v_mov_b32 v197, 0
    v_mov_b32 v198, 0
    v_mov_b32 v199, 0
    v_mov_b32 v200, 0
    v_mov_b32 v201, 0
    v_mov_b32 v202, 0
    v_mov_b32 v203, 0
    v_mov_b32 v204, 0
    v_mov_b32 v205, 0
    v_mov_b32 v206, 0
    v_mov_b32 v207, 0
    v_mov_b32 v208, 0
    v_mov_b32 v209, 0
    v_mov_b32 v210, 0
    v_mov_b32 v211, 0
    v_mov_b32 v212, 0
    v_mov_b32 v213, 0
    v_mov_b32 v214, 0
    v_mov_b32 v215, 0
    v_mov_b32 v216, 0
    v_mov_b32 v217, 0
    v_mov_b32 v218, 0
    v_mov_b32 v219, 0
    v_mov_b32 v220, 0
    v_mov_b32 v221, 0
    v_mov_b32 v222, 0
    v_mov_b32 v223, 0
    v_mov_b32 v224, 0
    v_mov_b32 v225, 0
    v_mov_b32 v226, 0
    v_mov_b32 v227, 0
    v_mov_b32 v228, 0
    v_mov_b32 v229, 0
    v_mov_b32 v230, 0
    v_mov_b32 v231, 0
    v_mov_b32 v232, 0
    v_mov_b32 v233, 0
    v_mov_b32 v234, 0
    v_mov_b32 v235, 0
    v_mov_b32 v236, 0
    v_mov_b32 v237, 0
    v_mov_b32 v238, 0
    v_mov_b32 v239, 0
    v_mov_b32 v240, 0
    v_mov_b32 v241, 0
    v_mov_b32 v242, 0
    v_mov_b32 v243, 0
    v_mov_b32 v244, 0
    v_mov_b32 v245, 0
    v_mov_b32 v246, 0
    v_mov_b32 v247, 0
    v_mov_b32 v248, 0
    v_mov_b32 v249, 0
    v_mov_b32 v250, 0
    v_mov_b32 v251, 0
    v_mov_b32 v252, 0
    v_mov_b32 v253, 0
    v_mov_b32 v254, 0
    v_mov_b32 v255, 0
    s_mov_b32 s29, 0
    s_waitcnt lgkmcnt(0)
    v_mov_b32 v24, 0
    v_mov_b32 v25, 0
    v_mov_b32 v26, 0
    v_mov_b32 v27, 0
    v_and_b32 v28, 63, v0
    v_lshlrev_b32 v28, 4, v28
    s_cmp_lg_u32 s24, 0
    s_cbranch_scc1 L_clr_1
    s_lshl_b32 s32, s26, 3
    s_add_u32 s32, s32, s25
    s_lshl_b32 s32, s32, 10
    s_add_u32 s32, s32, 266403840
    buffer_store_dwordx4 v[24:27], v28, s[20:23], s32 offen sc1
L_clr_1:
    s_barrier
    ds_read_b128 v[72:75], v3 offset:32768
    ds_read_b128 v[40:43], v1 offset:0
    ds_read_b128 v[56:59], v2 offset:0
    ds_read_b128 v[44:47], v1 offset:2048
    ds_read_b128 v[60:63], v2 offset:2048
    ds_read_b128 v[48:51], v1 offset:4096
    ds_read_b128 v[64:67], v2 offset:4096
    ds_read_b128 v[76:79], v4 offset:32768
    ds_read_b128 v[80:83], v3 offset:40960
    ds_read_b128 v[84:87], v4 offset:40960
    ds_read_b128 v[52:55], v1 offset:6144
    ds_read_b128 v[68:71], v2 offset:6144
    ds_read_b128 v[88:91], v3 offset:34816
    s_mov_b32 s28, 0
L_cloopA:
    s_add_u32 s32, s29, 53248
    s_cmp_eq_u32 s32, 159744
    s_cselect_b32 s32, 0, s32
    s_sub_u32 s30, s32, s29
    s_mov_b32 s29, s32
    s_waitcnt lgkmcnt(11)
    v_mfma_f32_16x16x32_bf16 v[96:99], v[40:43], v[72:75], v[96:99]
    s_waitcnt lgkmcnt(5)
    v_mfma_f32_16x16x32_bf16 v[96:99], v[56:59], v[76:79], v[96:99]
    s_waitcnt lgkmcnt(4)
    v_mfma_f32_16x16x32_bf16 v[112:115], v[40:43], v[80:83], v[112:115]
    s_waitcnt lgkmcnt(3)
    v_mfma_f32_16x16x32_bf16 v[112:115], v[56:59], v[84:87], v[112:115]
    v_mfma_f32_16x16x32_bf16 v[100:103], v[44:47], v[72:75], v[100:103]
    v_mfma_f32_16x16x32_bf16 v[100:103], v[60:63], v[76:79], v[100:103]
    v_mfma_f32_16x16x32_bf16 v[116:119], v[44:47], v[80:83], v[116:119]
    v_mfma_f32_16x16x32_bf16 v[116:119], v[60:63], v[84:87], v[116:119]
    v_mfma_f32_16x16x32_bf16 v[104:107], v[48:51], v[72:75], v[104:107]
    v_mfma_f32_16x16x32_bf16 v[104:107], v[64:67], v[76:79], v[104:107]
    v_mfma_f32_16x16x32_bf16 v[120:123], v[48:51], v[80:83], v[120:123]
    v_mfma_f32_16x16x32_bf16 v[120:123], v[64:67], v[84:87], v[120:123]
    s_waitcnt lgkmcnt(2)
    v_mfma_f32_16x16x32_bf16 v[108:111], v[52:55], v[72:75], v[108:111]
    ds_read_b128 v[72:75], v4 offset:34816
    s_waitcnt lgkmcnt(2)
    v_mfma_f32_16x16x32_bf16 v[108:111], v[68:71], v[76:79], v[108:111]
    ds_read_b128 v[76:79], v3 offset:43008
    v_mfma_f32_16x16x32_bf16 v[124:127], v[52:55], v[80:83], v[124:127]
    ds_read_b128 v[80:83], v4 offset:43008
    v_mfma_f32_16x16x32_bf16 v[124:127], v[68:71], v[84:87], v[124:127]
    ds_read_b128 v[84:87], v3 offset:36864
    s_waitcnt lgkmcnt(4)
    v_mfma_f32_16x16x32_bf16 v[128:131], v[40:43], v[88:91], v[128:131]
    s_waitcnt lgkmcnt(3)
    v_mfma_f32_16x16x32_bf16 v[128:131], v[56:59], v[72:75], v[128:131]
    v_mfma_f32_16x16x32_bf16 v[132:135], v[44:47], v[88:91], v[132:135]
    v_mfma_f32_16x16x32_bf16 v[132:135], v[60:63], v[72:75], v[132:135]
    v_mfma_f32_16x16x32_bf16 v[136:139], v[48:51], v[88:91], v[136:139]
    v_mfma_f32_16x16x32_bf16 v[136:139], v[64:67], v[72:75], v[136:139]
    v_mfma_f32_16x16x32_bf16 v[140:143], v[52:55], v[88:91], v[140:143]
    ds_read_b128 v[88:91], v4 offset:36864
    v_mfma_f32_16x16x32_bf16 v[140:143], v[68:71], v[72:75], v[140:143]
    ds_read_b128 v[72:75], v3 offset:45056
    s_waitcnt lgkmcnt(4)
    v_mfma_f32_16x16x32_bf16 v[144:147], v[40:43], v[76:79], v[144:147]
    s_waitcnt lgkmcnt(3)
    v_mfma_f32_16x16x32_bf16 v[144:147], v[56:59], v[80:83], v[144:147]
    v_mfma_f32_16x16x32_bf16 v[148:151], v[44:47], v[76:79], v[148:151]
    v_mfma_f32_16x16x32_bf16 v[148:151], v[60:63], v[80:83], v[148:151]
    v_mfma_f32_16x16x32_bf16 v[152:155], v[48:51], v[76:79], v[152:155]
    v_mfma_f32_16x16x32_bf16 v[152:155], v[64:67], v[80:83], v[152:155]
    v_mfma_f32_16x16x32_bf16 v[156:159], v[52:55], v[76:79], v[156:159]
    ds_read_b128 v[76:79], v4 offset:45056
    v_mfma_f32_16x16x32_bf16 v[156:159], v[68:71], v[80:83], v[156:159]
    ds_read_b128 v[80:83], v3 offset:38912
    s_waitcnt lgkmcnt(4)
    v_mfma_f32_16x16x32_bf16 v[160:163], v[40:43], v[84:87], v[160:163]
    s_waitcnt lgkmcnt(3)
    v_mfma_f32_16x16x32_bf16 v[160:163], v[56:59], v[88:91], v[160:163]
    v_mfma_f32_16x16x32_bf16 v[164:167], v[44:47], v[84:87], v[164:167]
    v_mfma_f32_16x16x32_bf16 v[164:167], v[60:63], v[88:91], v[164:167]
    v_mfma_f32_16x16x32_bf16 v[168:171], v[48:51], v[84:87], v[168:171]
    v_mfma_f32_16x16x32_bf16 v[168:171], v[64:67], v[88:91], v[168:171]
    v_mfma_f32_16x16x32_bf16 v[172:175], v[52:55], v[84:87], v[172:175]
    ds_read_b128 v[84:87], v4 offset:38912
    v_mfma_f32_16x16x32_bf16 v[172:175], v[68:71], v[88:91], v[172:175]
    ds_read_b128 v[88:91], v3 offset:47104
    s_waitcnt lgkmcnt(4)
    v_mfma_f32_16x16x32_bf16 v[176:179], v[40:43], v[72:75], v[176:179]
    s_waitcnt lgkmcnt(3)
    v_mfma_f32_16x16x32_bf16 v[176:179], v[56:59], v[76:79], v[176:179]
    v_mfma_f32_16x16x32_bf16 v[180:183], v[44:47], v[72:75], v[180:183]
    v_mfma_f32_16x16x32_bf16 v[180:183], v[60:63], v[76:79], v[180:183]
    v_mfma_f32_16x16x32_bf16 v[184:187], v[48:51], v[72:75], v[184:187]
    v_mfma_f32_16x16x32_bf16 v[184:187], v[64:67], v[76:79], v[184:187]
    v_mfma_f32_16x16x32_bf16 v[188:191], v[52:55], v[72:75], v[188:191]
    ds_read_b128 v[72:75], v4 offset:47104
    v_mfma_f32_16x16x32_bf16 v[188:191], v[68:71], v[76:79], v[188:191]
    ds_read_b64_tr_b16 v[76:77], v7 offset:49152
    s_waitcnt lgkmcnt(4)
    v_mfma_f32_16x16x32_bf16 v[192:195], v[40:43], v[80:83], v[192:195]
    ds_read_b64_tr_b16 v[78:79], v7 offset:49408
    s_waitcnt lgkmcnt(4)
    v_mfma_f32_16x16x32_bf16 v[192:195], v[56:59], v[84:87], v[192:195]
    v_mfma_f32_16x16x32_bf16 v[196:199], v[44:47], v[80:83], v[196:199]
    v_mfma_f32_16x16x32_bf16 v[196:199], v[60:63], v[84:87], v[196:199]
    v_mfma_f32_16x16x32_bf16 v[200:203], v[48:51], v[80:83], v[200:203]
    v_mfma_f32_16x16x32_bf16 v[200:203], v[64:67], v[84:87], v[200:203]
    v_mfma_f32_16x16x32_bf16 v[204:207], v[52:55], v[80:83], v[204:207]
    ds_read_b64_tr_b16 v[80:81], v7 offset:51200
    v_mfma_f32_16x16x32_bf16 v[204:207], v[68:71], v[84:87], v[204:207]
    ds_read_b64_tr_b16 v[82:83], v7 offset:51456
    s_waitcnt lgkmcnt(5)
    v_mfma_f32_16x16x32_bf16 v[208:211], v[40:43], v[88:91], v[208:211]
    ds_read_b64_tr_b16 v[84:85], v8 offset:49152
    s_waitcnt lgkmcnt(5)
    v_mfma_f32_16x16x32_bf16 v[208:211], v[56:59], v[72:75], v[208:211]
    ds_read_b64_tr_b16 v[86:87], v8 offset:49408
    v_mfma_f32_16x16x32_bf16 v[212:215], v[44:47], v[88:91], v[212:215]
    v_mfma_f32_16x16x32_bf16 v[212:215], v[60:63], v[72:75], v[212:215]
    v_mfma_f32_16x16x32_bf16 v[216:219], v[48:51], v[88:91], v[216:219]
    v_mfma_f32_16x16x32_bf16 v[216:219], v[64:67], v[72:75], v[216:219]
    v_mfma_f32_16x16x32_bf16 v[220:223], v[52:55], v[88:91], v[220:223]
    ds_read_b64_tr_b16 v[88:89], v8 offset:51200
    ds_read_b64_tr_b16 v[90:91], v8 offset:51456
    v_mfma_f32_16x16x32_bf16 v[220:223], v[68:71], v[72:75], v[220:223]
    v_add_u32 v1, s30, v1
    v_add_u32 v2, s30, v2
    s_waitcnt lgkmcnt(6)
    v_mfma_f32_16x16x32_bf16 v[224:227], v[76:79], v[40:43], v[224:227]
    v_add_u32 v3, s30, v3
    v_add_u32 v4, s30, v4
    s_waitcnt lgkmcnt(4)
    v_mfma_f32_16x16x32_bf16 v[224:227], v[80:83], v[56:59], v[224:227]
    v_add_u32 v7, s30, v7
    v_add_u32 v8, s30, v8
    s_waitcnt lgkmcnt(2)
    v_mfma_f32_16x16x32_bf16 v[240:243], v[84:87], v[40:43], v[240:243]
    s_waitcnt lgkmcnt(0)
    v_mfma_f32_16x16x32_bf16 v[240:243], v[88:91], v[56:59], v[240:243]
    s_waitcnt lgkmcnt(0)
    s_barrier
    v_mfma_f32_16x16x32_bf16 v[228:231], v[76:79], v[44:47], v[228:231]
    ds_read_b128 v[72:75], v3 offset:32768
    v_mfma_f32_16x16x32_bf16 v[228:231], v[80:83], v[60:63], v[228:231]
    ds_read_b128 v[40:43], v1 offset:0
    v_mfma_f32_16x16x32_bf16 v[244:247], v[84:87], v[44:47], v[244:247]
    ds_read_b128 v[56:59], v2 offset:0
    v_mfma_f32_16x16x32_bf16 v[244:247], v[88:91], v[60:63], v[244:247]
    ds_read_b128 v[44:47], v1 offset:2048
    v_mfma_f32_16x16x32_bf16 v[232:235], v[76:79], v[48:51], v[232:235]
    ds_read_b128 v[60:63], v2 offset:2048
    v_mfma_f32_16x16x32_bf16 v[232:235], v[80:83], v[64:67], v[232:235]
    v_mfma_f32_16x16x32_bf16 v[248:251], v[84:87], v[48:51], v[248:251]
    ds_read_b128 v[48:51], v1 offset:4096
    v_mfma_f32_16x16x32_bf16 v[248:251], v[88:91], v[64:67], v[248:251]
    ds_read_b128 v[64:67], v2 offset:4096
    v_mfma_f32_16x16x32_bf16 v[236:239], v[76:79], v[52:55], v[236:239]
    ds_read_b128 v[76:79], v4 offset:32768
    v_mfma_f32_16x16x32_bf16 v[236:239], v[80:83], v[68:71], v[236:239]
    ds_read_b128 v[80:83], v3 offset:40960
    v_mfma_f32_16x16x32_bf16 v[252:255], v[84:87], v[52:55], v[252:255]
    ds_read_b128 v[84:87], v4 offset:40960
    v_mfma_f32_16x16x32_bf16 v[252:255], v[88:91], v[68:71], v[252:255]
    ds_read_b128 v[52:55], v1 offset:6144
    ds_read_b128 v[68:71], v2 offset:6144
    ds_read_b128 v[88:91], v3 offset:34816
    s_add_u32 s28, s28, 1
    s_cmp_lt_u32 s28, 16
    s_cbranch_scc1 L_cloopA
    s_waitcnt vmcnt(0) lgkmcnt(0)
    s_lshl_b32 s32, s26, 8
    s_lshl_b32 s33, s25, 5
    s_add_u32 s32, s32, s33
    s_lshl_b32 s33, s24, 3
    s_add_u32 s32, s32, s33
    s_lshl_b32 s32, s32, 10
    s_add_u32 s32, s32, 251658240
    s_add_u32 s33, s32, 4194304
    v_and_b32 v6, 63, v0
    v_lshlrev_b32 v6, 7, v6
    buffer_load_dword v5, v6, s[20:23], s32 offen
    buffer_load_dword v4, v6, s[20:23], s33 offen
    v_and_b32 v10, 15, v0
    v_lshlrev_b32 v10, 5, v10
    v_add_u32 v10, 159744, v10
    ds_read_b128 v[40:43], v10 offset:0
    ds_read_b64 v[44:45], v10 offset:16
    ds_read_b128 v[48:51], v10 offset:512
    ds_read_b64 v[52:53], v10 offset:528
    ds_read_b128 v[56:59], v10 offset:1024
    ds_read_b64 v[60:61], v10 offset:1040
    ds_read_b128 v[64:67], v10 offset:1536
    ds_read_b64 v[68:69], v10 offset:1552
    v_bfe_u32 v11, v0, 4, 2
    s_lshl_b32 s32, s24, 2
    v_add_u32 v11, s32, v11
    v_lshlrev_b32 v11, 9, v11
    v_and_b32 v9, 15, v0
    v_lshlrev_b32 v9, 3, v9
    v_add_u32 v11, v11, v9
    s_nop 3
    s_waitcnt lgkmcnt(0)
    v_pk_fma_f32 v[76:77], v[40:41], v[96:97], v[98:99] op_sel:[0,0,0] op_sel_hi:[0,1,1]
    v_pk_fma_f32 v[78:79], v[40:41], v[112:113], v[114:115] op_sel:[0,0,0] op_sel_hi:[0,1,1]
    v_pk_fma_f32 v[76:77], v[40:41], v[112:113], v[76:77] op_sel:[1,0,0] op_sel_hi:[1,1,1] neg_lo:[1,0,0] neg_hi:[1,0,0]
    v_pk_fma_f32 v[78:79], v[40:41], v[96:97], v[78:79] op_sel:[1,0,0] op_sel_hi:[1,1,1]
    v_pk_fma_f32 v[84:85], v[48:49], v[128:129], v[130:131] op_sel:[0,0,0] op_sel_hi:[0,1,1]
    v_pk_fma_f32 v[86:87], v[48:49], v[144:145], v[146:147] op_sel:[0,0,0] op_sel_hi:[0,1,1]
    v_pk_fma_f32 v[84:85], v[48:49], v[144:145], v[84:85] op_sel:[1,0,0] op_sel_hi:[1,1,1] neg_lo:[1,0,0] neg_hi:[1,0,0]
    v_pk_fma_f32 v[86:87], v[48:49], v[128:129], v[86:87] op_sel:[1,0,0] op_sel_hi:[1,1,1]
    v_pk_fma_f32 v[92:93], v[56:57], v[160:161], v[162:163] op_sel:[0,0,0] op_sel_hi:[0,1,1]
    v_pk_fma_f32 v[94:95], v[56:57], v[176:177], v[178:179] op_sel:[0,0,0] op_sel_hi:[0,1,1]
    v_pk_fma_f32 v[92:93], v[56:57], v[176:177], v[92:93] op_sel:[1,0,0] op_sel_hi:[1,1,1] neg_lo:[1,0,0] neg_hi:[1,0,0]
    v_pk_fma_f32 v[94:95], v[56:57], v[160:161], v[94:95] op_sel:[1,0,0] op_sel_hi:[1,1,1]
    v_pk_fma_f32 v[16:17], v[64:65], v[192:193], v[194:195] op_sel:[0,0,0] op_sel_hi:[0,1,1]
    v_pk_fma_f32 v[18:19], v[64:65], v[208:209], v[210:211] op_sel:[0,0,0] op_sel_hi:[0,1,1]
    v_pk_fma_f32 v[16:17], v[64:65], v[208:209], v[16:17] op_sel:[1,0,0] op_sel_hi:[1,1,1] neg_lo:[1,0,0] neg_hi:[1,0,0]
    v_pk_fma_f32 v[18:19], v[64:65], v[192:193], v[18:19] op_sel:[1,0,0] op_sel_hi:[1,1,1]
    v_pk_fma_f32 v[72:73], v[40:41], v[76:77], v[100:101] op_sel:[0,0,0] op_sel_hi:[0,1,1]
    v_pk_fma_f32 v[74:75], v[40:41], v[78:79], v[116:117] op_sel:[0,0,0] op_sel_hi:[0,1,1]
    v_pk_fma_f32 v[72:73], v[40:41], v[78:79], v[72:73] op_sel:[1,0,0] op_sel_hi:[1,1,1] neg_lo:[1,0,0] neg_hi:[1,0,0]
    v_pk_fma_f32 v[74:75], v[40:41], v[76:77], v[74:75] op_sel:[1,0,0] op_sel_hi:[1,1,1]
    v_pk_fma_f32 v[80:81], v[48:49], v[84:85], v[132:133] op_sel:[0,0,0] op_sel_hi:[0,1,1]
    v_pk_fma_f32 v[82:83], v[48:49], v[86:87], v[148:149] op_sel:[0,0,0] op_sel_hi:[0,1,1]
    v_pk_fma_f32 v[80:81], v[48:49], v[86:87], v[80:81] op_sel:[1,0,0] op_sel_hi:[1,1,1] neg_lo:[1,0,0] neg_hi:[1,0,0]
    v_pk_fma_f32 v[82:83], v[48:49], v[84:85], v[82:83] op_sel:[1,0,0] op_sel_hi:[1,1,1]
    v_pk_fma_f32 v[88:89], v[56:57], v[92:93], v[164:165] op_sel:[0,0,0] op_sel_hi:[0,1,1]
    v_pk_fma_f32 v[90:91], v[56:57], v[94:95], v[180:181] op_sel:[0,0,0] op_sel_hi:[0,1,1]
    v_pk_fma_f32 v[88:89], v[56:57], v[94:95], v[88:89] op_sel:[1,0,0] op_sel_hi:[1,1,1] neg_lo:[1,0,0] neg_hi:[1,0,0]
    v_pk_fma_f32 v[90:91], v[56:57], v[92:93], v[90:91] op_sel:[1,0,0] op_sel_hi:[1,1,1]
    v_pk_fma_f32 v[12:13], v[64:65], v[16:17], v[196:197] op_sel:[0,0,0] op_sel_hi:[0,1,1]
    v_pk_fma_f32 v[14:15], v[64:65], v[18:19], v[212:213] op_sel:[0,0,0] op_sel_hi:[0,1,1]
    v_pk_fma_f32 v[12:13], v[64:65], v[18:19], v[12:13] op_sel:[1,0,0] op_sel_hi:[1,1,1] neg_lo:[1,0,0] neg_hi:[1,0,0]
    v_pk_fma_f32 v[14:15], v[64:65], v[16:17], v[14:15] op_sel:[1,0,0] op_sel_hi:[1,1,1]
    v_pk_fma_f32 v[76:77], v[40:41], v[72:73], v[102:103] op_sel:[0,0,0] op_sel_hi:[0,1,1]
    v_pk_fma_f32 v[78:79], v[40:41], v[74:75], v[118:119] op_sel:[0,0,0] op_sel_hi:[0,1,1]
    v_pk_fma_f32 v[76:77], v[40:41], v[74:75], v[76:77] op_sel:[1,0,0] op_sel_hi:[1,1,1] neg_lo:[1,0,0] neg_hi:[1,0,0]
    v_pk_fma_f32 v[78:79], v[40:41], v[72:73], v[78:79] op_sel:[1,0,0] op_sel_hi:[1,1,1]
    v_pk_fma_f32 v[84:85], v[48:49], v[80:81], v[134:135] op_sel:[0,0,0] op_sel_hi:[0,1,1]
    v_pk_fma_f32 v[86:87], v[48:49], v[82:83], v[150:151] op_sel:[0,0,0] op_sel_hi:[0,1,1]
    v_pk_fma_f32 v[84:85], v[48:49], v[82:83], v[84:85] op_sel:[1,0,0] op_sel_hi:[1,1,1] neg_lo:[1,0,0] neg_hi:[1,0,0]
    v_pk_fma_f32 v[86:87], v[48:49], v[80:81], v[86:87] op_sel:[1,0,0] op_sel_hi:[1,1,1]
    v_pk_fma_f32 v[92:93], v[56:57], v[88:89], v[166:167] op_sel:[0,0,0] op_sel_hi:[0,1,1]
    v_pk_fma_f32 v[94:95], v[56:57], v[90:91], v[182:183] op_sel:[0,0,0] op_sel_hi:[0,1,1]
    v_pk_fma_f32 v[92:93], v[56:57], v[90:91], v[92:93] op_sel:[1,0,0] op_sel_hi:[1,1,1] neg_lo:[1,0,0] neg_hi:[1,0,0]
    v_pk_fma_f32 v[94:95], v[56:57], v[88:89], v[94:95] op_sel:[1,0,0] op_sel_hi:[1,1,1]
    v_pk_fma_f32 v[16:17], v[64:65], v[12:13], v[198:199] op_sel:[0,0,0] op_sel_hi:[0,1,1]
    v_pk_fma_f32 v[18:19], v[64:65], v[14:15], v[214:215] op_sel:[0,0,0] op_sel_hi:[0,1,1]
    v_pk_fma_f32 v[16:17], v[64:65], v[14:15], v[16:17] op_sel:[1,0,0] op_sel_hi:[1,1,1] neg_lo:[1,0,0] neg_hi:[1,0,0]
    v_pk_fma_f32 v[18:19], v[64:65], v[12:13], v[18:19] op_sel:[1,0,0] op_sel_hi:[1,1,1]
    v_pk_fma_f32 v[72:73], v[40:41], v[76:77], v[104:105] op_sel:[0,0,0] op_sel_hi:[0,1,1]
    v_pk_fma_f32 v[74:75], v[40:41], v[78:79], v[120:121] op_sel:[0,0,0] op_sel_hi:[0,1,1]
    v_pk_fma_f32 v[72:73], v[40:41], v[78:79], v[72:73] op_sel:[1,0,0] op_sel_hi:[1,1,1] neg_lo:[1,0,0] neg_hi:[1,0,0]
    v_pk_fma_f32 v[74:75], v[40:41], v[76:77], v[74:75] op_sel:[1,0,0] op_sel_hi:[1,1,1]
    v_pk_fma_f32 v[80:81], v[48:49], v[84:85], v[136:137] op_sel:[0,0,0] op_sel_hi:[0,1,1]
    v_pk_fma_f32 v[82:83], v[48:49], v[86:87], v[152:153] op_sel:[0,0,0] op_sel_hi:[0,1,1]
    v_pk_fma_f32 v[80:81], v[48:49], v[86:87], v[80:81] op_sel:[1,0,0] op_sel_hi:[1,1,1] neg_lo:[1,0,0] neg_hi:[1,0,0]
    v_pk_fma_f32 v[82:83], v[48:49], v[84:85], v[82:83] op_sel:[1,0,0] op_sel_hi:[1,1,1]
    v_pk_fma_f32 v[88:89], v[56:57], v[92:93], v[168:169] op_sel:[0,0,0] op_sel_hi:[0,1,1]
    v_pk_fma_f32 v[90:91], v[56:57], v[94:95], v[184:185] op_sel:[0,0,0] op_sel_hi:[0,1,1]
    v_pk_fma_f32 v[88:89], v[56:57], v[94:95], v[88:89] op_sel:[1,0,0] op_sel_hi:[1,1,1] neg_lo:[1,0,0] neg_hi:[1,0,0]
    v_pk_fma_f32 v[90:91], v[56:57], v[92:93], v[90:91] op_sel:[1,0,0] op_sel_hi:[1,1,1]
    v_pk_fma_f32 v[12:13], v[64:65], v[16:17], v[200:201] op_sel:[0,0,0] op_sel_hi:[0,1,1]
    v_pk_fma_f32 v[14:15], v[64:65], v[18:19], v[216:217] op_sel:[0,0,0] op_sel_hi:[0,1,1]
    v_pk_fma_f32 v[12:13], v[64:65], v[18:19], v[12:13] op_sel:[1,0,0] op_sel_hi:[1,1,1] neg_lo:[1,0,0] neg_hi:[1,0,0]
    v_pk_fma_f32 v[14:15], v[64:65], v[16:17], v[14:15] op_sel:[1,0,0] op_sel_hi:[1,1,1]
    v_pk_fma_f32 v[76:77], v[40:41], v[72:73], v[106:107] op_sel:[0,0,0] op_sel_hi:[0,1,1]
    v_pk_fma_f32 v[78:79], v[40:41], v[74:75], v[122:123] op_sel:[0,0,0] op_sel_hi:[0,1,1]
    v_pk_fma_f32 v[76:77], v[40:41], v[74:75], v[76:77] op_sel:[1,0,0] op_sel_hi:[1,1,1] neg_lo:[1,0,0] neg_hi:[1,0,0]
    v_pk_fma_f32 v[78:79], v[40:41], v[72:73], v[78:79] op_sel:[1,0,0] op_sel_hi:[1,1,1]
    v_pk_fma_f32 v[84:85], v[48:49], v[80:81], v[138:139] op_sel:[0,0,0] op_sel_hi:[0,1,1]
    v_pk_fma_f32 v[86:87], v[48:49], v[82:83], v[154:155] op_sel:[0,0,0] op_sel_hi:[0,1,1]
    v_pk_fma_f32 v[84:85], v[48:49], v[82:83], v[84:85] op_sel:[1,0,0] op_sel_hi:[1,1,1] neg_lo:[1,0,0] neg_hi:[1,0,0]
    v_pk_fma_f32 v[86:87], v[48:49], v[80:81], v[86:87] op_sel:[1,0,0] op_sel_hi:[1,1,1]
    v_pk_fma_f32 v[92:93], v[56:57], v[88:89], v[170:171] op_sel:[0,0,0] op_sel_hi:[0,1,1]
    v_pk_fma_f32 v[94:95], v[56:57], v[90:91], v[186:187] op_sel:[0,0,0] op_sel_hi:[0,1,1]
    v_pk_fma_f32 v[92:93], v[56:57], v[90:91], v[92:93] op_sel:[1,0,0] op_sel_hi:[1,1,1] neg_lo:[1,0,0] neg_hi:[1,0,0]
    v_pk_fma_f32 v[94:95], v[56:57], v[88:89], v[94:95] op_sel:[1,0,0] op_sel_hi:[1,1,1]
    v_pk_fma_f32 v[16:17], v[64:65], v[12:13], v[202:203] op_sel:[0,0,0] op_sel_hi:[0,1,1]
    v_pk_fma_f32 v[18:19], v[64:65], v[14:15], v[218:219] op_sel:[0,0,0] op_sel_hi:[0,1,1]
    v_pk_fma_f32 v[16:17], v[64:65], v[14:15], v[16:17] op_sel:[1,0,0] op_sel_hi:[1,1,1] neg_lo:[1,0,0] neg_hi:[1,0,0]
    v_pk_fma_f32 v[18:19], v[64:65], v[12:13], v[18:19] op_sel:[1,0,0] op_sel_hi:[1,1,1]
    v_pk_fma_f32 v[72:73], v[40:41], v[76:77], v[108:109] op_sel:[0,0,0] op_sel_hi:[0,1,1]
    v_pk_fma_f32 v[74:75], v[40:41], v[78:79], v[124:125] op_sel:[0,0,0] op_sel_hi:[0,1,1]
    v_pk_fma_f32 v[72:73], v[40:41], v[78:79], v[72:73] op_sel:[1,0,0] op_sel_hi:[1,1,1] neg_lo:[1,0,0] neg_hi:[1,0,0]
    v_pk_fma_f32 v[74:75], v[40:41], v[76:77], v[74:75] op_sel:[1,0,0] op_sel_hi:[1,1,1]
    v_pk_fma_f32 v[80:81], v[48:49], v[84:85], v[140:141] op_sel:[0,0,0] op_sel_hi:[0,1,1]
    v_pk_fma_f32 v[82:83], v[48:49], v[86:87], v[156:157] op_sel:[0,0,0] op_sel_hi:[0,1,1]
    v_pk_fma_f32 v[80:81], v[48:49], v[86:87], v[80:81] op_sel:[1,0,0] op_sel_hi:[1,1,1] neg_lo:[1,0,0] neg_hi:[1,0,0]
    v_pk_fma_f32 v[82:83], v[48:49], v[84:85], v[82:83] op_sel:[1,0,0] op_sel_hi:[1,1,1]
    v_pk_fma_f32 v[88:89], v[56:57], v[92:93], v[172:173] op_sel:[0,0,0] op_sel_hi:[0,1,1]
    v_pk_fma_f32 v[90:91], v[56:57], v[94:95], v[188:189] op_sel:[0,0,0] op_sel_hi:[0,1,1]
    v_pk_fma_f32 v[88:89], v[56:57], v[94:95], v[88:89] op_sel:[1,0,0] op_sel_hi:[1,1,1] neg_lo:[1,0,0] neg_hi:[1,0,0]
    v_pk_fma_f32 v[90:91], v[56:57], v[92:93], v[90:91] op_sel:[1,0,0] op_sel_hi:[1,1,1]
    v_pk_fma_f32 v[12:13], v[64:65], v[16:17], v[204:205] op_sel:[0,0,0] op_sel_hi:[0,1,1]
    v_pk_fma_f32 v[14:15], v[64:65], v[18:19], v[220:221] op_sel:[0,0,0] op_sel_hi:[0,1,1]
    v_pk_fma_f32 v[12:13], v[64:65], v[18:19], v[12:13] op_sel:[1,0,0] op_sel_hi:[1,1,1] neg_lo:[1,0,0] neg_hi:[1,0,0]
    v_pk_fma_f32 v[14:15], v[64:65], v[16:17], v[14:15] op_sel:[1,0,0] op_sel_hi:[1,1,1]
    v_pk_fma_f32 v[76:77], v[40:41], v[72:73], v[110:111] op_sel:[0,0,0] op_sel_hi:[0,1,1]
    v_pk_fma_f32 v[78:79], v[40:41], v[74:75], v[126:127] op_sel:[0,0,0] op_sel_hi:[0,1,1]
    v_pk_fma_f32 v[76:77], v[40:41], v[74:75], v[76:77] op_sel:[1,0,0] op_sel_hi:[1,1,1] neg_lo:[1,0,0] neg_hi:[1,0,0]
    v_pk_fma_f32 v[78:79], v[40:41], v[72:73], v[78:79] op_sel:[1,0,0] op_sel_hi:[1,1,1]
    v_pk_fma_f32 v[84:85], v[48:49], v[80:81], v[142:143] op_sel:[0,0,0] op_sel_hi:[0,1,1]
    v_pk_fma_f32 v[86:87], v[48:49], v[82:83], v[158:159] op_sel:[0,0,0] op_sel_hi:[0,1,1]
    v_pk_fma_f32 v[84:85], v[48:49], v[82:83], v[84:85] op_sel:[1,0,0] op_sel_hi:[1,1,1] neg_lo:[1,0,0] neg_hi:[1,0,0]
    v_pk_fma_f32 v[86:87], v[48:49], v[80:81], v[86:87] op_sel:[1,0,0] op_sel_hi:[1,1,1]
    v_pk_fma_f32 v[92:93], v[56:57], v[88:89], v[174:175] op_sel:[0,0,0] op_sel_hi:[0,1,1]
    v_pk_fma_f32 v[94:95], v[56:57], v[90:91], v[190:191] op_sel:[0,0,0] op_sel_hi:[0,1,1]
    v_pk_fma_f32 v[92:93], v[56:57], v[90:91], v[92:93] op_sel:[1,0,0] op_sel_hi:[1,1,1] neg_lo:[1,0,0] neg_hi:[1,0,0]
    v_pk_fma_f32 v[94:95], v[56:57], v[88:89], v[94:95] op_sel:[1,0,0] op_sel_hi:[1,1,1]
    v_pk_fma_f32 v[16:17], v[64:65], v[12:13], v[206:207] op_sel:[0,0,0] op_sel_hi:[0,1,1]
    v_pk_fma_f32 v[18:19], v[64:65], v[14:15], v[222:223] op_sel:[0,0,0] op_sel_hi:[0,1,1]
    v_pk_fma_f32 v[16:17], v[64:65], v[14:15], v[16:17] op_sel:[1,0,0] op_sel_hi:[1,1,1] neg_lo:[1,0,0] neg_hi:[1,0,0]
    v_pk_fma_f32 v[18:19], v[64:65], v[12:13], v[18:19] op_sel:[1,0,0] op_sel_hi:[1,1,1]
    v_fma_f32 v72, v42, v76, v77
    v_fma_f32 v73, v42, v78, v79
    v_fma_f32 v72, -v43, v78, v72
    v_fma_f32 v73, v43, v76, v73
    ds_write_b64 v11, v[72:73] offset:0
    v_fma_f32 v80, v50, v84, v85
    v_fma_f32 v81, v50, v86, v87
    v_fma_f32 v80, -v51, v86, v80
    v_fma_f32 v81, v51, v84, v81
    ds_write_b64 v11, v[80:81] offset:128
    v_fma_f32 v88, v58, v92, v93
    v_fma_f32 v89, v58, v94, v95
    v_fma_f32 v88, -v59, v94, v88
    v_fma_f32 v89, v59, v92, v89
    ds_write_b64 v11, v[88:89] offset:256
    v_fma_f32 v12, v66, v16, v17
    v_fma_f32 v13, v66, v18, v19
    v_fma_f32 v12, -v67, v18, v12
    v_fma_f32 v13, v67, v16, v13
    ds_write_b64 v11, v[12:13] offset:384
    s_waitcnt lgkmcnt(0)
    s_barrier
    ds_read_b64 v[46:47], v11 offset:8192
    ds_read_b64 v[54:55], v11 offset:8320
    ds_read_b64 v[62:63], v11 offset:8448
    ds_read_b64 v[70:71], v11 offset:8576
    v_pk_mul_f32 v[20:21], v[44:45], v[96:97] op_sel:[0,0] op_sel_hi:[0,1]
    v_pk_mul_f32 v[22:23], v[44:45], v[96:97] op_sel:[1,0] op_sel_hi:[1,1]
    v_pk_fma_f32 v[96:97], v[44:45], v[112:113], v[20:21] op_sel:[1,0,0] op_sel_hi:[1,1,1] neg_lo:[1,0,0] neg_hi:[1,0,0]
    v_pk_fma_f32 v[112:113], v[44:45], v[112:113], v[22:23] op_sel:[0,0,0] op_sel_hi:[0,1,1]
    v_pk_mul_f32 v[24:25], v[44:45], v[98:99] op_sel:[0,0] op_sel_hi:[0,1]
    v_pk_mul_f32 v[26:27], v[44:45], v[98:99] op_sel:[1,0] op_sel_hi:[1,1]
    v_pk_fma_f32 v[98:99], v[44:45], v[114:115], v[24:25] op_sel:[1,0,0] op_sel_hi:[1,1,1] neg_lo:[1,0,0] neg_hi:[1,0,0]
    v_pk_fma_f32 v[114:115], v[44:45], v[114:115], v[26:27] op_sel:[0,0,0] op_sel_hi:[0,1,1]
    v_pk_mul_f32 v[20:21], v[44:45], v[100:101] op_sel:[0,0] op_sel_hi:[0,1]
    v_pk_mul_f32 v[22:23], v[44:45], v[100:101] op_sel:[1,0] op_sel_hi:[1,1]
    v_pk_fma_f32 v[100:101], v[44:45], v[116:117], v[20:21] op_sel:[1,0,0] op_sel_hi:[1,1,1] neg_lo:[1,0,0] neg_hi:[1,0,0]
    v_pk_fma_f32 v[116:117], v[44:45], v[116:117], v[22:23] op_sel:[0,0,0] op_sel_hi:[0,1,1]
    v_pk_mul_f32 v[24:25], v[44:45], v[102:103] op_sel:[0,0] op_sel_hi:[0,1]
    v_pk_mul_f32 v[26:27], v[44:45], v[102:103] op_sel:[1,0] op_sel_hi:[1,1]
    v_pk_fma_f32 v[102:103], v[44:45], v[118:119], v[24:25] op_sel:[1,0,0] op_sel_hi:[1,1,1] neg_lo:[1,0,0] neg_hi:[1,0,0]
    v_pk_fma_f32 v[118:119], v[44:45], v[118:119], v[26:27] op_sel:[0,0,0] op_sel_hi:[0,1,1]
    v_pk_mul_f32 v[20:21], v[44:45], v[104:105] op_sel:[0,0] op_sel_hi:[0,1]
    v_pk_mul_f32 v[22:23], v[44:45], v[104:105] op_sel:[1,0] op_sel_hi:[1,1]
    v_pk_fma_f32 v[104:105], v[44:45], v[120:121], v[20:21] op_sel:[1,0,0] op_sel_hi:[1,1,1] neg_lo:[1,0,0] neg_hi:[1,0,0]
    v_pk_fma_f32 v[120:121], v[44:45], v[120:121], v[22:23] op_sel:[0,0,0] op_sel_hi:[0,1,1]
    v_pk_mul_f32 v[24:25], v[44:45], v[106:107] op_sel:[0,0] op_sel_hi:[0,1]
    v_pk_mul_f32 v[26:27], v[44:45], v[106:107] op_sel:[1,0] op_sel_hi:[1,1]
    v_pk_fma_f32 v[106:107], v[44:45], v[122:123], v[24:25] op_sel:[1,0,0] op_sel_hi:[1,1,1] neg_lo:[1,0,0] neg_hi:[1,0,0]
    v_pk_fma_f32 v[122:123], v[44:45], v[122:123], v[26:27] op_sel:[0,0,0] op_sel_hi:[0,1,1]
    v_pk_mul_f32 v[20:21], v[44:45], v[108:109] op_sel:[0,0] op_sel_hi:[0,1]
    v_pk_mul_f32 v[22:23], v[44:45], v[108:109] op_sel:[1,0] op_sel_hi:[1,1]
    v_pk_fma_f32 v[108:109], v[44:45], v[124:125], v[20:21] op_sel:[1,0,0] op_sel_hi:[1,1,1] neg_lo:[1,0,0] neg_hi:[1,0,0]
    v_pk_fma_f32 v[124:125], v[44:45], v[124:125], v[22:23] op_sel:[0,0,0] op_sel_hi:[0,1,1]
    v_pk_mul_f32 v[24:25], v[44:45], v[110:111] op_sel:[0,0] op_sel_hi:[0,1]
    v_pk_mul_f32 v[26:27], v[44:45], v[110:111] op_sel:[1,0] op_sel_hi:[1,1]
    v_pk_fma_f32 v[110:111], v[44:45], v[126:127], v[24:25] op_sel:[1,0,0] op_sel_hi:[1,1,1] neg_lo:[1,0,0] neg_hi:[1,0,0]
    v_pk_fma_f32 v[126:127], v[44:45], v[126:127], v[26:27] op_sel:[0,0,0] op_sel_hi:[0,1,1]
    v_pk_mul_f32 v[20:21], v[52:53], v[128:129] op_sel:[0,0] op_sel_hi:[0,1]
    v_pk_mul_f32 v[22:23], v[52:53], v[128:129] op_sel:[1,0] op_sel_hi:[1,1]
    v_pk_fma_f32 v[128:129], v[52:53], v[144:145], v[20:21] op_sel:[1,0,0] op_sel_hi:[1,1,1] neg_lo:[1,0,0] neg_hi:[1,0,0]
    v_pk_fma_f32 v[144:145], v[52:53], v[144:145], v[22:23] op_sel:[0,0,0] op_sel_hi:[0,1,1]
    v_pk_mul_f32 v[24:25], v[52:53], v[130:131] op_sel:[0,0] op_sel_hi:[0,1]
    v_pk_mul_f32 v[26:27], v[52:53], v[130:131] op_sel:[1,0] op_sel_hi:[1,1]
    v_pk_fma_f32 v[130:131], v[52:53], v[146:147], v[24:25] op_sel:[1,0,0] op_sel_hi:[1,1,1] neg_lo:[1,0,0] neg_hi:[1,0,0]
    v_pk_fma_f32 v[146:147], v[52:53], v[146:147], v[26:27] op_sel:[0,0,0] op_sel_hi:[0,1,1]
    v_pk_mul_f32 v[20:21], v[52:53], v[132:133] op_sel:[0,0] op_sel_hi:[0,1]
    v_pk_mul_f32 v[22:23], v[52:53], v[132:133] op_sel:[1,0] op_sel_hi:[1,1]
    v_pk_fma_f32 v[132:133], v[52:53], v[148:149], v[20:21] op_sel:[1,0,0] op_sel_hi:[1,1,1] neg_lo:[1,0,0] neg_hi:[1,0,0]
    v_pk_fma_f32 v[148:149], v[52:53], v[148:149], v[22:23] op_sel:[0,0,0] op_sel_hi:[0,1,1]
    v_pk_mul_f32 v[24:25], v[52:53], v[134:135] op_sel:[0,0] op_sel_hi:[0,1]
    v_pk_mul_f32 v[26:27], v[52:53], v[134:135] op_sel:[1,0] op_sel_hi:[1,1]
    v_pk_fma_f32 v[134:135], v[52:53], v[150:151], v[24:25] op_sel:[1,0,0] op_sel_hi:[1,1,1] neg_lo:[1,0,0] neg_hi:[1,0,0]
    v_pk_fma_f32 v[150:151], v[52:53], v[150:151], v[26:27] op_sel:[0,0,0] op_sel_hi:[0,1,1]
    v_pk_mul_f32 v[20:21], v[52:53], v[136:137] op_sel:[0,0] op_sel_hi:[0,1]
    v_pk_mul_f32 v[22:23], v[52:53], v[136:137] op_sel:[1,0] op_sel_hi:[1,1]
    v_pk_fma_f32 v[136:137], v[52:53], v[152:153], v[20:21] op_sel:[1,0,0] op_sel_hi:[1,1,1] neg_lo:[1,0,0] neg_hi:[1,0,0]
    v_pk_fma_f32 v[152:153], v[52:53], v[152:153], v[22:23] op_sel:[0,0,0] op_sel_hi:[0,1,1]
    v_pk_mul_f32 v[24:25], v[52:53], v[138:139] op_sel:[0,0] op_sel_hi:[0,1]
    v_pk_mul_f32 v[26:27], v[52:53], v[138:139] op_sel:[1,0] op_sel_hi:[1,1]
    v_pk_fma_f32 v[138:139], v[52:53], v[154:155], v[24:25] op_sel:[1,0,0] op_sel_hi:[1,1,1] neg_lo:[1,0,0] neg_hi:[1,0,0]
    v_pk_fma_f32 v[154:155], v[52:53], v[154:155], v[26:27] op_sel:[0,0,0] op_sel_hi:[0,1,1]
    v_pk_mul_f32 v[20:21], v[52:53], v[140:141] op_sel:[0,0] op_sel_hi:[0,1]
    v_pk_mul_f32 v[22:23], v[52:53], v[140:141] op_sel:[1,0] op_sel_hi:[1,1]
    v_pk_fma_f32 v[140:141], v[52:53], v[156:157], v[20:21] op_sel:[1,0,0] op_sel_hi:[1,1,1] neg_lo:[1,0,0] neg_hi:[1,0,0]
    v_pk_fma_f32 v[156:157], v[52:53], v[156:157], v[22:23] op_sel:[0,0,0] op_sel_hi:[0,1,1]
    v_pk_mul_f32 v[24:25], v[52:53], v[142:143] op_sel:[0,0] op_sel_hi:[0,1]
    v_pk_mul_f32 v[26:27], v[52:53], v[142:143] op_sel:[1,0] op_sel_hi:[1,1]
    v_pk_fma_f32 v[142:143], v[52:53], v[158:159], v[24:25] op_sel:[1,0,0] op_sel_hi:[1,1,1] neg_lo:[1,0,0] neg_hi:[1,0,0]
    v_pk_fma_f32 v[158:159], v[52:53], v[158:159], v[26:27] op_sel:[0,0,0] op_sel_hi:[0,1,1]
    v_pk_mul_f32 v[20:21], v[60:61], v[160:161] op_sel:[0,0] op_sel_hi:[0,1]
    v_pk_mul_f32 v[22:23], v[60:61], v[160:161] op_sel:[1,0] op_sel_hi:[1,1]
    v_pk_fma_f32 v[160:161], v[60:61], v[176:177], v[20:21] op_sel:[1,0,0] op_sel_hi:[1,1,1] neg_lo:[1,0,0] neg_hi:[1,0,0]
    v_pk_fma_f32 v[176:177], v[60:61], v[176:177], v[22:23] op_sel:[0,0,0] op_sel_hi:[0,1,1]
    v_pk_mul_f32 v[24:25], v[60:61], v[162:163] op_sel:[0,0] op_sel_hi:[0,1]
    v_pk_mul_f32 v[26:27], v[60:61], v[162:163] op_sel:[1,0] op_sel_hi:[1,1]
    v_pk_fma_f32 v[162:163], v[60:61], v[178:179], v[24:25] op_sel:[1,0,0] op_sel_hi:[1,1,1] neg_lo:[1,0,0] neg_hi:[1,0,0]
    v_pk_fma_f32 v[178:179], v[60:61], v[178:179], v[26:27] op_sel:[0,0,0] op_sel_hi:[0,1,1]
    v_pk_mul_f32 v[20:21], v[60:61], v[164:165] op_sel:[0,0] op_sel_hi:[0,1]
    v_pk_mul_f32 v[22:23], v[60:61], v[164:165] op_sel:[1,0] op_sel_hi:[1,1]
    v_pk_fma_f32 v[164:165], v[60:61], v[180:181], v[20:21] op_sel:[1,0,0] op_sel_hi:[1,1,1] neg_lo:[1,0,0] neg_hi:[1,0,0]
    v_pk_fma_f32 v[180:181], v[60:61], v[180:181], v[22:23] op_sel:[0,0,0] op_sel_hi:[0,1,1]
    v_pk_mul_f32 v[24:25], v[60:61], v[166:167] op_sel:[0,0] op_sel_hi:[0,1]
    v_pk_mul_f32 v[26:27], v[60:61], v[166:167] op_sel:[1,0] op_sel_hi:[1,1]
    v_pk_fma_f32 v[166:167], v[60:61], v[182:183], v[24:25] op_sel:[1,0,0] op_sel_hi:[1,1,1] neg_lo:[1,0,0] neg_hi:[1,0,0]
    v_pk_fma_f32 v[182:183], v[60:61], v[182:183], v[26:27] op_sel:[0,0,0] op_sel_hi:[0,1,1]
    v_pk_mul_f32 v[20:21], v[60:61], v[168:169] op_sel:[0,0] op_sel_hi:[0,1]
    v_pk_mul_f32 v[22:23], v[60:61], v[168:169] op_sel:[1,0] op_sel_hi:[1,1]
    v_pk_fma_f32 v[168:169], v[60:61], v[184:185], v[20:21] op_sel:[1,0,0] op_sel_hi:[1,1,1] neg_lo:[1,0,0] neg_hi:[1,0,0]
    v_pk_fma_f32 v[184:185], v[60:61], v[184:185], v[22:23] op_sel:[0,0,0] op_sel_hi:[0,1,1]
    v_pk_mul_f32 v[24:25], v[60:61], v[170:171] op_sel:[0,0] op_sel_hi:[0,1]
    v_pk_mul_f32 v[26:27], v[60:61], v[170:171] op_sel:[1,0] op_sel_hi:[1,1]
    v_pk_fma_f32 v[170:171], v[60:61], v[186:187], v[24:25] op_sel:[1,0,0] op_sel_hi:[1,1,1] neg_lo:[1,0,0] neg_hi:[1,0,0]
    v_pk_fma_f32 v[186:187], v[60:61], v[186:187], v[26:27] op_sel:[0,0,0] op_sel_hi:[0,1,1]
    v_pk_mul_f32 v[20:21], v[60:61], v[172:173] op_sel:[0,0] op_sel_hi:[0,1]
    v_pk_mul_f32 v[22:23], v[60:61], v[172:173] op_sel:[1,0] op_sel_hi:[1,1]
    v_pk_fma_f32 v[172:173], v[60:61], v[188:189], v[20:21] op_sel:[1,0,0] op_sel_hi:[1,1,1] neg_lo:[1,0,0] neg_hi:[1,0,0]
    v_pk_fma_f32 v[188:189], v[60:61], v[188:189], v[22:23] op_sel:[0,0,0] op_sel_hi:[0,1,1]
    v_pk_mul_f32 v[24:25], v[60:61], v[174:175] op_sel:[0,0] op_sel_hi:[0,1]
    v_pk_mul_f32 v[26:27], v[60:61], v[174:175] op_sel:[1,0] op_sel_hi:[1,1]
    v_pk_fma_f32 v[174:175], v[60:61], v[190:191], v[24:25] op_sel:[1,0,0] op_sel_hi:[1,1,1] neg_lo:[1,0,0] neg_hi:[1,0,0]
    v_pk_fma_f32 v[190:191], v[60:61], v[190:191], v[26:27] op_sel:[0,0,0] op_sel_hi:[0,1,1]
    v_pk_mul_f32 v[20:21], v[68:69], v[192:193] op_sel:[0,0] op_sel_hi:[0,1]
    v_pk_mul_f32 v[22:23], v[68:69], v[192:193] op_sel:[1,0] op_sel_hi:[1,1]
    v_pk_fma_f32 v[192:193], v[68:69], v[208:209], v[20:21] op_sel:[1,0,0] op_sel_hi:[1,1,1] neg_lo:[1,0,0] neg_hi:[1,0,0]
    v_pk_fma_f32 v[208:209], v[68:69], v[208:209], v[22:23] op_sel:[0,0,0] op_sel_hi:[0,1,1]
    v_pk_mul_f32 v[24:25], v[68:69], v[194:195] op_sel:[0,0] op_sel_hi:[0,1]
    v_pk_mul_f32 v[26:27], v[68:69], v[194:195] op_sel:[1,0] op_sel_hi:[1,1]
    v_pk_fma_f32 v[194:195], v[68:69], v[210:211], v[24:25] op_sel:[1,0,0] op_sel_hi:[1,1,1] neg_lo:[1,0,0] neg_hi:[1,0,0]
    v_pk_fma_f32 v[210:211], v[68:69], v[210:211], v[26:27] op_sel:[0,0,0] op_sel_hi:[0,1,1]
    v_pk_mul_f32 v[20:21], v[68:69], v[196:197] op_sel:[0,0] op_sel_hi:[0,1]
    v_pk_mul_f32 v[22:23], v[68:69], v[196:197] op_sel:[1,0] op_sel_hi:[1,1]
    v_pk_fma_f32 v[196:197], v[68:69], v[212:213], v[20:21] op_sel:[1,0,0] op_sel_hi:[1,1,1] neg_lo:[1,0,0] neg_hi:[1,0,0]
    v_pk_fma_f32 v[212:213], v[68:69], v[212:213], v[22:23] op_sel:[0,0,0] op_sel_hi:[0,1,1]
    v_pk_mul_f32 v[24:25], v[68:69], v[198:199] op_sel:[0,0] op_sel_hi:[0,1]
    v_pk_mul_f32 v[26:27], v[68:69], v[198:199] op_sel:[1,0] op_sel_hi:[1,1]
    v_pk_fma_f32 v[198:199], v[68:69], v[214:215], v[24:25] op_sel:[1,0,0] op_sel_hi:[1,1,1] neg_lo:[1,0,0] neg_hi:[1,0,0]
    v_pk_fma_f32 v[214:215], v[68:69], v[214:215], v[26:27] op_sel:[0,0,0] op_sel_hi:[0,1,1]
    v_pk_mul_f32 v[20:21], v[68:69], v[200:201] op_sel:[0,0] op_sel_hi:[0,1]
    v_pk_mul_f32 v[22:23], v[68:69], v[200:201] op_sel:[1,0] op_sel_hi:[1,1]
    v_pk_fma_f32 v[200:201], v[68:69], v[216:217], v[20:21] op_sel:[1,0,0] op_sel_hi:[1,1,1] neg_lo:[1,0,0] neg_hi:[1,0,0]
    v_pk_fma_f32 v[216:217], v[68:69], v[216:217], v[22:23] op_sel:[0,0,0] op_sel_hi:[0,1,1]
    v_pk_mul_f32 v[24:25], v[68:69], v[202:203] op_sel:[0,0] op_sel_hi:[0,1]
    v_pk_mul_f32 v[26:27], v[68:69], v[202:203] op_sel:[1,0] op_sel_hi:[1,1]
    v_pk_fma_f32 v[202:203], v[68:69], v[218:219], v[24:25] op_sel:[1,0,0] op_sel_hi:[1,1,1] neg_lo:[1,0,0] neg_hi:[1,0,0]
    v_pk_fma_f32 v[218:219], v[68:69], v[218:219], v[26:27] op_sel:[0,0,0] op_sel_hi:[0,1,1]
    v_pk_mul_f32 v[20:21], v[68:69], v[204:205] op_sel:[0,0] op_sel_hi:[0,1]
    v_pk_mul_f32 v[22:23], v[68:69], v[204:205] op_sel:[1,0] op_sel_hi:[1,1]
    v_pk_fma_f32 v[204:205], v[68:69], v[220:221], v[20:21] op_sel:[1,0,0] op_sel_hi:[1,1,1] neg_lo:[1,0,0] neg_hi:[1,0,0]
    v_pk_fma_f32 v[220:221], v[68:69], v[220:221], v[22:23] op_sel:[0,0,0] op_sel_hi:[0,1,1]
    v_pk_mul_f32 v[24:25], v[68:69], v[206:207] op_sel:[0,0] op_sel_hi:[0,1]
    v_pk_mul_f32 v[26:27], v[68:69], v[206:207] op_sel:[1,0] op_sel_hi:[1,1]
    v_pk_fma_f32 v[206:207], v[68:69], v[222:223], v[24:25] op_sel:[1,0,0] op_sel_hi:[1,1,1] neg_lo:[1,0,0] neg_hi:[1,0,0]
    v_pk_fma_f32 v[222:223], v[68:69], v[222:223], v[26:27] op_sel:[0,0,0] op_sel_hi:[0,1,1]
    v_mul_f32 v72, v44, v76
    v_mul_f32 v73, v44, v78
    v_fma_f32 v72, -v45, v78, v72
    v_fma_f32 v73, v45, v76, v73
    v_mul_f32 v80, v52, v84
    v_mul_f32 v81, v52, v86
    v_fma_f32 v80, -v53, v86, v80
    v_fma_f32 v81, v53, v84, v81
    v_mul_f32 v88, v60, v92
    v_mul_f32 v89, v60, v94
    v_fma_f32 v88, -v61, v94, v88
    v_fma_f32 v89, v61, v92, v89
    v_mul_f32 v12, v68, v16
    v_mul_f32 v13, v68, v18
    v_fma_f32 v12, -v69, v18, v12
    v_fma_f32 v13, v69, v16, v13
    s_mov_b32 s88, 0x3fb8aa3b
    s_mov_b32 s89, 0x3fb8aa3b
    s_mov_b32 s90, 0x358637bd
    s_mov_b32 s91, 0x358637bd
    v_pk_mul_f32 v[20:21], v[224:225], s[88:89]
    v_exp_f32 v20, v20 clamp
    v_exp_f32 v21, v21 clamp
    v_max_f32 v224, 0, v224
    v_max_f32 v225, 0, v225
    v_pk_add_f32 v[224:225], v[224:225], s[90:91]
    v_pk_add_f32 v[224:225], v[224:225], v[20:21]
    v_pk_mul_f32 v[22:23], v[226:227], s[88:89]
    v_exp_f32 v22, v22 clamp
    v_exp_f32 v23, v23 clamp
    v_max_f32 v226, 0, v226
    v_max_f32 v227, 0, v227
    v_pk_add_f32 v[226:227], v[226:227], s[90:91]
    v_pk_add_f32 v[226:227], v[226:227], v[22:23]
    v_pk_mul_f32 v[20:21], v[240:241], s[88:89]
    v_exp_f32 v20, v20 clamp
    v_exp_f32 v21, v21 clamp
    v_max_f32 v240, 0, v240
    v_max_f32 v241, 0, v241
    v_pk_add_f32 v[240:241], v[240:241], s[90:91]
    v_pk_add_f32 v[240:241], v[240:241], v[20:21]
    v_pk_mul_f32 v[22:23], v[242:243], s[88:89]
    v_exp_f32 v22, v22 clamp
    v_exp_f32 v23, v23 clamp
    v_max_f32 v242, 0, v242
    v_max_f32 v243, 0, v243
    v_pk_add_f32 v[242:243], v[242:243], s[90:91]
    v_pk_add_f32 v[242:243], v[242:243], v[22:23]
    v_pk_mul_f32 v[20:21], v[228:229], s[88:89]
    v_exp_f32 v20, v20 clamp
    v_exp_f32 v21, v21 clamp
    v_max_f32 v228, 0, v228
    v_max_f32 v229, 0, v229
    v_pk_add_f32 v[228:229], v[228:229], s[90:91]
    v_pk_add_f32 v[228:229], v[228:229], v[20:21]
    v_pk_mul_f32 v[22:23], v[230:231], s[88:89]
    v_exp_f32 v22, v22 clamp
    v_exp_f32 v23, v23 clamp
    v_max_f32 v230, 0, v230
    v_max_f32 v231, 0, v231
    v_pk_add_f32 v[230:231], v[230:231], s[90:91]
    v_pk_add_f32 v[230:231], v[230:231], v[22:23]
    v_pk_mul_f32 v[20:21], v[244:245], s[88:89]
    v_exp_f32 v20, v20 clamp
    v_exp_f32 v21, v21 clamp
    v_max_f32 v244, 0, v244
    v_max_f32 v245, 0, v245
    v_pk_add_f32 v[244:245], v[244:245], s[90:91]
    v_pk_add_f32 v[244:245], v[244:245], v[20:21]
    v_pk_mul_f32 v[22:23], v[246:247], s[88:89]
    v_exp_f32 v22, v22 clamp
    v_exp_f32 v23, v23 clamp
    v_max_f32 v246, 0, v246
    v_max_f32 v247, 0, v247
    v_pk_add_f32 v[246:247], v[246:247], s[90:91]
    v_pk_add_f32 v[246:247], v[246:247], v[22:23]
    v_pk_mul_f32 v[20:21], v[232:233], s[88:89]
    v_exp_f32 v20, v20 clamp
    v_exp_f32 v21, v21 clamp
    v_max_f32 v232, 0, v232
    v_max_f32 v233, 0, v233
    v_pk_add_f32 v[232:233], v[232:233], s[90:91]
    v_pk_add_f32 v[232:233], v[232:233], v[20:21]
    v_pk_mul_f32 v[22:23], v[234:235], s[88:89]
    v_exp_f32 v22, v22 clamp
    v_exp_f32 v23, v23 clamp
    v_max_f32 v234, 0, v234
    v_max_f32 v235, 0, v235
    v_pk_add_f32 v[234:235], v[234:235], s[90:91]
    v_pk_add_f32 v[234:235], v[234:235], v[22:23]
    v_pk_mul_f32 v[20:21], v[248:249], s[88:89]
    v_exp_f32 v20, v20 clamp
    v_exp_f32 v21, v21 clamp
    v_max_f32 v248, 0, v248
    v_max_f32 v249, 0, v249
    v_pk_add_f32 v[248:249], v[248:249], s[90:91]
    v_pk_add_f32 v[248:249], v[248:249], v[20:21]
    v_pk_mul_f32 v[22:23], v[250:251], s[88:89]
    v_exp_f32 v22, v22 clamp
    v_exp_f32 v23, v23 clamp
    v_max_f32 v250, 0, v250
    v_max_f32 v251, 0, v251
    v_pk_add_f32 v[250:251], v[250:251], s[90:91]
    v_pk_add_f32 v[250:251], v[250:251], v[22:23]
    v_pk_mul_f32 v[20:21], v[236:237], s[88:89]
    v_exp_f32 v20, v20 clamp
    v_exp_f32 v21, v21 clamp
    v_max_f32 v236, 0, v236
    v_max_f32 v237, 0, v237
    v_pk_add_f32 v[236:237], v[236:237], s[90:91]
    v_pk_add_f32 v[236:237], v[236:237], v[20:21]
    v_pk_mul_f32 v[22:23], v[238:239], s[88:89]
    v_exp_f32 v22, v22 clamp
    v_exp_f32 v23, v23 clamp
    v_max_f32 v238, 0, v238
    v_max_f32 v239, 0, v239
    v_pk_add_f32 v[238:239], v[238:239], s[90:91]
    v_pk_add_f32 v[238:239], v[238:239], v[22:23]
    v_pk_mul_f32 v[20:21], v[252:253], s[88:89]
    v_exp_f32 v20, v20 clamp
    v_exp_f32 v21, v21 clamp
    v_max_f32 v252, 0, v252
    v_max_f32 v253, 0, v253
    v_pk_add_f32 v[252:253], v[252:253], s[90:91]
    v_pk_add_f32 v[252:253], v[252:253], v[20:21]
    v_pk_mul_f32 v[22:23], v[254:255], s[88:89]
    v_exp_f32 v22, v22 clamp
    v_exp_f32 v23, v23 clamp
    v_max_f32 v254, 0, v254
    v_max_f32 v255, 0, v255
    v_pk_add_f32 v[254:255], v[254:255], s[90:91]
    v_pk_add_f32 v[254:255], v[254:255], v[22:23]
    v_cvt_pk_bf16_f32 v224, v224, v225
    v_cvt_pk_bf16_f32 v225, v226, v227
    v_cvt_pk_bf16_f32 v226, v240, v241
    v_cvt_pk_bf16_f32 v227, v242, v243
    v_cvt_pk_bf16_f32 v228, v228, v229
    v_cvt_pk_bf16_f32 v229, v230, v231
    v_cvt_pk_bf16_f32 v230, v244, v245
    v_cvt_pk_bf16_f32 v231, v246, v247
    v_cvt_pk_bf16_f32 v232, v232, v233
    v_cvt_pk_bf16_f32 v233, v234, v235
    v_cvt_pk_bf16_f32 v234, v248, v249
    v_cvt_pk_bf16_f32 v235, v250, v251
    v_cvt_pk_bf16_f32 v236, v236, v237
    v_cvt_pk_bf16_f32 v237, v238, v239
    v_cvt_pk_bf16_f32 v238, v252, v253
    v_cvt_pk_bf16_f32 v239, v254, v255
    s_lshl_b32 s32, s26, 8
    s_lshl_b32 s33, s25, 5
    s_add_u32 s32, s32, s33
    s_lshl_b32 s33, s24, 3
    s_add_u32 s32, s32, s33
    s_lshl_b32 s32, s32, 10
    s_add_u32 s32, s32, 251658240
    s_add_u32 s33, s32, 4194304
    v_bfe_u32 v10, v0, 4, 2
    v_lshlrev_b32 v10, 11, v10
    v_and_b32 v8, 15, v0
    v_lshlrev_b32 v8, 4, v8
    v_add_u32 v10, v10, v8
    s_waitcnt vmcnt(0)
    s_barrier
    ds_read_b64 v[24:25], v11 offset:16384
    ds_read_b64 v[26:27], v9 offset:24576
    ds_read_b64 v[28:29], v11 offset:16512
    ds_read_b64 v[30:31], v9 offset:24704
    ds_read_b64 v[32:33], v11 offset:16640
    ds_read_b64 v[34:35], v9 offset:24832
    ds_read_b64 v[36:37], v11 offset:16768
    ds_read_b64 v[38:39], v9 offset:24960
    s_waitcnt lgkmcnt(6)
    v_fma_f32 v20, v46, v26, v24
    v_fma_f32 v22, v46, v27, v25
    v_fma_f32 v20, -v47, v27, v20
    v_fma_f32 v22, v47, v26, v22
    v_fma_f32 v21, v42, v20, v72
    v_fma_f32 v23, v42, v22, v73
    v_fma_f32 v21, -v43, v22, v21
    v_fma_f32 v23, v43, v20, v23
    v_pk_fma_f32 v[96:97], v[40:41], v[20:21], v[96:97] op_sel:[0,0,0] op_sel_hi:[0,1,1]
    v_pk_fma_f32 v[112:113], v[40:41], v[22:23], v[112:113] op_sel:[0,0,0] op_sel_hi:[0,1,1]
    v_pk_fma_f32 v[96:97], v[40:41], v[22:23], v[96:97] op_sel:[1,0,0] op_sel_hi:[1,1,1] neg_lo:[1,0,0] neg_hi:[1,0,0]
    v_pk_fma_f32 v[112:113], v[40:41], v[20:21], v[112:113] op_sel:[1,0,0] op_sel_hi:[1,1,1]
    v_pk_fma_f32 v[98:99], v[40:41], v[96:97], v[98:99] op_sel:[0,0,0] op_sel_hi:[0,1,1]
    v_pk_fma_f32 v[114:115], v[40:41], v[112:113], v[114:115] op_sel:[0,0,0] op_sel_hi:[0,1,1]
    v_pk_fma_f32 v[98:99], v[40:41], v[112:113], v[98:99] op_sel:[1,0,0] op_sel_hi:[1,1,1] neg_lo:[1,0,0] neg_hi:[1,0,0]
    v_pk_fma_f32 v[114:115], v[40:41], v[96:97], v[114:115] op_sel:[1,0,0] op_sel_hi:[1,1,1]
    v_pk_fma_f32 v[100:101], v[40:41], v[98:99], v[100:101] op_sel:[0,0,0] op_sel_hi:[0,1,1]
    v_pk_fma_f32 v[116:117], v[40:41], v[114:115], v[116:117] op_sel:[0,0,0] op_sel_hi:[0,1,1]
    v_pk_fma_f32 v[100:101], v[40:41], v[114:115], v[100:101] op_sel:[1,0,0] op_sel_hi:[1,1,1] neg_lo:[1,0,0] neg_hi:[1,0,0]
    v_pk_fma_f32 v[116:117], v[40:41], v[98:99], v[116:117] op_sel:[1,0,0] op_sel_hi:[1,1,1]
    v_pk_fma_f32 v[102:103], v[40:41], v[100:101], v[102:103] op_sel:[0,0,0] op_sel_hi:[0,1,1]
    v_pk_fma_f32 v[118:119], v[40:41], v[116:117], v[118:119] op_sel:[0,0,0] op_sel_hi:[0,1,1]
    v_pk_fma_f32 v[102:103], v[40:41], v[116:117], v[102:103] op_sel:[1,0,0] op_sel_hi:[1,1,1] neg_lo:[1,0,0] neg_hi:[1,0,0]
    v_pk_fma_f32 v[118:119], v[40:41], v[100:101], v[118:119] op_sel:[1,0,0] op_sel_hi:[1,1,1]
    v_pk_fma_f32 v[104:105], v[40:41], v[102:103], v[104:105] op_sel:[0,0,0] op_sel_hi:[0,1,1]
    v_pk_fma_f32 v[120:121], v[40:41], v[118:119], v[120:121] op_sel:[0,0,0] op_sel_hi:[0,1,1]
    v_pk_fma_f32 v[104:105], v[40:41], v[118:119], v[104:105] op_sel:[1,0,0] op_sel_hi:[1,1,1] neg_lo:[1,0,0] neg_hi:[1,0,0]
    v_pk_fma_f32 v[120:121], v[40:41], v[102:103], v[120:121] op_sel:[1,0,0] op_sel_hi:[1,1,1]
    v_pk_fma_f32 v[106:107], v[40:41], v[104:105], v[106:107] op_sel:[0,0,0] op_sel_hi:[0,1,1]
    v_pk_fma_f32 v[122:123], v[40:41], v[120:121], v[122:123] op_sel:[0,0,0] op_sel_hi:[0,1,1]
    v_pk_fma_f32 v[106:107], v[40:41], v[120:121], v[106:107] op_sel:[1,0,0] op_sel_hi:[1,1,1] neg_lo:[1,0,0] neg_hi:[1,0,0]
    v_pk_fma_f32 v[122:123], v[40:41], v[104:105], v[122:123] op_sel:[1,0,0] op_sel_hi:[1,1,1]
    v_pk_fma_f32 v[108:109], v[40:41], v[106:107], v[108:109] op_sel:[0,0,0] op_sel_hi:[0,1,1]
    v_pk_fma_f32 v[124:125], v[40:41], v[122:123], v[124:125] op_sel:[0,0,0] op_sel_hi:[0,1,1]
    v_pk_fma_f32 v[108:109], v[40:41], v[122:123], v[108:109] op_sel:[1,0,0] op_sel_hi:[1,1,1] neg_lo:[1,0,0] neg_hi:[1,0,0]
    v_pk_fma_f32 v[124:125], v[40:41], v[106:107], v[124:125] op_sel:[1,0,0] op_sel_hi:[1,1,1]
    v_pk_fma_f32 v[110:111], v[40:41], v[108:109], v[110:111] op_sel:[0,0,0] op_sel_hi:[0,1,1]
    v_pk_fma_f32 v[126:127], v[40:41], v[124:125], v[126:127] op_sel:[0,0,0] op_sel_hi:[0,1,1]
    v_pk_fma_f32 v[110:111], v[40:41], v[124:125], v[110:111] op_sel:[1,0,0] op_sel_hi:[1,1,1] neg_lo:[1,0,0] neg_hi:[1,0,0]
    v_pk_fma_f32 v[126:127], v[40:41], v[108:109], v[126:127] op_sel:[1,0,0] op_sel_hi:[1,1,1]
    v_cvt_pk_bf16_f32 v240, v96, v98
    v_cvt_pk_bf16_f32 v241, v100, v102
    v_cvt_pk_bf16_f32 v242, v104, v106
    v_cvt_pk_bf16_f32 v243, v108, v110
    buffer_store_dwordx4 v[240:243], v10, s[20:23], s32 offen offset:0
    v_cvt_pk_bf16_f32 v244, v97, v99
    v_cvt_pk_bf16_f32 v245, v101, v103
    v_cvt_pk_bf16_f32 v246, v105, v107
    v_cvt_pk_bf16_f32 v247, v109, v111
    buffer_store_dwordx4 v[244:247], v10, s[20:23], s32 offen offset:1024
    v_cvt_pk_bf16_f32 v248, -v112, -v114
    v_cvt_pk_bf16_f32 v249, -v116, -v118
    v_cvt_pk_bf16_f32 v250, -v120, -v122
    v_cvt_pk_bf16_f32 v251, -v124, -v126
    buffer_store_dwordx4 v[248:251], v10, s[20:23], s33 offen offset:0
    v_cvt_pk_bf16_f32 v252, -v113, -v115
    v_cvt_pk_bf16_f32 v253, -v117, -v119
    v_cvt_pk_bf16_f32 v254, -v121, -v123
    v_cvt_pk_bf16_f32 v255, -v125, -v127
    buffer_store_dwordx4 v[252:255], v10, s[20:23], s33 offen offset:1024
    s_waitcnt lgkmcnt(4)
    v_fma_f32 v20, v54, v30, v28
    v_fma_f32 v22, v54, v31, v29
    v_fma_f32 v20, -v55, v31, v20
    v_fma_f32 v22, v55, v30, v22
    v_fma_f32 v21, v50, v20, v80
    v_fma_f32 v23, v50, v22, v81
    v_fma_f32 v21, -v51, v22, v21
    v_fma_f32 v23, v51, v20, v23
    v_pk_fma_f32 v[128:129], v[48:49], v[20:21], v[128:129] op_sel:[0,0,0] op_sel_hi:[0,1,1]
    v_pk_fma_f32 v[144:145], v[48:49], v[22:23], v[144:145] op_sel:[0,0,0] op_sel_hi:[0,1,1]
    v_pk_fma_f32 v[128:129], v[48:49], v[22:23], v[128:129] op_sel:[1,0,0] op_sel_hi:[1,1,1] neg_lo:[1,0,0] neg_hi:[1,0,0]
    v_pk_fma_f32 v[144:145], v[48:49], v[20:21], v[144:145] op_sel:[1,0,0] op_sel_hi:[1,1,1]
    v_pk_fma_f32 v[130:131], v[48:49], v[128:129], v[130:131] op_sel:[0,0,0] op_sel_hi:[0,1,1]
    v_pk_fma_f32 v[146:147], v[48:49], v[144:145], v[146:147] op_sel:[0,0,0] op_sel_hi:[0,1,1]
    v_pk_fma_f32 v[130:131], v[48:49], v[144:145], v[130:131] op_sel:[1,0,0] op_sel_hi:[1,1,1] neg_lo:[1,0,0] neg_hi:[1,0,0]
    v_pk_fma_f32 v[146:147], v[48:49], v[128:129], v[146:147] op_sel:[1,0,0] op_sel_hi:[1,1,1]
    v_pk_fma_f32 v[132:133], v[48:49], v[130:131], v[132:133] op_sel:[0,0,0] op_sel_hi:[0,1,1]
    v_pk_fma_f32 v[148:149], v[48:49], v[146:147], v[148:149] op_sel:[0,0,0] op_sel_hi:[0,1,1]
    v_pk_fma_f32 v[132:133], v[48:49], v[146:147], v[132:133] op_sel:[1,0,0] op_sel_hi:[1,1,1] neg_lo:[1,0,0] neg_hi:[1,0,0]
    v_pk_fma_f32 v[148:149], v[48:49], v[130:131], v[148:149] op_sel:[1,0,0] op_sel_hi:[1,1,1]
    v_pk_fma_f32 v[134:135], v[48:49], v[132:133], v[134:135] op_sel:[0,0,0] op_sel_hi:[0,1,1]
    v_pk_fma_f32 v[150:151], v[48:49], v[148:149], v[150:151] op_sel:[0,0,0] op_sel_hi:[0,1,1]
    v_pk_fma_f32 v[134:135], v[48:49], v[148:149], v[134:135] op_sel:[1,0,0] op_sel_hi:[1,1,1] neg_lo:[1,0,0] neg_hi:[1,0,0]
    v_pk_fma_f32 v[150:151], v[48:49], v[132:133], v[150:151] op_sel:[1,0,0] op_sel_hi:[1,1,1]
    v_pk_fma_f32 v[136:137], v[48:49], v[134:135], v[136:137] op_sel:[0,0,0] op_sel_hi:[0,1,1]
    v_pk_fma_f32 v[152:153], v[48:49], v[150:151], v[152:153] op_sel:[0,0,0] op_sel_hi:[0,1,1]
    v_pk_fma_f32 v[136:137], v[48:49], v[150:151], v[136:137] op_sel:[1,0,0] op_sel_hi:[1,1,1] neg_lo:[1,0,0] neg_hi:[1,0,0]
    v_pk_fma_f32 v[152:153], v[48:49], v[134:135], v[152:153] op_sel:[1,0,0] op_sel_hi:[1,1,1]
    v_pk_fma_f32 v[138:139], v[48:49], v[136:137], v[138:139] op_sel:[0,0,0] op_sel_hi:[0,1,1]
    v_pk_fma_f32 v[154:155], v[48:49], v[152:153], v[154:155] op_sel:[0,0,0] op_sel_hi:[0,1,1]
    v_pk_fma_f32 v[138:139], v[48:49], v[152:153], v[138:139] op_sel:[1,0,0] op_sel_hi:[1,1,1] neg_lo:[1,0,0] neg_hi:[1,0,0]
    v_pk_fma_f32 v[154:155], v[48:49], v[136:137], v[154:155] op_sel:[1,0,0] op_sel_hi:[1,1,1]
    v_pk_fma_f32 v[140:141], v[48:49], v[138:139], v[140:141] op_sel:[0,0,0] op_sel_hi:[0,1,1]
    v_pk_fma_f32 v[156:157], v[48:49], v[154:155], v[156:157] op_sel:[0,0,0] op_sel_hi:[0,1,1]
    v_pk_fma_f32 v[140:141], v[48:49], v[154:155], v[140:141] op_sel:[1,0,0] op_sel_hi:[1,1,1] neg_lo:[1,0,0] neg_hi:[1,0,0]
    v_pk_fma_f32 v[156:157], v[48:49], v[138:139], v[156:157] op_sel:[1,0,0] op_sel_hi:[1,1,1]
    v_pk_fma_f32 v[142:143], v[48:49], v[140:141], v[142:143] op_sel:[0,0,0] op_sel_hi:[0,1,1]
    v_pk_fma_f32 v[158:159], v[48:49], v[156:157], v[158:159] op_sel:[0,0,0] op_sel_hi:[0,1,1]
    v_pk_fma_f32 v[142:143], v[48:49], v[156:157], v[142:143] op_sel:[1,0,0] op_sel_hi:[1,1,1] neg_lo:[1,0,0] neg_hi:[1,0,0]
    v_pk_fma_f32 v[158:159], v[48:49], v[140:141], v[158:159] op_sel:[1,0,0] op_sel_hi:[1,1,1]
    v_cvt_pk_bf16_f32 v240, v128, v130
    v_cvt_pk_bf16_f32 v241, v132, v134
    v_cvt_pk_bf16_f32 v242, v136, v138
    v_cvt_pk_bf16_f32 v243, v140, v142
    buffer_store_dwordx4 v[240:243], v10, s[20:23], s32 offen offset:256
    v_cvt_pk_bf16_f32 v244, v129, v131
    v_cvt_pk_bf16_f32 v245, v133, v135
    v_cvt_pk_bf16_f32 v246, v137, v139
    v_cvt_pk_bf16_f32 v247, v141, v143
    buffer_store_dwordx4 v[244:247], v10, s[20:23], s32 offen offset:1280
    v_cvt_pk_bf16_f32 v248, -v144, -v146
    v_cvt_pk_bf16_f32 v249, -v148, -v150
    v_cvt_pk_bf16_f32 v250, -v152, -v154
    v_cvt_pk_bf16_f32 v251, -v156, -v158
    buffer_store_dwordx4 v[248:251], v10, s[20:23], s33 offen offset:256
    v_cvt_pk_bf16_f32 v252, -v145, -v147
    v_cvt_pk_bf16_f32 v253, -v149, -v151
    v_cvt_pk_bf16_f32 v254, -v153, -v155
    v_cvt_pk_bf16_f32 v255, -v157, -v159
    buffer_store_dwordx4 v[252:255], v10, s[20:23], s33 offen offset:1280
    s_waitcnt lgkmcnt(2)
    v_fma_f32 v20, v62, v34, v32
    v_fma_f32 v22, v62, v35, v33
    v_fma_f32 v20, -v63, v35, v20
    v_fma_f32 v22, v63, v34, v22
    v_fma_f32 v21, v58, v20, v88
    v_fma_f32 v23, v58, v22, v89
    v_fma_f32 v21, -v59, v22, v21
    v_fma_f32 v23, v59, v20, v23
    v_pk_fma_f32 v[160:161], v[56:57], v[20:21], v[160:161] op_sel:[0,0,0] op_sel_hi:[0,1,1]
    v_pk_fma_f32 v[176:177], v[56:57], v[22:23], v[176:177] op_sel:[0,0,0] op_sel_hi:[0,1,1]
    v_pk_fma_f32 v[160:161], v[56:57], v[22:23], v[160:161] op_sel:[1,0,0] op_sel_hi:[1,1,1] neg_lo:[1,0,0] neg_hi:[1,0,0]
    v_pk_fma_f32 v[176:177], v[56:57], v[20:21], v[176:177] op_sel:[1,0,0] op_sel_hi:[1,1,1]
    v_pk_fma_f32 v[162:163], v[56:57], v[160:161], v[162:163] op_sel:[0,0,0] op_sel_hi:[0,1,1]
    v_pk_fma_f32 v[178:179], v[56:57], v[176:177], v[178:179] op_sel:[0,0,0] op_sel_hi:[0,1,1]
    v_pk_fma_f32 v[162:163], v[56:57], v[176:177], v[162:163] op_sel:[1,0,0] op_sel_hi:[1,1,1] neg_lo:[1,0,0] neg_hi:[1,0,0]
    v_pk_fma_f32 v[178:179], v[56:57], v[160:161], v[178:179] op_sel:[1,0,0] op_sel_hi:[1,1,1]
    v_pk_fma_f32 v[164:165], v[56:57], v[162:163], v[164:165] op_sel:[0,0,0] op_sel_hi:[0,1,1]
    v_pk_fma_f32 v[180:181], v[56:57], v[178:179], v[180:181] op_sel:[0,0,0] op_sel_hi:[0,1,1]
    v_pk_fma_f32 v[164:165], v[56:57], v[178:179], v[164:165] op_sel:[1,0,0] op_sel_hi:[1,1,1] neg_lo:[1,0,0] neg_hi:[1,0,0]
    v_pk_fma_f32 v[180:181], v[56:57], v[162:163], v[180:181] op_sel:[1,0,0] op_sel_hi:[1,1,1]
    v_pk_fma_f32 v[166:167], v[56:57], v[164:165], v[166:167] op_sel:[0,0,0] op_sel_hi:[0,1,1]
    v_pk_fma_f32 v[182:183], v[56:57], v[180:181], v[182:183] op_sel:[0,0,0] op_sel_hi:[0,1,1]
    v_pk_fma_f32 v[166:167], v[56:57], v[180:181], v[166:167] op_sel:[1,0,0] op_sel_hi:[1,1,1] neg_lo:[1,0,0] neg_hi:[1,0,0]
    v_pk_fma_f32 v[182:183], v[56:57], v[164:165], v[182:183] op_sel:[1,0,0] op_sel_hi:[1,1,1]
    v_pk_fma_f32 v[168:169], v[56:57], v[166:167], v[168:169] op_sel:[0,0,0] op_sel_hi:[0,1,1]
    v_pk_fma_f32 v[184:185], v[56:57], v[182:183], v[184:185] op_sel:[0,0,0] op_sel_hi:[0,1,1]
    v_pk_fma_f32 v[168:169], v[56:57], v[182:183], v[168:169] op_sel:[1,0,0] op_sel_hi:[1,1,1] neg_lo:[1,0,0] neg_hi:[1,0,0]
    v_pk_fma_f32 v[184:185], v[56:57], v[166:167], v[184:185] op_sel:[1,0,0] op_sel_hi:[1,1,1]
    v_pk_fma_f32 v[170:171], v[56:57], v[168:169], v[170:171] op_sel:[0,0,0] op_sel_hi:[0,1,1]
    v_pk_fma_f32 v[186:187], v[56:57], v[184:185], v[186:187] op_sel:[0,0,0] op_sel_hi:[0,1,1]
    v_pk_fma_f32 v[170:171], v[56:57], v[184:185], v[170:171] op_sel:[1,0,0] op_sel_hi:[1,1,1] neg_lo:[1,0,0] neg_hi:[1,0,0]
    v_pk_fma_f32 v[186:187], v[56:57], v[168:169], v[186:187] op_sel:[1,0,0] op_sel_hi:[1,1,1]
    v_pk_fma_f32 v[172:173], v[56:57], v[170:171], v[172:173] op_sel:[0,0,0] op_sel_hi:[0,1,1]
    v_pk_fma_f32 v[188:189], v[56:57], v[186:187], v[188:189] op_sel:[0,0,0] op_sel_hi:[0,1,1]
    v_pk_fma_f32 v[172:173], v[56:57], v[186:187], v[172:173] op_sel:[1,0,0] op_sel_hi:[1,1,1] neg_lo:[1,0,0] neg_hi:[1,0,0]
    v_pk_fma_f32 v[188:189], v[56:57], v[170:171], v[188:189] op_sel:[1,0,0] op_sel_hi:[1,1,1]
    v_pk_fma_f32 v[174:175], v[56:57], v[172:173], v[174:175] op_sel:[0,0,0] op_sel_hi:[0,1,1]
    v_pk_fma_f32 v[190:191], v[56:57], v[188:189], v[190:191] op_sel:[0,0,0] op_sel_hi:[0,1,1]
    v_pk_fma_f32 v[174:175], v[56:57], v[188:189], v[174:175] op_sel:[1,0,0] op_sel_hi:[1,1,1] neg_lo:[1,0,0] neg_hi:[1,0,0]
    v_pk_fma_f32 v[190:191], v[56:57], v[172:173], v[190:191] op_sel:[1,0,0] op_sel_hi:[1,1,1]
    v_cvt_pk_bf16_f32 v240, v160, v162
    v_cvt_pk_bf16_f32 v241, v164, v166
    v_cvt_pk_bf16_f32 v242, v168, v170
    v_cvt_pk_bf16_f32 v243, v172, v174
    buffer_store_dwordx4 v[240:243], v10, s[20:23], s32 offen offset:512
    v_cvt_pk_bf16_f32 v244, v161, v163
    v_cvt_pk_bf16_f32 v245, v165, v167
    v_cvt_pk_bf16_f32 v246, v169, v171
    v_cvt_pk_bf16_f32 v247, v173, v175
    buffer_store_dwordx4 v[244:247], v10, s[20:23], s32 offen offset:1536
    v_cvt_pk_bf16_f32 v248, -v176, -v178
    v_cvt_pk_bf16_f32 v249, -v180, -v182
    v_cvt_pk_bf16_f32 v250, -v184, -v186
    v_cvt_pk_bf16_f32 v251, -v188, -v190
    buffer_store_dwordx4 v[248:251], v10, s[20:23], s33 offen offset:512
    v_cvt_pk_bf16_f32 v252, -v177, -v179
    v_cvt_pk_bf16_f32 v253, -v181, -v183
    v_cvt_pk_bf16_f32 v254, -v185, -v187
    v_cvt_pk_bf16_f32 v255, -v189, -v191
    buffer_store_dwordx4 v[252:255], v10, s[20:23], s33 offen offset:1536
    s_waitcnt lgkmcnt(0)
    v_fma_f32 v20, v70, v38, v36
    v_fma_f32 v22, v70, v39, v37
    v_fma_f32 v20, -v71, v39, v20
    v_fma_f32 v22, v71, v38, v22
    v_fma_f32 v21, v66, v20, v12
    v_fma_f32 v23, v66, v22, v13
    v_fma_f32 v21, -v67, v22, v21
    v_fma_f32 v23, v67, v20, v23
    v_pk_fma_f32 v[192:193], v[64:65], v[20:21], v[192:193] op_sel:[0,0,0] op_sel_hi:[0,1,1]
    v_pk_fma_f32 v[208:209], v[64:65], v[22:23], v[208:209] op_sel:[0,0,0] op_sel_hi:[0,1,1]
    v_pk_fma_f32 v[192:193], v[64:65], v[22:23], v[192:193] op_sel:[1,0,0] op_sel_hi:[1,1,1] neg_lo:[1,0,0] neg_hi:[1,0,0]
    v_pk_fma_f32 v[208:209], v[64:65], v[20:21], v[208:209] op_sel:[1,0,0] op_sel_hi:[1,1,1]
    v_pk_fma_f32 v[194:195], v[64:65], v[192:193], v[194:195] op_sel:[0,0,0] op_sel_hi:[0,1,1]
    v_pk_fma_f32 v[210:211], v[64:65], v[208:209], v[210:211] op_sel:[0,0,0] op_sel_hi:[0,1,1]
    v_pk_fma_f32 v[194:195], v[64:65], v[208:209], v[194:195] op_sel:[1,0,0] op_sel_hi:[1,1,1] neg_lo:[1,0,0] neg_hi:[1,0,0]
    v_pk_fma_f32 v[210:211], v[64:65], v[192:193], v[210:211] op_sel:[1,0,0] op_sel_hi:[1,1,1]
    v_pk_fma_f32 v[196:197], v[64:65], v[194:195], v[196:197] op_sel:[0,0,0] op_sel_hi:[0,1,1]
    v_pk_fma_f32 v[212:213], v[64:65], v[210:211], v[212:213] op_sel:[0,0,0] op_sel_hi:[0,1,1]
    v_pk_fma_f32 v[196:197], v[64:65], v[210:211], v[196:197] op_sel:[1,0,0] op_sel_hi:[1,1,1] neg_lo:[1,0,0] neg_hi:[1,0,0]
    v_pk_fma_f32 v[212:213], v[64:65], v[194:195], v[212:213] op_sel:[1,0,0] op_sel_hi:[1,1,1]
    v_pk_fma_f32 v[198:199], v[64:65], v[196:197], v[198:199] op_sel:[0,0,0] op_sel_hi:[0,1,1]
    v_pk_fma_f32 v[214:215], v[64:65], v[212:213], v[214:215] op_sel:[0,0,0] op_sel_hi:[0,1,1]
    v_pk_fma_f32 v[198:199], v[64:65], v[212:213], v[198:199] op_sel:[1,0,0] op_sel_hi:[1,1,1] neg_lo:[1,0,0] neg_hi:[1,0,0]
    v_pk_fma_f32 v[214:215], v[64:65], v[196:197], v[214:215] op_sel:[1,0,0] op_sel_hi:[1,1,1]
    v_pk_fma_f32 v[200:201], v[64:65], v[198:199], v[200:201] op_sel:[0,0,0] op_sel_hi:[0,1,1]
    v_pk_fma_f32 v[216:217], v[64:65], v[214:215], v[216:217] op_sel:[0,0,0] op_sel_hi:[0,1,1]
    v_pk_fma_f32 v[200:201], v[64:65], v[214:215], v[200:201] op_sel:[1,0,0] op_sel_hi:[1,1,1] neg_lo:[1,0,0] neg_hi:[1,0,0]
    v_pk_fma_f32 v[216:217], v[64:65], v[198:199], v[216:217] op_sel:[1,0,0] op_sel_hi:[1,1,1]
    v_pk_fma_f32 v[202:203], v[64:65], v[200:201], v[202:203] op_sel:[0,0,0] op_sel_hi:[0,1,1]
    v_pk_fma_f32 v[218:219], v[64:65], v[216:217], v[218:219] op_sel:[0,0,0] op_sel_hi:[0,1,1]
    v_pk_fma_f32 v[202:203], v[64:65], v[216:217], v[202:203] op_sel:[1,0,0] op_sel_hi:[1,1,1] neg_lo:[1,0,0] neg_hi:[1,0,0]
    v_pk_fma_f32 v[218:219], v[64:65], v[200:201], v[218:219] op_sel:[1,0,0] op_sel_hi:[1,1,1]
    v_pk_fma_f32 v[204:205], v[64:65], v[202:203], v[204:205] op_sel:[0,0,0] op_sel_hi:[0,1,1]
    v_pk_fma_f32 v[220:221], v[64:65], v[218:219], v[220:221] op_sel:[0,0,0] op_sel_hi:[0,1,1]
    v_pk_fma_f32 v[204:205], v[64:65], v[218:219], v[204:205] op_sel:[1,0,0] op_sel_hi:[1,1,1] neg_lo:[1,0,0] neg_hi:[1,0,0]
    v_pk_fma_f32 v[220:221], v[64:65], v[202:203], v[220:221] op_sel:[1,0,0] op_sel_hi:[1,1,1]
    v_pk_fma_f32 v[206:207], v[64:65], v[204:205], v[206:207] op_sel:[0,0,0] op_sel_hi:[0,1,1]
    v_pk_fma_f32 v[222:223], v[64:65], v[220:221], v[222:223] op_sel:[0,0,0] op_sel_hi:[0,1,1]
    v_pk_fma_f32 v[206:207], v[64:65], v[220:221], v[206:207] op_sel:[1,0,0] op_sel_hi:[1,1,1] neg_lo:[1,0,0] neg_hi:[1,0,0]
    v_pk_fma_f32 v[222:223], v[64:65], v[204:205], v[222:223] op_sel:[1,0,0] op_sel_hi:[1,1,1]
    v_cvt_pk_bf16_f32 v240, v192, v194
    v_cvt_pk_bf16_f32 v241, v196, v198
    v_cvt_pk_bf16_f32 v242, v200, v202
    v_cvt_pk_bf16_f32 v243, v204, v206
    buffer_store_dwordx4 v[240:243], v10, s[20:23], s32 offen offset:768
    v_cvt_pk_bf16_f32 v244, v193, v195
    v_cvt_pk_bf16_f32 v245, v197, v199
    v_cvt_pk_bf16_f32 v246, v201, v203
    v_cvt_pk_bf16_f32 v247, v205, v207
    buffer_store_dwordx4 v[244:247], v10, s[20:23], s32 offen offset:1792
    v_cvt_pk_bf16_f32 v248, -v208, -v210
    v_cvt_pk_bf16_f32 v249, -v212, -v214
    v_cvt_pk_bf16_f32 v250, -v216, -v218
    v_cvt_pk_bf16_f32 v251, -v220, -v222
    buffer_store_dwordx4 v[248:251], v10, s[20:23], s33 offen offset:768
    v_cvt_pk_bf16_f32 v252, -v209, -v211
    v_cvt_pk_bf16_f32 v253, -v213, -v215
    v_cvt_pk_bf16_f32 v254, -v217, -v219
    v_cvt_pk_bf16_f32 v255, -v221, -v223
    buffer_store_dwordx4 v[252:255], v10, s[20:23], s33 offen offset:1792
    s_waitcnt vmcnt(0)
    s_barrier
    s_load_dwordx2 s[8:9], s[0:1], 40
    s_mov_b32 s10, 2097152
    s_mov_b32 s11, 0x20000
    s_load_dwordx2 s[12:13], s[0:1], 48
    s_mov_b32 s14, 2097152
    s_mov_b32 s15, 0x20000
    s_load_dwordx2 s[16:17], s[0:1], 88
    s_mov_b32 s18, 2097152
    s_mov_b32 s19, 0x20000
    s_load_dwordx2 s[60:61], s[0:1], 104
    s_mov_b32 s62, 8388608
    s_mov_b32 s63, 0x20000
    s_load_dwordx2 s[64:65], s[0:1], 64
    s_mov_b32 s66, 2048
    s_mov_b32 s67, 0x20000
    s_mov_b32 s73, s26
    s_mov_b32 s71, s25
    s_lshl_b32 s72, s26, 1
    s_add_u32 s72, s72, s27
    s_lshr_b32 s32, s31, 4
    s_lshl_b32 s25, s3, 1
    s_add_u32 s25, s25, s32
    s_and_b32 s26, s31, 15
    s_waitcnt lgkmcnt(0)
    s_and_b32 s33, s24, 1
    s_lshl_b32 s33, s33, 5
    s_lshl_b32 s34, s26, 6
    s_add_u32 s33, s33, s34
    v_and_b32 v222, 31, v0
    v_add_u32 v222, s33, v222
    v_lshlrev_b32 v222, 1, v222
    buffer_load_ushort v223, v222, s[64:67], 0 offen
    s_lshr_b32 s32, s24, 1
    s_and_b32 s33, s24, 1
    v_and_b32 v16, 63, v0
    v_lshrrev_b32 v17, 5, v16
    v_bfe_u32 v18, v16, 4, 1
    v_and_b32 v19, 31, v16
    v_bfe_u32 v20, v16, 2, 2
    v_and_b32 v21, 3, v16
    v_lshrrev_b32 v22, 1, v21
    v_lshlrev_b32 v23, 1, v18
    v_add_u32 v22, v22, v23
    v_lshlrev_b32 v23, 3, v17
    v_add_u32 v23, v23, v20
    v_lshlrev_b32 v24, 2, v22
    v_xor_b32 v23, v23, v24
    v_lshlrev_b32 v23, 4, v23
    v_lshlrev_b32 v22, 10, v22
    v_add_u32 v22, v22, v23
    v_and_b32 v23, 1, v21
    v_lshlrev_b32 v23, 3, v23
    v_add_u32 v22, v22, v23
    s_lshl_b32 s34, s32, 13
    v_add_u32 v1, s34, v22
    v_xor_b32 v2, 64, v1
    v_add_u32 v3, 49152, v1
    v_add_u32 v4, 49152, v2
    v_bfe_u32 v22, v16, 1, 3
    v_xor_b32 v22, v22, v17
    v_lshlrev_b32 v22, 4, v22
    v_lshlrev_b32 v23, 7, v19
    v_add_u32 v23, v23, v22
    s_lshl_b32 s35, s33, 12
    s_add_u32 s36, s35, 98304
    v_xor_b32 v22, 0, v23
    v_add_u32 v9, s34, v22
    v_add_u32 v5, s36, v22
    v_xor_b32 v22, 32, v23
    v_add_u32 v10, s34, v22
    v_add_u32 v6, s36, v22
    v_xor_b32 v22, 64, v23
    v_add_u32 v11, s34, v22
    v_add_u32 v7, s36, v22
    v_xor_b32 v22, 96, v23
    v_add_u32 v12, s34, v22
    v_add_u32 v8, s36, v22
    v_lshlrev_b32 v22, 2, v17
    v_add_u32 v22, v22, v20
    v_lshlrev_b32 v22, 7, v22
    s_lshl_b32 s35, s33, 1
    v_add_u32 v23, s35, v18
    v_and_b32 v24, 2, v20
    v_xor_b32 v23, v23, v24
    v_lshlrev_b32 v23, 5, v23
    v_add_u32 v22, v22, v23
    v_lshlrev_b32 v23, 3, v21
    v_add_u32 v22, v22, v23
    v_add_u32 v13, 98304, v22
    s_lshl_b32 s34, s25, 7
    s_lshl_b32 s32, s32, 6
    s_add_u32 s34, s34, s32
    s_lshl_b32 s35, s26, 6
    s_lshl_b32 s33, s33, 5
    s_add_u32 s35, s35, s33
    v_lshlrev_b32 v22, 2, v17
    v_add_u32 v22, s34, v22
    v_add_u32 v23, s35, v19
    v_lshlrev_b32 v22, 12, v22
    v_lshlrev_b32 v23, 2, v23
    v_add_u32 v14, v22, v23
    v_mov_b32 v112, 0
    v_mov_b32 v113, 0
    v_mov_b32 v114, 0
    v_mov_b32 v115, 0
    v_mov_b32 v116, 0
    v_mov_b32 v117, 0
    v_mov_b32 v118, 0
    v_mov_b32 v119, 0
    v_mov_b32 v120, 0
    v_mov_b32 v121, 0
    v_mov_b32 v122, 0
    v_mov_b32 v123, 0
    v_mov_b32 v124, 0
    v_mov_b32 v125, 0
    v_mov_b32 v126, 0
    v_mov_b32 v127, 0
    v_mov_b32 v128, 0
    v_mov_b32 v129, 0
    v_mov_b32 v130, 0
    v_mov_b32 v131, 0
    v_mov_b32 v132, 0
    v_mov_b32 v133, 0
    v_mov_b32 v134, 0
    v_mov_b32 v135, 0
    v_mov_b32 v136, 0
    v_mov_b32 v137, 0
    v_mov_b32 v138, 0
    v_mov_b32 v139, 0
    v_mov_b32 v140, 0
    v_mov_b32 v141, 0
    v_mov_b32 v142, 0
    v_mov_b32 v143, 0
    v_mov_b32 v144, 0
    v_mov_b32 v145, 0
    v_mov_b32 v146, 0
    v_mov_b32 v147, 0
    v_mov_b32 v148, 0
    v_mov_b32 v149, 0
    v_mov_b32 v150, 0
    v_mov_b32 v151, 0
    v_mov_b32 v152, 0
    v_mov_b32 v153, 0
    v_mov_b32 v154, 0
    v_mov_b32 v155, 0
    v_mov_b32 v156, 0
    v_mov_b32 v157, 0
    v_mov_b32 v158, 0
    v_mov_b32 v159, 0
    v_mov_b32 v160, 0
    v_mov_b32 v161, 0
    v_mov_b32 v162, 0
    v_mov_b32 v163, 0
    v_mov_b32 v164, 0
    v_mov_b32 v165, 0
    v_mov_b32 v166, 0
    v_mov_b32 v167, 0
    v_mov_b32 v168, 0
    v_mov_b32 v169, 0
    v_mov_b32 v170, 0
    v_mov_b32 v171, 0
    v_mov_b32 v172, 0
    v_mov_b32 v173, 0
    v_mov_b32 v174, 0
    v_mov_b32 v175, 0
    s_mov_b32 s42, 0
    s_mov_b32 s43, 0
    s_waitcnt vmcnt(0)
    s_branch L_cons2
L_consB:
    v_and_b32 v20, 63, v0
    v_lshrrev_b32 v21, 4, v20
    v_and_b32 v22, 15, v20
    v_bfe_u32 v23, v20, 1, 3
    v_xor_b32 v23, v23, v21
    v_lshlrev_b32 v23, 4, v23
    v_lshlrev_b32 v24, 7, v22
    v_add_u32 v24, v24, v23
    s_lshl_b32 s32, s24, 13
    v_xor_b32 v25, 0, v24
    v_add_u32 v1, s32, v25
    v_xor_b32 v25, 64, v24
    v_add_u32 v2, s32, v25
    v_bfe_u32 v25, v20, 2, 2
    v_lshlrev_b32 v26, 3, v21
    v_add_u32 v26, v26, v25
    v_and_b32 v27, 3, v20
    v_lshlrev_b32 v28, 7, v26
    v_lshrrev_b32 v29, 1, v25
    v_and_b32 v30, 1, v21
    v_lshlrev_b32 v30, 1, v30
    v_or_b32 v29, v29, v30
    v_lshlrev_b32 v29, 5, v29
    v_add_u32 v28, v28, v29
    v_lshlrev_b32 v29, 3, v27
    v_add_u32 v28, v28, v29
    v_xor_b32 v3, 0, v28
    v_xor_b32 v4, 32, v28
    v_xor_b32 v5, 64, v28
    v_xor_b32 v6, 96, v28
    v_lshlrev_b32 v28, 6, v26
    v_and_b32 v30, 1, v21
    v_lshlrev_b32 v30, 5, v30
    v_add_u32 v28, v28, v30
    v_lshlrev_b32 v29, 3, v27
    v_add_u32 v28, v28, v29
    v_xor_b32 v7, 0, v28
    v_xor_b32 v8, 32, v28
    v_mov_b32 v96, 0
    v_mov_b32 v97, 0
    v_mov_b32 v98, 0
    v_mov_b32 v99, 0
    v_mov_b32 v100, 0
    v_mov_b32 v101, 0
    v_mov_b32 v102, 0
    v_mov_b32 v103, 0
    v_mov_b32 v104, 0
    v_mov_b32 v105, 0
    v_mov_b32 v106, 0
    v_mov_b32 v107, 0
    v_mov_b32 v108, 0
    v_mov_b32 v109, 0
    v_mov_b32 v110, 0
    v_mov_b32 v111, 0
    v_mov_b32 v112, 0
    v_mov_b32 v113, 0
    v_mov_b32 v114, 0
    v_mov_b32 v115, 0
    v_mov_b32 v116, 0
    v_mov_b32 v117, 0
    v_mov_b32 v118, 0
    v_mov_b32 v119, 0
    v_mov_b32 v120, 0
    v_mov_b32 v121, 0
    v_mov_b32 v122, 0
    v_mov_b32 v123, 0
    v_mov_b32 v124, 0
    v_mov_b32 v125, 0
    v_mov_b32 v126, 0
    v_mov_b32 v127, 0
    v_mov_b32 v128, 0
    v_mov_b32 v129, 0
    v_mov_b32 v130, 0
    v_mov_b32 v131, 0
    v_mov_b32 v132, 0
    v_mov_b32 v133, 0
    v_mov_b32 v134, 0
    v_mov_b32 v135, 0
    v_mov_b32 v136, 0
    v_mov_b32 v137, 0
    v_mov_b32 v138, 0
    v_mov_b32 v139, 0
    v_mov_b32 v140, 0
    v_mov_b32 v141, 0
    v_mov_b32 v142, 0
    v_mov_b32 v143, 0
    v_mov_b32 v144, 0
    v_mov_b32 v145, 0
    v_mov_b32 v146, 0
    v_mov_b32 v147, 0
    v_mov_b32 v148, 0
    v_mov_b32 v149, 0
    v_mov_b32 v150, 0
    v_mov_b32 v151, 0
    v_mov_b32 v152, 0
    v_mov_b32 v153, 0
    v_mov_b32 v154, 0
    v_mov_b32 v155, 0
    v_mov_b32 v156, 0
    v_mov_b32 v157, 0
    v_mov_b32 v158, 0
    v_mov_b32 v159, 0
    v_mov_b32 v160, 0
    v_mov_b32 v161, 0
    v_mov_b32 v162, 0
    v_mov_b32 v163, 0
    v_mov_b32 v164, 0
    v_mov_b32 v165, 0
    v_mov_b32 v166, 0
    v_mov_b32 v167, 0
    v_mov_b32 v168, 0
    v_mov_b32 v169, 0
    v_mov_b32 v170, 0
    v_mov_b32 v171, 0
    v_mov_b32 v172, 0
    v_mov_b32 v173, 0
    v_mov_b32 v174, 0
    v_mov_b32 v175, 0
    v_mov_b32 v176, 0
    v_mov_b32 v177, 0
    v_mov_b32 v178, 0
    v_mov_b32 v179, 0
    v_mov_b32 v180, 0
    v_mov_b32 v181, 0
    v_mov_b32 v182, 0
    v_mov_b32 v183, 0
    v_mov_b32 v184, 0
    v_mov_b32 v185, 0
    v_mov_b32 v186, 0
    v_mov_b32 v187, 0
    v_mov_b32 v188, 0
    v_mov_b32 v189, 0
    v_mov_b32 v190, 0
    v_mov_b32 v191, 0
    v_mov_b32 v192, 0
    v_mov_b32 v193, 0
    v_mov_b32 v194, 0
    v_mov_b32 v195, 0
    v_mov_b32 v196, 0
    v_mov_b32 v197, 0
    v_mov_b32 v198, 0
    v_mov_b32 v199, 0
    v_mov_b32 v200, 0
    v_mov_b32 v201, 0
    v_mov_b32 v202, 0
    v_mov_b32 v203, 0
    v_mov_b32 v204, 0
    v_mov_b32 v205, 0
    v_mov_b32 v206, 0
    v_mov_b32 v207, 0
    v_mov_b32 v208, 0
    v_mov_b32 v209, 0
    v_mov_b32 v210, 0
    v_mov_b32 v211, 0
    v_mov_b32 v212, 0
    v_mov_b32 v213, 0
    v_mov_b32 v214, 0
    v_mov_b32 v215, 0
    v_mov_b32 v216, 0
    v_mov_b32 v217, 0
    v_mov_b32 v218, 0
    v_mov_b32 v219, 0
    v_mov_b32 v220, 0
    v_mov_b32 v221, 0
    v_mov_b32 v222, 0
    v_mov_b32 v223, 0
    v_mov_b32 v224, 0
    v_mov_b32 v225, 0
    v_mov_b32 v226, 0
    v_mov_b32 v227, 0
    v_mov_b32 v228, 0
    v_mov_b32 v229, 0
    v_mov_b32 v230, 0
    v_mov_b32 v231, 0
    v_mov_b32 v232, 0
    v_mov_b32 v233, 0
    v_mov_b32 v234, 0
    v_mov_b32 v235, 0
    v_mov_b32 v236, 0
    v_mov_b32 v237, 0
    v_mov_b32 v238, 0
    v_mov_b32 v239, 0
    v_mov_b32 v240, 0
    v_mov_b32 v241, 0
    v_mov_b32 v242, 0
    v_mov_b32 v243, 0
    v_mov_b32 v244, 0
    v_mov_b32 v245, 0
    v_mov_b32 v246, 0
    v_mov_b32 v247, 0
    v_mov_b32 v248, 0
    v_mov_b32 v249, 0
    v_mov_b32 v250, 0
    v_mov_b32 v251, 0
    v_mov_b32 v252, 0
    v_mov_b32 v253, 0
    v_mov_b32 v254, 0
    v_mov_b32 v255, 0
    s_mov_b32 s29, 0
    s_waitcnt lgkmcnt(0)
    s_barrier
    ds_read_b64_tr_b16 v[72:73], v3 offset:32768
    ds_read_b64_tr_b16 v[74:75], v3 offset:33280
    ds_read_b128 v[40:43], v1 offset:0
    ds_read_b128 v[56:59], v2 offset:0
    ds_read_b128 v[44:47], v1 offset:2048
    ds_read_b128 v[60:63], v2 offset:2048
    ds_read_b128 v[48:51], v1 offset:4096
    ds_read_b128 v[64:67], v2 offset:4096
    ds_read_b64_tr_b16 v[76:77], v3 offset:36864
    ds_read_b64_tr_b16 v[78:79], v3 offset:37376
    ds_read_b64_tr_b16 v[80:81], v3 offset:40960
    ds_read_b64_tr_b16 v[82:83], v3 offset:41472
    ds_read_b64_tr_b16 v[84:85], v3 offset:45056
    ds_read_b64_tr_b16 v[86:87], v3 offset:45568
    ds_read_b128 v[52:55], v1 offset:6144
    ds_read_b128 v[68:71], v2 offset:6144
    ds_read_b64_tr_b16 v[88:89], v4 offset:32768
    ds_read_b64_tr_b16 v[90:91], v4 offset:33280
    s_mov_b32 s28, 0
L_cloopB:
    s_add_u32 s32, s29, 53248
    s_cmp_eq_u32 s32, 159744
    s_cselect_b32 s32, 0, s32
    s_sub_u32 s30, s32, s29
    s_mov_b32 s29, s32
    s_waitcnt lgkmcnt(15)
    v_mfma_f32_16x16x32_bf16 v[96:99], v[40:43], v[72:75], v[96:99]
    s_waitcnt lgkmcnt(8)
    v_mfma_f32_16x16x32_bf16 v[96:99], v[56:59], v[76:79], v[96:99]
    s_waitcnt lgkmcnt(6)
    v_mfma_f32_16x16x32_bf16 v[112:115], v[40:43], v[80:83], v[112:115]
    s_waitcnt lgkmcnt(4)
    v_mfma_f32_16x16x32_bf16 v[112:115], v[56:59], v[84:87], v[112:115]
    v_mfma_f32_16x16x32_bf16 v[100:103], v[44:47], v[72:75], v[100:103]
    v_mfma_f32_16x16x32_bf16 v[100:103], v[60:63], v[76:79], v[100:103]
    v_mfma_f32_16x16x32_bf16 v[116:119], v[44:47], v[80:83], v[116:119]
    v_mfma_f32_16x16x32_bf16 v[116:119], v[60:63], v[84:87], v[116:119]
    v_mfma_f32_16x16x32_bf16 v[104:107], v[48:51], v[72:75], v[104:107]
    v_mfma_f32_16x16x32_bf16 v[104:107], v[64:67], v[76:79], v[104:107]
    v_mfma_f32_16x16x32_bf16 v[120:123], v[48:51], v[80:83], v[120:123]
    v_mfma_f32_16x16x32_bf16 v[120:123], v[64:67], v[84:87], v[120:123]
    s_waitcnt lgkmcnt(3)
    v_mfma_f32_16x16x32_bf16 v[108:111], v[52:55], v[72:75], v[108:111]
    ds_read_b64_tr_b16 v[72:73], v4 offset:36864
    ds_read_b64_tr_b16 v[74:75], v4 offset:37376
    s_waitcnt lgkmcnt(4)
    v_mfma_f32_16x16x32_bf16 v[108:111], v[68:71], v[76:79], v[108:111]
    ds_read_b64_tr_b16 v[76:77], v4 offset:40960
    v_mfma_f32_16x16x32_bf16 v[124:127], v[52:55], v[80:83], v[124:127]
    ds_read_b64_tr_b16 v[78:79], v4 offset:41472
    v_mfma_f32_16x16x32_bf16 v[124:127], v[68:71], v[84:87], v[124:127]
    ds_read_b64_tr_b16 v[80:81], v4 offset:45056
    s_waitcnt lgkmcnt(5)
    v_mfma_f32_16x16x32_bf16 v[128:131], v[40:43], v[88:91], v[128:131]
    ds_read_b64_tr_b16 v[82:83], v4 offset:45568
    s_waitcnt lgkmcnt(4)
    v_mfma_f32_16x16x32_bf16 v[128:131], v[56:59], v[72:75], v[128:131]
    ds_read_b64_tr_b16 v[84:85], v5 offset:32768
    v_mfma_f32_16x16x32_bf16 v[132:135], v[44:47], v[88:91], v[132:135]
    ds_read_b64_tr_b16 v[86:87], v5 offset:33280
    v_mfma_f32_16x16x32_bf16 v[132:135], v[60:63], v[72:75], v[132:135]
    v_mfma_f32_16x16x32_bf16 v[136:139], v[48:51], v[88:91], v[136:139]
    v_mfma_f32_16x16x32_bf16 v[136:139], v[64:67], v[72:75], v[136:139]
    v_mfma_f32_16x16x32_bf16 v[140:143], v[52:55], v[88:91], v[140:143]
    ds_read_b64_tr_b16 v[88:89], v5 offset:36864
    v_mfma_f32_16x16x32_bf16 v[140:143], v[68:71], v[72:75], v[140:143]
    ds_read_b64_tr_b16 v[90:91], v5 offset:37376
    s_waitcnt lgkmcnt(6)
    v_mfma_f32_16x16x32_bf16 v[144:147], v[40:43], v[76:79], v[144:147]
    ds_read_b64_tr_b16 v[72:73], v5 offset:40960
    s_waitcnt lgkmcnt(5)
    v_mfma_f32_16x16x32_bf16 v[144:147], v[56:59], v[80:83], v[144:147]
    ds_read_b64_tr_b16 v[74:75], v5 offset:41472
    v_mfma_f32_16x16x32_bf16 v[148:151], v[44:47], v[76:79], v[148:151]
    v_mfma_f32_16x16x32_bf16 v[148:151], v[60:63], v[80:83], v[148:151]
    v_mfma_f32_16x16x32_bf16 v[152:155], v[48:51], v[76:79], v[152:155]
    v_mfma_f32_16x16x32_bf16 v[152:155], v[64:67], v[80:83], v[152:155]
    v_mfma_f32_16x16x32_bf16 v[156:159], v[52:55], v[76:79], v[156:159]
    ds_read_b64_tr_b16 v[76:77], v5 offset:45056
    v_mfma_f32_16x16x32_bf16 v[156:159], v[68:71], v[80:83], v[156:159]
    ds_read_b64_tr_b16 v[78:79], v5 offset:45568
    s_waitcnt lgkmcnt(6)
    v_mfma_f32_16x16x32_bf16 v[160:163], v[40:43], v[84:87], v[160:163]
    ds_read_b64_tr_b16 v[80:81], v6 offset:32768
    s_waitcnt lgkmcnt(5)
    v_mfma_f32_16x16x32_bf16 v[160:163], v[56:59], v[88:91], v[160:163]
    ds_read_b64_tr_b16 v[82:83], v6 offset:33280
    v_mfma_f32_16x16x32_bf16 v[164:167], v[44:47], v[84:87], v[164:167]
    v_mfma_f32_16x16x32_bf16 v[164:167], v[60:63], v[88:91], v[164:167]
    v_mfma_f32_16x16x32_bf16 v[168:171], v[48:51], v[84:87], v[168:171]
    v_mfma_f32_16x16x32_bf16 v[168:171], v[64:67], v[88:91], v[168:171]
    v_mfma_f32_16x16x32_bf16 v[172:175], v[52:55], v[84:87], v[172:175]
    ds_read_b64_tr_b16 v[84:85], v6 offset:36864
    v_mfma_f32_16x16x32_bf16 v[172:175], v[68:71], v[88:91], v[172:175]
    ds_read_b64_tr_b16 v[86:87], v6 offset:37376
    s_waitcnt lgkmcnt(6)
    v_mfma_f32_16x16x32_bf16 v[176:179], v[40:43], v[72:75], v[176:179]
    ds_read_b64_tr_b16 v[88:89], v6 offset:40960
    s_waitcnt lgkmcnt(5)
    v_mfma_f32_16x16x32_bf16 v[176:179], v[56:59], v[76:79], v[176:179]
    ds_read_b64_tr_b16 v[90:91], v6 offset:41472
    v_mfma_f32_16x16x32_bf16 v[180:183], v[44:47], v[72:75], v[180:183]
    v_mfma_f32_16x16x32_bf16 v[180:183], v[60:63], v[76:79], v[180:183]
    v_mfma_f32_16x16x32_bf16 v[184:187], v[48:51], v[72:75], v[184:187]
    v_mfma_f32_16x16x32_bf16 v[184:187], v[64:67], v[76:79], v[184:187]
    v_mfma_f32_16x16x32_bf16 v[188:191], v[52:55], v[72:75], v[188:191]
    ds_read_b64_tr_b16 v[72:73], v6 offset:45056
    v_mfma_f32_16x16x32_bf16 v[188:191], v[68:71], v[76:79], v[188:191]
    ds_read_b64_tr_b16 v[74:75], v6 offset:45568
    s_waitcnt lgkmcnt(6)
    v_mfma_f32_16x16x32_bf16 v[192:195], v[40:43], v[80:83], v[192:195]
    ds_read_b64_tr_b16 v[76:77], v7 offset:49152
    s_waitcnt lgkmcnt(5)
    v_mfma_f32_16x16x32_bf16 v[192:195], v[56:59], v[84:87], v[192:195]
    ds_read_b64_tr_b16 v[78:79], v7 offset:49408
    v_mfma_f32_16x16x32_bf16 v[196:199], v[44:47], v[80:83], v[196:199]
    v_mfma_f32_16x16x32_bf16 v[196:199], v[60:63], v[84:87], v[196:199]
    v_mfma_f32_16x16x32_bf16 v[200:203], v[48:51], v[80:83], v[200:203]
    v_mfma_f32_16x16x32_bf16 v[200:203], v[64:67], v[84:87], v[200:203]
    v_mfma_f32_16x16x32_bf16 v[204:207], v[52:55], v[80:83], v[204:207]
    ds_read_b64_tr_b16 v[80:81], v7 offset:51200
    v_mfma_f32_16x16x32_bf16 v[204:207], v[68:71], v[84:87], v[204:207]
    ds_read_b64_tr_b16 v[82:83], v7 offset:51456
    s_waitcnt lgkmcnt(6)
    v_mfma_f32_16x16x32_bf16 v[208:211], v[40:43], v[88:91], v[208:211]
    ds_read_b64_tr_b16 v[84:85], v8 offset:49152
    s_waitcnt lgkmcnt(5)
    v_mfma_f32_16x16x32_bf16 v[208:211], v[56:59], v[72:75], v[208:211]
    ds_read_b64_tr_b16 v[86:87], v8 offset:49408
    v_mfma_f32_16x16x32_bf16 v[212:215], v[44:47], v[88:91], v[212:215]
    v_mfma_f32_16x16x32_bf16 v[212:215], v[60:63], v[72:75], v[212:215]
    v_mfma_f32_16x16x32_bf16 v[216:219], v[48:51], v[88:91], v[216:219]
    v_mfma_f32_16x16x32_bf16 v[216:219], v[64:67], v[72:75], v[216:219]
    v_mfma_f32_16x16x32_bf16 v[220:223], v[52:55], v[88:91], v[220:223]
    ds_read_b64_tr_b16 v[88:89], v8 offset:51200
    ds_read_b64_tr_b16 v[90:91], v8 offset:51456
    v_mfma_f32_16x16x32_bf16 v[220:223], v[68:71], v[72:75], v[220:223]
    v_add_u32 v1, s30, v1
    v_add_u32 v2, s30, v2
    s_waitcnt lgkmcnt(6)
    v_mfma_f32_16x16x32_bf16 v[224:227], v[76:79], v[40:43], v[224:227]
    v_add_u32 v3, s30, v3
    v_add_u32 v4, s30, v4
    s_waitcnt lgkmcnt(4)
    v_mfma_f32_16x16x32_bf16 v[224:227], v[80:83], v[56:59], v[224:227]
    v_add_u32 v5, s30, v5
    v_add_u32 v6, s30, v6
    s_waitcnt lgkmcnt(2)
    v_mfma_f32_16x16x32_bf16 v[240:243], v[84:87], v[40:43], v[240:243]
    v_add_u32 v7, s30, v7
    v_add_u32 v8, s30, v8
    s_waitcnt lgkmcnt(0)
    v_mfma_f32_16x16x32_bf16 v[240:243], v[88:91], v[56:59], v[240:243]
    s_waitcnt lgkmcnt(0)
    s_barrier
    v_mfma_f32_16x16x32_bf16 v[228:231], v[76:79], v[44:47], v[228:231]
    ds_read_b64_tr_b16 v[72:73], v3 offset:32768
    v_mfma_f32_16x16x32_bf16 v[228:231], v[80:83], v[60:63], v[228:231]
    ds_read_b64_tr_b16 v[74:75], v3 offset:33280
    v_mfma_f32_16x16x32_bf16 v[244:247], v[84:87], v[44:47], v[244:247]
    ds_read_b128 v[40:43], v1 offset:0
    v_mfma_f32_16x16x32_bf16 v[244:247], v[88:91], v[60:63], v[244:247]
    ds_read_b128 v[56:59], v2 offset:0
    v_mfma_f32_16x16x32_bf16 v[232:235], v[76:79], v[48:51], v[232:235]
    ds_read_b128 v[44:47], v1 offset:2048
    v_mfma_f32_16x16x32_bf16 v[232:235], v[80:83], v[64:67], v[232:235]
    ds_read_b128 v[60:63], v2 offset:2048
    v_mfma_f32_16x16x32_bf16 v[248:251], v[84:87], v[48:51], v[248:251]
    ds_read_b128 v[48:51], v1 offset:4096
    v_mfma_f32_16x16x32_bf16 v[248:251], v[88:91], v[64:67], v[248:251]
    ds_read_b128 v[64:67], v2 offset:4096
    v_mfma_f32_16x16x32_bf16 v[236:239], v[76:79], v[52:55], v[236:239]
    ds_read_b64_tr_b16 v[76:77], v3 offset:36864
    ds_read_b64_tr_b16 v[78:79], v3 offset:37376
    v_mfma_f32_16x16x32_bf16 v[236:239], v[80:83], v[68:71], v[236:239]
    ds_read_b64_tr_b16 v[80:81], v3 offset:40960
    ds_read_b64_tr_b16 v[82:83], v3 offset:41472
    v_mfma_f32_16x16x32_bf16 v[252:255], v[84:87], v[52:55], v[252:255]
    ds_read_b64_tr_b16 v[84:85], v3 offset:45056
    ds_read_b64_tr_b16 v[86:87], v3 offset:45568
    v_mfma_f32_16x16x32_bf16 v[252:255], v[88:91], v[68:71], v[252:255]
    ds_read_b128 v[52:55], v1 offset:6144
    ds_read_b128 v[68:71], v2 offset:6144
    ds_read_b64_tr_b16 v[88:89], v4 offset:32768
    ds_read_b64_tr_b16 v[90:91], v4 offset:33280
    s_add_u32 s28, s28, 1
    s_cmp_lt_u32 s28, 16
    s_cbranch_scc1 L_cloopB
    s_waitcnt vmcnt(0) lgkmcnt(0)
    s_nop 7
    s_nop 1
    s_mov_b32 s88, 0x3fb8aa3b
    s_mov_b32 s89, 0x3fb8aa3b
    s_mov_b32 s90, 0x358637bd
    s_mov_b32 s91, 0x358637bd
    v_pk_mul_f32 v[10:11], v[96:97], s[88:89]
    v_exp_f32 v10, v10 clamp
    v_exp_f32 v11, v11 clamp
    v_max_f32 v96, 0, v96
    v_max_f32 v97, 0, v97
    v_pk_add_f32 v[96:97], v[96:97], s[90:91]
    v_pk_add_f32 v[96:97], v[96:97], v[10:11]
    v_pk_mul_f32 v[12:13], v[98:99], s[88:89]
    v_exp_f32 v12, v12 clamp
    v_exp_f32 v13, v13 clamp
    v_max_f32 v98, 0, v98
    v_max_f32 v99, 0, v99
    v_pk_add_f32 v[98:99], v[98:99], s[90:91]
    v_pk_add_f32 v[98:99], v[98:99], v[12:13]
    v_pk_mul_f32 v[10:11], v[100:101], s[88:89]
    v_exp_f32 v10, v10 clamp
    v_exp_f32 v11, v11 clamp
    v_max_f32 v100, 0, v100
    v_max_f32 v101, 0, v101
    v_pk_add_f32 v[100:101], v[100:101], s[90:91]
    v_pk_add_f32 v[100:101], v[100:101], v[10:11]
    v_pk_mul_f32 v[12:13], v[102:103], s[88:89]
    v_exp_f32 v12, v12 clamp
    v_exp_f32 v13, v13 clamp
    v_max_f32 v102, 0, v102
    v_max_f32 v103, 0, v103
    v_pk_add_f32 v[102:103], v[102:103], s[90:91]
    v_pk_add_f32 v[102:103], v[102:103], v[12:13]
    v_pk_mul_f32 v[10:11], v[104:105], s[88:89]
    v_exp_f32 v10, v10 clamp
    v_exp_f32 v11, v11 clamp
    v_max_f32 v104, 0, v104
    v_max_f32 v105, 0, v105
    v_pk_add_f32 v[104:105], v[104:105], s[90:91]
    v_pk_add_f32 v[104:105], v[104:105], v[10:11]
    v_pk_mul_f32 v[12:13], v[106:107], s[88:89]
    v_exp_f32 v12, v12 clamp
    v_exp_f32 v13, v13 clamp
    v_max_f32 v106, 0, v106
    v_max_f32 v107, 0, v107
    v_pk_add_f32 v[106:107], v[106:107], s[90:91]
    v_pk_add_f32 v[106:107], v[106:107], v[12:13]
    v_pk_mul_f32 v[10:11], v[108:109], s[88:89]
    v_exp_f32 v10, v10 clamp
    v_exp_f32 v11, v11 clamp
    v_max_f32 v108, 0, v108
    v_max_f32 v109, 0, v109
    v_pk_add_f32 v[108:109], v[108:109], s[90:91]
    v_pk_add_f32 v[108:109], v[108:109], v[10:11]
    v_pk_mul_f32 v[12:13], v[110:111], s[88:89]
    v_exp_f32 v12, v12 clamp
    v_exp_f32 v13, v13 clamp
    v_max_f32 v110, 0, v110
    v_max_f32 v111, 0, v111
    v_pk_add_f32 v[110:111], v[110:111], s[90:91]
    v_pk_add_f32 v[110:111], v[110:111], v[12:13]
    v_pk_mul_f32 v[10:11], v[128:129], s[88:89]
    v_exp_f32 v10, v10 clamp
    v_exp_f32 v11, v11 clamp
    v_max_f32 v128, 0, v128
    v_max_f32 v129, 0, v129
    v_pk_add_f32 v[128:129], v[128:129], s[90:91]
    v_pk_add_f32 v[128:129], v[128:129], v[10:11]
    v_pk_mul_f32 v[12:13], v[130:131], s[88:89]
    v_exp_f32 v12, v12 clamp
    v_exp_f32 v13, v13 clamp
    v_max_f32 v130, 0, v130
    v_max_f32 v131, 0, v131
    v_pk_add_f32 v[130:131], v[130:131], s[90:91]
    v_pk_add_f32 v[130:131], v[130:131], v[12:13]
    v_pk_mul_f32 v[10:11], v[132:133], s[88:89]
    v_exp_f32 v10, v10 clamp
    v_exp_f32 v11, v11 clamp
    v_max_f32 v132, 0, v132
    v_max_f32 v133, 0, v133
    v_pk_add_f32 v[132:133], v[132:133], s[90:91]
    v_pk_add_f32 v[132:133], v[132:133], v[10:11]
    v_pk_mul_f32 v[12:13], v[134:135], s[88:89]
    v_exp_f32 v12, v12 clamp
    v_exp_f32 v13, v13 clamp
    v_max_f32 v134, 0, v134
    v_max_f32 v135, 0, v135
    v_pk_add_f32 v[134:135], v[134:135], s[90:91]
    v_pk_add_f32 v[134:135], v[134:135], v[12:13]
    v_pk_mul_f32 v[10:11], v[136:137], s[88:89]
    v_exp_f32 v10, v10 clamp
    v_exp_f32 v11, v11 clamp
    v_max_f32 v136, 0, v136
    v_max_f32 v137, 0, v137
    v_pk_add_f32 v[136:137], v[136:137], s[90:91]
    v_pk_add_f32 v[136:137], v[136:137], v[10:11]
    v_pk_mul_f32 v[12:13], v[138:139], s[88:89]
    v_exp_f32 v12, v12 clamp
    v_exp_f32 v13, v13 clamp
    v_max_f32 v138, 0, v138
    v_max_f32 v139, 0, v139
    v_pk_add_f32 v[138:139], v[138:139], s[90:91]
    v_pk_add_f32 v[138:139], v[138:139], v[12:13]
    v_pk_mul_f32 v[10:11], v[140:141], s[88:89]
    v_exp_f32 v10, v10 clamp
    v_exp_f32 v11, v11 clamp
    v_max_f32 v140, 0, v140
    v_max_f32 v141, 0, v141
    v_pk_add_f32 v[140:141], v[140:141], s[90:91]
    v_pk_add_f32 v[140:141], v[140:141], v[10:11]
    v_pk_mul_f32 v[12:13], v[142:143], s[88:89]
    v_exp_f32 v12, v12 clamp
    v_exp_f32 v13, v13 clamp
    v_max_f32 v142, 0, v142
    v_max_f32 v143, 0, v143
    v_pk_add_f32 v[142:143], v[142:143], s[90:91]
    v_pk_add_f32 v[142:143], v[142:143], v[12:13]
    v_pk_mul_f32 v[10:11], v[160:161], s[88:89]
    v_exp_f32 v10, v10 clamp
    v_exp_f32 v11, v11 clamp
    v_max_f32 v160, 0, v160
    v_max_f32 v161, 0, v161
    v_pk_add_f32 v[160:161], v[160:161], s[90:91]
    v_pk_add_f32 v[160:161], v[160:161], v[10:11]
    v_pk_mul_f32 v[12:13], v[162:163], s[88:89]
    v_exp_f32 v12, v12 clamp
    v_exp_f32 v13, v13 clamp
    v_max_f32 v162, 0, v162
    v_max_f32 v163, 0, v163
    v_pk_add_f32 v[162:163], v[162:163], s[90:91]
    v_pk_add_f32 v[162:163], v[162:163], v[12:13]
    v_pk_mul_f32 v[10:11], v[164:165], s[88:89]
    v_exp_f32 v10, v10 clamp
    v_exp_f32 v11, v11 clamp
    v_max_f32 v164, 0, v164
    v_max_f32 v165, 0, v165
    v_pk_add_f32 v[164:165], v[164:165], s[90:91]
    v_pk_add_f32 v[164:165], v[164:165], v[10:11]
    v_pk_mul_f32 v[12:13], v[166:167], s[88:89]
    v_exp_f32 v12, v12 clamp
    v_exp_f32 v13, v13 clamp
    v_max_f32 v166, 0, v166
    v_max_f32 v167, 0, v167
    v_pk_add_f32 v[166:167], v[166:167], s[90:91]
    v_pk_add_f32 v[166:167], v[166:167], v[12:13]
    v_pk_mul_f32 v[10:11], v[168:169], s[88:89]
    v_exp_f32 v10, v10 clamp
    v_exp_f32 v11, v11 clamp
    v_max_f32 v168, 0, v168
    v_max_f32 v169, 0, v169
    v_pk_add_f32 v[168:169], v[168:169], s[90:91]
    v_pk_add_f32 v[168:169], v[168:169], v[10:11]
    v_pk_mul_f32 v[12:13], v[170:171], s[88:89]
    v_exp_f32 v12, v12 clamp
    v_exp_f32 v13, v13 clamp
    v_max_f32 v170, 0, v170
    v_max_f32 v171, 0, v171
    v_pk_add_f32 v[170:171], v[170:171], s[90:91]
    v_pk_add_f32 v[170:171], v[170:171], v[12:13]
    v_pk_mul_f32 v[10:11], v[172:173], s[88:89]
    v_exp_f32 v10, v10 clamp
    v_exp_f32 v11, v11 clamp
    v_max_f32 v172, 0, v172
    v_max_f32 v173, 0, v173
    v_pk_add_f32 v[172:173], v[172:173], s[90:91]
    v_pk_add_f32 v[172:173], v[172:173], v[10:11]
    v_pk_mul_f32 v[12:13], v[174:175], s[88:89]
    v_exp_f32 v12, v12 clamp
    v_exp_f32 v13, v13 clamp
    v_max_f32 v174, 0, v174
    v_max_f32 v175, 0, v175
    v_pk_add_f32 v[174:175], v[174:175], s[90:91]
    v_pk_add_f32 v[174:175], v[174:175], v[12:13]
    v_pk_mul_f32 v[10:11], v[192:193], s[88:89]
    v_exp_f32 v10, v10 clamp
    v_exp_f32 v11, v11 clamp
    v_max_f32 v192, 0, v192
    v_max_f32 v193, 0, v193
    v_pk_add_f32 v[192:193], v[192:193], s[90:91]
    v_pk_add_f32 v[192:193], v[192:193], v[10:11]
    v_pk_mul_f32 v[12:13], v[194:195], s[88:89]
    v_exp_f32 v12, v12 clamp
    v_exp_f32 v13, v13 clamp
    v_max_f32 v194, 0, v194
    v_max_f32 v195, 0, v195
    v_pk_add_f32 v[194:195], v[194:195], s[90:91]
    v_pk_add_f32 v[194:195], v[194:195], v[12:13]
    v_pk_mul_f32 v[10:11], v[196:197], s[88:89]
    v_exp_f32 v10, v10 clamp
    v_exp_f32 v11, v11 clamp
    v_max_f32 v196, 0, v196
    v_max_f32 v197, 0, v197
    v_pk_add_f32 v[196:197], v[196:197], s[90:91]
    v_pk_add_f32 v[196:197], v[196:197], v[10:11]
    v_pk_mul_f32 v[12:13], v[198:199], s[88:89]
    v_exp_f32 v12, v12 clamp
    v_exp_f32 v13, v13 clamp
    v_max_f32 v198, 0, v198
    v_max_f32 v199, 0, v199
    v_pk_add_f32 v[198:199], v[198:199], s[90:91]
    v_pk_add_f32 v[198:199], v[198:199], v[12:13]
    v_pk_mul_f32 v[10:11], v[200:201], s[88:89]
    v_exp_f32 v10, v10 clamp
    v_exp_f32 v11, v11 clamp
    v_max_f32 v200, 0, v200
    v_max_f32 v201, 0, v201
    v_pk_add_f32 v[200:201], v[200:201], s[90:91]
    v_pk_add_f32 v[200:201], v[200:201], v[10:11]
    v_pk_mul_f32 v[12:13], v[202:203], s[88:89]
    v_exp_f32 v12, v12 clamp
    v_exp_f32 v13, v13 clamp
    v_max_f32 v202, 0, v202
    v_max_f32 v203, 0, v203
    v_pk_add_f32 v[202:203], v[202:203], s[90:91]
    v_pk_add_f32 v[202:203], v[202:203], v[12:13]
    v_pk_mul_f32 v[10:11], v[204:205], s[88:89]
    v_exp_f32 v10, v10 clamp
    v_exp_f32 v11, v11 clamp
    v_max_f32 v204, 0, v204
    v_max_f32 v205, 0, v205
    v_pk_add_f32 v[204:205], v[204:205], s[90:91]
    v_pk_add_f32 v[204:205], v[204:205], v[10:11]
    v_pk_mul_f32 v[12:13], v[206:207], s[88:89]
    v_exp_f32 v12, v12 clamp
    v_exp_f32 v13, v13 clamp
    v_max_f32 v206, 0, v206
    v_max_f32 v207, 0, v207
    v_pk_add_f32 v[206:207], v[206:207], s[90:91]
    v_pk_add_f32 v[206:207], v[206:207], v[12:13]
    v_cvt_pk_bf16_f32 v96, v96, v97
    v_cvt_pk_bf16_f32 v97, v98, v99
    v_cvt_pk_bf16_f32 v98, v100, v101
    v_cvt_pk_bf16_f32 v99, v102, v103
    v_cvt_pk_bf16_f32 v104, v104, v105
    v_cvt_pk_bf16_f32 v105, v106, v107
    v_cvt_pk_bf16_f32 v106, v108, v109
    v_cvt_pk_bf16_f32 v107, v110, v111
    v_cvt_pk_bf16_f32 v112, v112, v113
    v_cvt_pk_bf16_f32 v113, v114, v115
    v_cvt_pk_bf16_f32 v114, v116, v117
    v_cvt_pk_bf16_f32 v115, v118, v119
    v_cvt_pk_bf16_f32 v120, v120, v121
    v_cvt_pk_bf16_f32 v121, v122, v123
    v_cvt_pk_bf16_f32 v122, v124, v125
    v_cvt_pk_bf16_f32 v123, v126, v127
    v_cvt_pk_bf16_f32 v128, v128, v129
    v_cvt_pk_bf16_f32 v129, v130, v131
    v_cvt_pk_bf16_f32 v130, v132, v133
    v_cvt_pk_bf16_f32 v131, v134, v135
    v_cvt_pk_bf16_f32 v136, v136, v137
    v_cvt_pk_bf16_f32 v137, v138, v139
    v_cvt_pk_bf16_f32 v138, v140, v141
    v_cvt_pk_bf16_f32 v139, v142, v143
    v_cvt_pk_bf16_f32 v144, v144, v145
    v_cvt_pk_bf16_f32 v145, v146, v147
    v_cvt_pk_bf16_f32 v146, v148, v149
    v_cvt_pk_bf16_f32 v147, v150, v151
    v_cvt_pk_bf16_f32 v152, v152, v153
    v_cvt_pk_bf16_f32 v153, v154, v155
    v_cvt_pk_bf16_f32 v154, v156, v157
    v_cvt_pk_bf16_f32 v155, v158, v159
    v_cvt_pk_bf16_f32 v160, v160, v161
    v_cvt_pk_bf16_f32 v161, v162, v163
    v_cvt_pk_bf16_f32 v162, v164, v165
    v_cvt_pk_bf16_f32 v163, v166, v167
    v_cvt_pk_bf16_f32 v168, v168, v169
    v_cvt_pk_bf16_f32 v169, v170, v171
    v_cvt_pk_bf16_f32 v170, v172, v173
    v_cvt_pk_bf16_f32 v171, v174, v175
    v_cvt_pk_bf16_f32 v176, v176, v177
    v_cvt_pk_bf16_f32 v177, v178, v179
    v_cvt_pk_bf16_f32 v178, v180, v181
    v_cvt_pk_bf16_f32 v179, v182, v183
    v_cvt_pk_bf16_f32 v184, v184, v185
    v_cvt_pk_bf16_f32 v185, v186, v187
    v_cvt_pk_bf16_f32 v186, v188, v189
    v_cvt_pk_bf16_f32 v187, v190, v191
    v_cvt_pk_bf16_f32 v192, v192, v193
    v_cvt_pk_bf16_f32 v193, v194, v195
    v_cvt_pk_bf16_f32 v194, v196, v197
    v_cvt_pk_bf16_f32 v195, v198, v199
    v_cvt_pk_bf16_f32 v200, v200, v201
    v_cvt_pk_bf16_f32 v201, v202, v203
    v_cvt_pk_bf16_f32 v202, v204, v205
    v_cvt_pk_bf16_f32 v203, v206, v207
    v_cvt_pk_bf16_f32 v208, v208, v209
    v_cvt_pk_bf16_f32 v209, v210, v211
    v_cvt_pk_bf16_f32 v210, v212, v213
    v_cvt_pk_bf16_f32 v211, v214, v215
    v_cvt_pk_bf16_f32 v216, v216, v217
    v_cvt_pk_bf16_f32 v217, v218, v219
    v_cvt_pk_bf16_f32 v218, v220, v221
    v_cvt_pk_bf16_f32 v219, v222, v223
    v_mov_b32 v88, 0x3f803f80
    v_mov_b32 v89, 0x3f803f80
    v_mov_b32 v90, 0x3f803f80
    v_mov_b32 v91, 0x3f803f80
    v_and_b32 v10, 63, v0
    v_lshlrev_b32 v10, 4, v10
    s_lshl_b32 s32, s24, 13
    v_add_u32 v11, s32, v10
    s_lshl_b32 s32, s24, 12
    v_add_u32 v12, s32, v10
    v_mfma_f32_16x16x32_bf16 v[40:43], v[96:99], v[112:115], 0
    v_mfma_f32_16x16x32_bf16 v[44:47], v[96:99], v[144:147], 0
    v_mfma_f32_16x16x32_bf16 v[72:75], v[96:99], v[88:91], 0
    v_mfma_f32_16x16x32_bf16 v[48:51], v[128:131], v[112:115], 0
    v_mfma_f32_16x16x32_bf16 v[52:55], v[128:131], v[144:147], 0
    v_mfma_f32_16x16x32_bf16 v[76:79], v[128:131], v[88:91], 0
    v_mfma_f32_16x16x32_bf16 v[56:59], v[160:163], v[176:179], 0
    v_mfma_f32_16x16x32_bf16 v[60:63], v[160:163], v[208:211], 0
    v_mfma_f32_16x16x32_bf16 v[80:83], v[160:163], v[88:91], 0
    v_mfma_f32_16x16x32_bf16 v[64:67], v[192:195], v[176:179], 0
    v_mfma_f32_16x16x32_bf16 v[68:71], v[192:195], v[208:211], 0
    v_mfma_f32_16x16x32_bf16 v[84:87], v[192:195], v[88:91], 0
    v_mfma_f32_16x16x32_bf16 v[40:43], v[104:107], v[120:123], v[40:43]
    v_mfma_f32_16x16x32_bf16 v[44:47], v[104:107], v[152:155], v[44:47]
    v_mfma_f32_16x16x32_bf16 v[72:75], v[104:107], v[88:91], v[72:75]
    v_mfma_f32_16x16x32_bf16 v[48:51], v[136:139], v[120:123], v[48:51]
    v_mfma_f32_16x16x32_bf16 v[52:55], v[136:139], v[152:155], v[52:55]
    v_mfma_f32_16x16x32_bf16 v[76:79], v[136:139], v[88:91], v[76:79]
    v_mfma_f32_16x16x32_bf16 v[56:59], v[168:171], v[184:187], v[56:59]
    v_mfma_f32_16x16x32_bf16 v[60:63], v[168:171], v[216:219], v[60:63]
    v_mfma_f32_16x16x32_bf16 v[80:83], v[168:171], v[88:91], v[80:83]
    v_mfma_f32_16x16x32_bf16 v[64:67], v[200:203], v[184:187], v[64:67]
    v_mfma_f32_16x16x32_bf16 v[68:71], v[200:203], v[216:219], v[68:71]
    v_mfma_f32_16x16x32_bf16 v[84:87], v[200:203], v[88:91], v[84:87]
    s_nop 7
    ds_write_b128 v11, v[40:43] offset:0
    ds_write_b128 v11, v[44:47] offset:1024
    ds_write_b128 v11, v[48:51] offset:2048
    ds_write_b128 v11, v[52:55] offset:3072
    ds_write_b128 v11, v[56:59] offset:4096
    ds_write_b128 v11, v[60:63] offset:5120
    ds_write_b128 v11, v[64:67] offset:6144
    ds_write_b128 v11, v[68:71] offset:7168
    ds_write_b128 v12, v[72:75] offset:32768
    ds_write_b128 v12, v[76:79] offset:33792
    ds_write_b128 v12, v[80:83] offset:34816
    ds_write_b128 v12, v[84:87] offset:35840
    s_waitcnt lgkmcnt(0)
    s_barrier
    s_lshl_b32 s32, s25, 8
    s_lshl_b32 s33, s26, 4
    s_add_u32 s32, s32, s33
    s_lshl_b32 s33, s24, 2
    s_add_u32 s32, s32, s33
    s_lshl_b32 s70, s32, 2
    s_lshl_b32 s32, s32, 11
    v_and_b32 v14, 63, v0
    v_lshlrev_b32 v14, 5, v14
    buffer_load_dwordx4 v[176:179], v14, s[4:7], s32 offen
    buffer_load_dwordx4 v[180:183], v14, s[4:7], s32 offen offset:16
    s_add_u32 s32, s32, 2048
    buffer_load_dwordx4 v[184:187], v14, s[4:7], s32 offen
    buffer_load_dwordx4 v[188:191], v14, s[4:7], s32 offen offset:16
    s_add_u32 s32, s32, 2048
    buffer_load_dwordx4 v[192:195], v14, s[4:7], s32 offen
    buffer_load_dwordx4 v[196:199], v14, s[4:7], s32 offen offset:16
    s_add_u32 s32, s32, 2048
    buffer_load_dwordx4 v[200:203], v14, s[4:7], s32 offen
    buffer_load_dwordx4 v[204:207], v14, s[4:7], s32 offen offset:16
    buffer_load_dwordx4 v[208:211], v14, s[84:87], 0 offen
    buffer_load_dwordx4 v[212:215], v14, s[84:87], 0 offen offset:16
    v_pk_mul_f32 v[10:11], v[224:225], s[88:89]
    v_exp_f32 v10, v10 clamp
    v_exp_f32 v11, v11 clamp
    v_max_f32 v224, 0, v224
    v_max_f32 v225, 0, v225
    v_pk_add_f32 v[224:225], v[224:225], s[90:91]
    v_pk_add_f32 v[224:225], v[224:225], v[10:11]
    v_pk_mul_f32 v[12:13], v[226:227], s[88:89]
    v_exp_f32 v12, v12 clamp
    v_exp_f32 v13, v13 clamp
    v_max_f32 v226, 0, v226
    v_max_f32 v227, 0, v227
    v_pk_add_f32 v[226:227], v[226:227], s[90:91]
    v_pk_add_f32 v[226:227], v[226:227], v[12:13]
    v_pk_mul_f32 v[10:11], v[240:241], s[88:89]
    v_exp_f32 v10, v10 clamp
    v_exp_f32 v11, v11 clamp
    v_max_f32 v240, 0, v240
    v_max_f32 v241, 0, v241
    v_pk_add_f32 v[240:241], v[240:241], s[90:91]
    v_pk_add_f32 v[240:241], v[240:241], v[10:11]
    v_pk_mul_f32 v[12:13], v[242:243], s[88:89]
    v_exp_f32 v12, v12 clamp
    v_exp_f32 v13, v13 clamp
    v_max_f32 v242, 0, v242
    v_max_f32 v243, 0, v243
    v_pk_add_f32 v[242:243], v[242:243], s[90:91]
    v_pk_add_f32 v[242:243], v[242:243], v[12:13]
    v_pk_mul_f32 v[10:11], v[228:229], s[88:89]
    v_exp_f32 v10, v10 clamp
    v_exp_f32 v11, v11 clamp
    v_max_f32 v228, 0, v228
    v_max_f32 v229, 0, v229
    v_pk_add_f32 v[228:229], v[228:229], s[90:91]
    v_pk_add_f32 v[228:229], v[228:229], v[10:11]
    v_pk_mul_f32 v[12:13], v[230:231], s[88:89]
    v_exp_f32 v12, v12 clamp
    v_exp_f32 v13, v13 clamp
    v_max_f32 v230, 0, v230
    v_max_f32 v231, 0, v231
    v_pk_add_f32 v[230:231], v[230:231], s[90:91]
    v_pk_add_f32 v[230:231], v[230:231], v[12:13]
    v_pk_mul_f32 v[10:11], v[244:245], s[88:89]
    v_exp_f32 v10, v10 clamp
    v_exp_f32 v11, v11 clamp
    v_max_f32 v244, 0, v244
    v_max_f32 v245, 0, v245
    v_pk_add_f32 v[244:245], v[244:245], s[90:91]
    v_pk_add_f32 v[244:245], v[244:245], v[10:11]
    v_pk_mul_f32 v[12:13], v[246:247], s[88:89]
    v_exp_f32 v12, v12 clamp
    v_exp_f32 v13, v13 clamp
    v_max_f32 v246, 0, v246
    v_max_f32 v247, 0, v247
    v_pk_add_f32 v[246:247], v[246:247], s[90:91]
    v_pk_add_f32 v[246:247], v[246:247], v[12:13]
    v_pk_mul_f32 v[10:11], v[232:233], s[88:89]
    v_exp_f32 v10, v10 clamp
    v_exp_f32 v11, v11 clamp
    v_max_f32 v232, 0, v232
    v_max_f32 v233, 0, v233
    v_pk_add_f32 v[232:233], v[232:233], s[90:91]
    v_pk_add_f32 v[232:233], v[232:233], v[10:11]
    v_pk_mul_f32 v[12:13], v[234:235], s[88:89]
    v_exp_f32 v12, v12 clamp
    v_exp_f32 v13, v13 clamp
    v_max_f32 v234, 0, v234
    v_max_f32 v235, 0, v235
    v_pk_add_f32 v[234:235], v[234:235], s[90:91]
    v_pk_add_f32 v[234:235], v[234:235], v[12:13]
    v_pk_mul_f32 v[10:11], v[248:249], s[88:89]
    v_exp_f32 v10, v10 clamp
    v_exp_f32 v11, v11 clamp
    v_max_f32 v248, 0, v248
    v_max_f32 v249, 0, v249
    v_pk_add_f32 v[248:249], v[248:249], s[90:91]
    v_pk_add_f32 v[248:249], v[248:249], v[10:11]
    v_pk_mul_f32 v[12:13], v[250:251], s[88:89]
    v_exp_f32 v12, v12 clamp
    v_exp_f32 v13, v13 clamp
    v_max_f32 v250, 0, v250
    v_max_f32 v251, 0, v251
    v_pk_add_f32 v[250:251], v[250:251], s[90:91]
    v_pk_add_f32 v[250:251], v[250:251], v[12:13]
    v_pk_mul_f32 v[10:11], v[236:237], s[88:89]
    v_exp_f32 v10, v10 clamp
    v_exp_f32 v11, v11 clamp
    v_max_f32 v236, 0, v236
    v_max_f32 v237, 0, v237
    v_pk_add_f32 v[236:237], v[236:237], s[90:91]
    v_pk_add_f32 v[236:237], v[236:237], v[10:11]
    v_pk_mul_f32 v[12:13], v[238:239], s[88:89]
    v_exp_f32 v12, v12 clamp
    v_exp_f32 v13, v13 clamp
    v_max_f32 v238, 0, v238
    v_max_f32 v239, 0, v239
    v_pk_add_f32 v[238:239], v[238:239], s[90:91]
    v_pk_add_f32 v[238:239], v[238:239], v[12:13]
    v_pk_mul_f32 v[10:11], v[252:253], s[88:89]
    v_exp_f32 v10, v10 clamp
    v_exp_f32 v11, v11 clamp
    v_max_f32 v252, 0, v252
    v_max_f32 v253, 0, v253
    v_pk_add_f32 v[252:253], v[252:253], s[90:91]
    v_pk_add_f32 v[252:253], v[252:253], v[10:11]
    v_pk_mul_f32 v[12:13], v[254:255], s[88:89]
    v_exp_f32 v12, v12 clamp
    v_exp_f32 v13, v13 clamp
    v_max_f32 v254, 0, v254
    v_max_f32 v255, 0, v255
    v_pk_add_f32 v[254:255], v[254:255], s[90:91]
    v_pk_add_f32 v[254:255], v[254:255], v[12:13]
    v_cvt_pk_bf16_f32 v224, v224, v225
    v_cvt_pk_bf16_f32 v225, v226, v227
    v_cvt_pk_bf16_f32 v226, v240, v241
    v_cvt_pk_bf16_f32 v227, v242, v243
    v_cvt_pk_bf16_f32 v228, v228, v229
    v_cvt_pk_bf16_f32 v229, v230, v231
    v_cvt_pk_bf16_f32 v230, v244, v245
    v_cvt_pk_bf16_f32 v231, v246, v247
    v_cvt_pk_bf16_f32 v232, v232, v233
    v_cvt_pk_bf16_f32 v233, v234, v235
    v_cvt_pk_bf16_f32 v234, v248, v249
    v_cvt_pk_bf16_f32 v235, v250, v251
    v_cvt_pk_bf16_f32 v236, v236, v237
    v_cvt_pk_bf16_f32 v237, v238, v239
    v_cvt_pk_bf16_f32 v238, v252, v253
    v_cvt_pk_bf16_f32 v239, v254, v255
    s_barrier
    s_load_dwordx2 s[8:9], s[0:1], 40
    s_mov_b32 s10, 2097152
    s_mov_b32 s11, 0x20000
    s_load_dwordx2 s[12:13], s[0:1], 48
    s_mov_b32 s14, 2097152
    s_mov_b32 s15, 0x20000
    s_load_dwordx2 s[16:17], s[0:1], 88
    s_mov_b32 s18, 2097152
    s_mov_b32 s19, 0x20000
    s_load_dwordx2 s[60:61], s[0:1], 104
    s_mov_b32 s62, 8388608
    s_mov_b32 s63, 0x20000
    s_load_dwordx2 s[64:65], s[0:1], 64
    s_mov_b32 s66, 2048
    s_mov_b32 s67, 0x20000
    s_mov_b32 s73, s26
    s_mov_b32 s71, s25
    s_lshl_b32 s72, s26, 1
    s_add_u32 s72, s72, s27
    s_lshr_b32 s32, s31, 4
    s_lshl_b32 s25, s3, 1
    s_add_u32 s25, s25, s32
    s_and_b32 s26, s31, 15
    s_waitcnt lgkmcnt(0)
    s_and_b32 s33, s24, 1
    s_lshl_b32 s33, s33, 5
    s_lshl_b32 s34, s26, 6
    s_add_u32 s33, s33, s34
    v_and_b32 v222, 31, v0
    v_add_u32 v222, s33, v222
    v_lshlrev_b32 v222, 1, v222
    buffer_load_ushort v223, v222, s[64:67], 0 offen
    s_waitcnt vmcnt(0)
    s_mov_b32 s36, 0xffff0000
    v_mov_b32 v216, 0x3f803f80
    v_mov_b32 v217, 0
    v_lshlrev_b32 v218, 16, v208
    v_and_b32 v219, s36, v208
    v_lshlrev_b32 v220, 16, v176
    v_and_b32 v221, s36, v176
    v_pk_mul_f32 v[220:221], v[220:221], v[218:219]
    v_cvt_pk_bf16_f32 v220, v220, v221
    v_dot2_f32_bf16 v217, v220, v216, v217
    v_lshlrev_b32 v218, 16, v209
    v_and_b32 v219, s36, v209
    v_lshlrev_b32 v220, 16, v177
    v_and_b32 v221, s36, v177
    v_pk_mul_f32 v[220:221], v[220:221], v[218:219]
    v_cvt_pk_bf16_f32 v220, v220, v221
    v_dot2_f32_bf16 v217, v220, v216, v217
    v_lshlrev_b32 v218, 16, v210
    v_and_b32 v219, s36, v210
    v_lshlrev_b32 v220, 16, v178
    v_and_b32 v221, s36, v178
    v_pk_mul_f32 v[220:221], v[220:221], v[218:219]
    v_cvt_pk_bf16_f32 v220, v220, v221
    v_dot2_f32_bf16 v217, v220, v216, v217
    v_lshlrev_b32 v218, 16, v211
    v_and_b32 v219, s36, v211
    v_lshlrev_b32 v220, 16, v179
    v_and_b32 v221, s36, v179
    v_pk_mul_f32 v[220:221], v[220:221], v[218:219]
    v_cvt_pk_bf16_f32 v220, v220, v221
    v_dot2_f32_bf16 v217, v220, v216, v217
    v_lshlrev_b32 v218, 16, v212
    v_and_b32 v219, s36, v212
    v_lshlrev_b32 v220, 16, v180
    v_and_b32 v221, s36, v180
    v_pk_mul_f32 v[220:221], v[220:221], v[218:219]
    v_cvt_pk_bf16_f32 v220, v220, v221
    v_dot2_f32_bf16 v217, v220, v216, v217
    v_lshlrev_b32 v218, 16, v213
    v_and_b32 v219, s36, v213
    v_lshlrev_b32 v220, 16, v181
    v_and_b32 v221, s36, v181
    v_pk_mul_f32 v[220:221], v[220:221], v[218:219]
    v_cvt_pk_bf16_f32 v220, v220, v221
    v_dot2_f32_bf16 v217, v220, v216, v217
    v_lshlrev_b32 v218, 16, v214
    v_and_b32 v219, s36, v214
    v_lshlrev_b32 v220, 16, v182
    v_and_b32 v221, s36, v182
    v_pk_mul_f32 v[220:221], v[220:221], v[218:219]
    v_cvt_pk_bf16_f32 v220, v220, v221
    v_dot2_f32_bf16 v217, v220, v216, v217
    v_lshlrev_b32 v218, 16, v215
    v_and_b32 v219, s36, v215
    v_lshlrev_b32 v220, 16, v183
    v_and_b32 v221, s36, v183
    v_pk_mul_f32 v[220:221], v[220:221], v[218:219]
    v_cvt_pk_bf16_f32 v220, v220, v221
    v_dot2_f32_bf16 v217, v220, v216, v217
    s_nop 2
    v_mov_b32 v176, v217
    s_mov_b32 s36, 0xffff0000
    v_mov_b32 v216, 0x3f803f80
    v_mov_b32 v217, 0
    v_lshlrev_b32 v218, 16, v208
    v_and_b32 v219, s36, v208
    v_lshlrev_b32 v220, 16, v184
    v_and_b32 v221, s36, v184
    v_pk_mul_f32 v[220:221], v[220:221], v[218:219]
    v_cvt_pk_bf16_f32 v220, v220, v221
    v_dot2_f32_bf16 v217, v220, v216, v217
    v_lshlrev_b32 v218, 16, v209
    v_and_b32 v219, s36, v209
    v_lshlrev_b32 v220, 16, v185
    v_and_b32 v221, s36, v185
    v_pk_mul_f32 v[220:221], v[220:221], v[218:219]
    v_cvt_pk_bf16_f32 v220, v220, v221
    v_dot2_f32_bf16 v217, v220, v216, v217
    v_lshlrev_b32 v218, 16, v210
    v_and_b32 v219, s36, v210
    v_lshlrev_b32 v220, 16, v186
    v_and_b32 v221, s36, v186
    v_pk_mul_f32 v[220:221], v[220:221], v[218:219]
    v_cvt_pk_bf16_f32 v220, v220, v221
    v_dot2_f32_bf16 v217, v220, v216, v217
    v_lshlrev_b32 v218, 16, v211
    v_and_b32 v219, s36, v211
    v_lshlrev_b32 v220, 16, v187
    v_and_b32 v221, s36, v187
    v_pk_mul_f32 v[220:221], v[220:221], v[218:219]
    v_cvt_pk_bf16_f32 v220, v220, v221
    v_dot2_f32_bf16 v217, v220, v216, v217
    v_lshlrev_b32 v218, 16, v212
    v_and_b32 v219, s36, v212
    v_lshlrev_b32 v220, 16, v188
    v_and_b32 v221, s36, v188
    v_pk_mul_f32 v[220:221], v[220:221], v[218:219]
    v_cvt_pk_bf16_f32 v220, v220, v221
    v_dot2_f32_bf16 v217, v220, v216, v217
    v_lshlrev_b32 v218, 16, v213
    v_and_b32 v219, s36, v213
    v_lshlrev_b32 v220, 16, v189
    v_and_b32 v221, s36, v189
    v_pk_mul_f32 v[220:221], v[220:221], v[218:219]
    v_cvt_pk_bf16_f32 v220, v220, v221
    v_dot2_f32_bf16 v217, v220, v216, v217
    v_lshlrev_b32 v218, 16, v214
    v_and_b32 v219, s36, v214
    v_lshlrev_b32 v220, 16, v190
    v_and_b32 v221, s36, v190
    v_pk_mul_f32 v[220:221], v[220:221], v[218:219]
    v_cvt_pk_bf16_f32 v220, v220, v221
    v_dot2_f32_bf16 v217, v220, v216, v217
    v_lshlrev_b32 v218, 16, v215
    v_and_b32 v219, s36, v215
    v_lshlrev_b32 v220, 16, v191
    v_and_b32 v221, s36, v191
    v_pk_mul_f32 v[220:221], v[220:221], v[218:219]
    v_cvt_pk_bf16_f32 v220, v220, v221
    v_dot2_f32_bf16 v217, v220, v216, v217
    s_nop 2
    v_mov_b32 v177, v217
    s_mov_b32 s36, 0xffff0000
    v_mov_b32 v216, 0x3f803f80
    v_mov_b32 v217, 0
    v_lshlrev_b32 v218, 16, v208
    v_and_b32 v219, s36, v208
    v_lshlrev_b32 v220, 16, v192
    v_and_b32 v221, s36, v192
    v_pk_mul_f32 v[220:221], v[220:221], v[218:219]
    v_cvt_pk_bf16_f32 v220, v220, v221
    v_dot2_f32_bf16 v217, v220, v216, v217
    v_lshlrev_b32 v218, 16, v209
    v_and_b32 v219, s36, v209
    v_lshlrev_b32 v220, 16, v193
    v_and_b32 v221, s36, v193
    v_pk_mul_f32 v[220:221], v[220:221], v[218:219]
    v_cvt_pk_bf16_f32 v220, v220, v221
    v_dot2_f32_bf16 v217, v220, v216, v217
    v_lshlrev_b32 v218, 16, v210
    v_and_b32 v219, s36, v210
    v_lshlrev_b32 v220, 16, v194
    v_and_b32 v221, s36, v194
    v_pk_mul_f32 v[220:221], v[220:221], v[218:219]
    v_cvt_pk_bf16_f32 v220, v220, v221
    v_dot2_f32_bf16 v217, v220, v216, v217
    v_lshlrev_b32 v218, 16, v211
    v_and_b32 v219, s36, v211
    v_lshlrev_b32 v220, 16, v195
    v_and_b32 v221, s36, v195
    v_pk_mul_f32 v[220:221], v[220:221], v[218:219]
    v_cvt_pk_bf16_f32 v220, v220, v221
    v_dot2_f32_bf16 v217, v220, v216, v217
    v_lshlrev_b32 v218, 16, v212
    v_and_b32 v219, s36, v212
    v_lshlrev_b32 v220, 16, v196
    v_and_b32 v221, s36, v196
    v_pk_mul_f32 v[220:221], v[220:221], v[218:219]
    v_cvt_pk_bf16_f32 v220, v220, v221
    v_dot2_f32_bf16 v217, v220, v216, v217
    v_lshlrev_b32 v218, 16, v213
    v_and_b32 v219, s36, v213
    v_lshlrev_b32 v220, 16, v197
    v_and_b32 v221, s36, v197
    v_pk_mul_f32 v[220:221], v[220:221], v[218:219]
    v_cvt_pk_bf16_f32 v220, v220, v221
    v_dot2_f32_bf16 v217, v220, v216, v217
    v_lshlrev_b32 v218, 16, v214
    v_and_b32 v219, s36, v214
    v_lshlrev_b32 v220, 16, v198
    v_and_b32 v221, s36, v198
    v_pk_mul_f32 v[220:221], v[220:221], v[218:219]
    v_cvt_pk_bf16_f32 v220, v220, v221
    v_dot2_f32_bf16 v217, v220, v216, v217
    v_lshlrev_b32 v218, 16, v215
    v_and_b32 v219, s36, v215
    v_lshlrev_b32 v220, 16, v199
    v_and_b32 v221, s36, v199
    v_pk_mul_f32 v[220:221], v[220:221], v[218:219]
    v_cvt_pk_bf16_f32 v220, v220, v221
    v_dot2_f32_bf16 v217, v220, v216, v217
    s_nop 2
    v_mov_b32 v178, v217
    s_mov_b32 s36, 0xffff0000
    v_mov_b32 v216, 0x3f803f80
    v_mov_b32 v217, 0
    v_lshlrev_b32 v218, 16, v208
    v_and_b32 v219, s36, v208
    v_lshlrev_b32 v220, 16, v200
    v_and_b32 v221, s36, v200
    v_pk_mul_f32 v[220:221], v[220:221], v[218:219]
    v_cvt_pk_bf16_f32 v220, v220, v221
    v_dot2_f32_bf16 v217, v220, v216, v217
    v_lshlrev_b32 v218, 16, v209
    v_and_b32 v219, s36, v209
    v_lshlrev_b32 v220, 16, v201
    v_and_b32 v221, s36, v201
    v_pk_mul_f32 v[220:221], v[220:221], v[218:219]
    v_cvt_pk_bf16_f32 v220, v220, v221
    v_dot2_f32_bf16 v217, v220, v216, v217
    v_lshlrev_b32 v218, 16, v210
    v_and_b32 v219, s36, v210
    v_lshlrev_b32 v220, 16, v202
    v_and_b32 v221, s36, v202
    v_pk_mul_f32 v[220:221], v[220:221], v[218:219]
    v_cvt_pk_bf16_f32 v220, v220, v221
    v_dot2_f32_bf16 v217, v220, v216, v217
    v_lshlrev_b32 v218, 16, v211
    v_and_b32 v219, s36, v211
    v_lshlrev_b32 v220, 16, v203
    v_and_b32 v221, s36, v203
    v_pk_mul_f32 v[220:221], v[220:221], v[218:219]
    v_cvt_pk_bf16_f32 v220, v220, v221
    v_dot2_f32_bf16 v217, v220, v216, v217
    v_lshlrev_b32 v218, 16, v212
    v_and_b32 v219, s36, v212
    v_lshlrev_b32 v220, 16, v204
    v_and_b32 v221, s36, v204
    v_pk_mul_f32 v[220:221], v[220:221], v[218:219]
    v_cvt_pk_bf16_f32 v220, v220, v221
    v_dot2_f32_bf16 v217, v220, v216, v217
    v_lshlrev_b32 v218, 16, v213
    v_and_b32 v219, s36, v213
    v_lshlrev_b32 v220, 16, v205
    v_and_b32 v221, s36, v205
    v_pk_mul_f32 v[220:221], v[220:221], v[218:219]
    v_cvt_pk_bf16_f32 v220, v220, v221
    v_dot2_f32_bf16 v217, v220, v216, v217
    v_lshlrev_b32 v218, 16, v214
    v_and_b32 v219, s36, v214
    v_lshlrev_b32 v220, 16, v206
    v_and_b32 v221, s36, v206
    v_pk_mul_f32 v[220:221], v[220:221], v[218:219]
    v_cvt_pk_bf16_f32 v220, v220, v221
    v_dot2_f32_bf16 v217, v220, v216, v217
    v_lshlrev_b32 v218, 16, v215
    v_and_b32 v219, s36, v215
    v_lshlrev_b32 v220, 16, v207
    v_and_b32 v221, s36, v207
    v_pk_mul_f32 v[220:221], v[220:221], v[218:219]
    v_cvt_pk_bf16_f32 v220, v220, v221
    v_dot2_f32_bf16 v217, v220, v216, v217
    s_nop 2
    v_mov_b32 v179, v217
    v_add_f32_dpp v176, v176, v176 row_shr:1 row_mask:0xf bank_mask:0xf bound_ctrl:0
    v_add_f32_dpp v177, v177, v177 row_shr:1 row_mask:0xf bank_mask:0xf bound_ctrl:0
    v_add_f32_dpp v178, v178, v178 row_shr:1 row_mask:0xf bank_mask:0xf bound_ctrl:0
    v_add_f32_dpp v179, v179, v179 row_shr:1 row_mask:0xf bank_mask:0xf bound_ctrl:0
    v_add_f32_dpp v176, v176, v176 row_shr:2 row_mask:0xf bank_mask:0xf bound_ctrl:0
    v_add_f32_dpp v177, v177, v177 row_shr:2 row_mask:0xf bank_mask:0xf bound_ctrl:0
    v_add_f32_dpp v178, v178, v178 row_shr:2 row_mask:0xf bank_mask:0xf bound_ctrl:0
    v_add_f32_dpp v179, v179, v179 row_shr:2 row_mask:0xf bank_mask:0xf bound_ctrl:0
    v_add_f32_dpp v176, v176, v176 row_shr:4 row_mask:0xf bank_mask:0xf bound_ctrl:0
    v_add_f32_dpp v177, v177, v177 row_shr:4 row_mask:0xf bank_mask:0xf bound_ctrl:0
    v_add_f32_dpp v178, v178, v178 row_shr:4 row_mask:0xf bank_mask:0xf bound_ctrl:0
    v_add_f32_dpp v179, v179, v179 row_shr:4 row_mask:0xf bank_mask:0xf bound_ctrl:0
    v_add_f32_dpp v176, v176, v176 row_shr:8 row_mask:0xf bank_mask:0xf bound_ctrl:0
    v_add_f32_dpp v177, v177, v177 row_shr:8 row_mask:0xf bank_mask:0xf bound_ctrl:0
    v_add_f32_dpp v178, v178, v178 row_shr:8 row_mask:0xf bank_mask:0xf bound_ctrl:0
    v_add_f32_dpp v179, v179, v179 row_shr:8 row_mask:0xf bank_mask:0xf bound_ctrl:0
    v_add_f32_dpp v176, v176, v176 row_bcast:15 row_mask:0xa bank_mask:0xf
    v_add_f32_dpp v177, v177, v177 row_bcast:15 row_mask:0xa bank_mask:0xf
    v_add_f32_dpp v178, v178, v178 row_bcast:15 row_mask:0xa bank_mask:0xf
    v_add_f32_dpp v179, v179, v179 row_bcast:15 row_mask:0xa bank_mask:0xf
    v_add_f32_dpp v176, v176, v176 row_bcast:31 row_mask:0xc bank_mask:0xf
    v_add_f32_dpp v177, v177, v177 row_bcast:31 row_mask:0xc bank_mask:0xf
    v_add_f32_dpp v178, v178, v178 row_bcast:31 row_mask:0xc bank_mask:0xf
    v_add_f32_dpp v179, v179, v179 row_bcast:31 row_mask:0xc bank_mask:0xf
    v_cvt_pk_bf16_f32 v218, v176, v176
    v_lshlrev_b32 v176, 16, v218
    v_mul_f32 v176, 0xbfb8aa3b, v176
    v_exp_f32 v176, v176
    s_nop 0
    v_add_f32 v176, 1.0, v176
    v_rcp_f32 v176, v176
    s_nop 0
    v_cvt_pk_bf16_f32 v218, v176, v176
    v_lshlrev_b32 v176, 16, v218
    v_cvt_pk_bf16_f32 v218, v177, v177
    v_lshlrev_b32 v177, 16, v218
    v_mul_f32 v177, 0xbfb8aa3b, v177
    v_exp_f32 v177, v177
    s_nop 0
    v_add_f32 v177, 1.0, v177
    v_rcp_f32 v177, v177
    s_nop 0
    v_cvt_pk_bf16_f32 v218, v177, v177
    v_lshlrev_b32 v177, 16, v218
    v_cvt_pk_bf16_f32 v218, v178, v178
    v_lshlrev_b32 v178, 16, v218
    v_mul_f32 v178, 0xbfb8aa3b, v178
    v_exp_f32 v178, v178
    s_nop 0
    v_add_f32 v178, 1.0, v178
    v_rcp_f32 v178, v178
    s_nop 0
    v_cvt_pk_bf16_f32 v218, v178, v178
    v_lshlrev_b32 v178, 16, v218
    v_cvt_pk_bf16_f32 v218, v179, v179
    v_lshlrev_b32 v179, 16, v218
    v_mul_f32 v179, 0xbfb8aa3b, v179
    v_exp_f32 v179, v179
    s_nop 0
    v_add_f32 v179, 1.0, v179
    v_rcp_f32 v179, v179
    s_nop 0
    v_cvt_pk_bf16_f32 v218, v179, v179
    v_lshlrev_b32 v179, 16, v218
    v_mov_b32 v218, s70
    s_mov_b32 s37, 266338304
    s_mov_b64 s[74:75], exec
    s_mov_b32 exec_lo, 0
    s_mov_b32 exec_hi, 0x80000000
    buffer_store_dwordx4 v[176:179], v218, s[20:23], s37 offen sc1
    s_mov_b64 exec, s[74:75]
    s_lshr_b32 s32, s24, 1
    s_and_b32 s33, s24, 1
    v_and_b32 v16, 63, v0
    v_lshrrev_b32 v17, 5, v16
    v_bfe_u32 v18, v16, 4, 1
    v_and_b32 v19, 31, v16
    v_bfe_u32 v20, v16, 2, 2
    v_and_b32 v21, 3, v16
    v_lshrrev_b32 v22, 1, v21
    v_lshlrev_b32 v23, 1, v18
    v_add_u32 v22, v22, v23
    v_lshlrev_b32 v23, 3, v17
    v_add_u32 v23, v23, v20
    v_lshlrev_b32 v24, 2, v22
    v_xor_b32 v23, v23, v24
    v_lshlrev_b32 v23, 4, v23
    v_lshlrev_b32 v22, 10, v22
    v_add_u32 v22, v22, v23
    v_and_b32 v23, 1, v21
    v_lshlrev_b32 v23, 3, v23
    v_add_u32 v22, v22, v23
    s_lshl_b32 s34, s32, 13
    v_add_u32 v1, s34, v22
    v_xor_b32 v2, 64, v1
    v_add_u32 v3, 49152, v1
    v_add_u32 v4, 49152, v2
    v_bfe_u32 v22, v16, 1, 3
    v_xor_b32 v22, v22, v17
    v_lshlrev_b32 v22, 4, v22
    v_lshlrev_b32 v23, 7, v19
    v_add_u32 v23, v23, v22
    s_lshl_b32 s35, s33, 12
    s_add_u32 s36, s35, 98304
    v_xor_b32 v22, 0, v23
    v_add_u32 v9, s34, v22
    v_add_u32 v5, s36, v22
    v_xor_b32 v22, 32, v23
    v_add_u32 v10, s34, v22
    v_add_u32 v6, s36, v22
    v_xor_b32 v22, 64, v23
    v_add_u32 v11, s34, v22
    v_add_u32 v7, s36, v22
    v_xor_b32 v22, 96, v23
    v_add_u32 v12, s34, v22
    v_add_u32 v8, s36, v22
    v_lshlrev_b32 v22, 2, v17
    v_add_u32 v22, v22, v20
    v_lshlrev_b32 v22, 7, v22
    s_lshl_b32 s35, s33, 1
    v_add_u32 v23, s35, v18
    v_and_b32 v24, 2, v20
    v_xor_b32 v23, v23, v24
    v_lshlrev_b32 v23, 5, v23
    v_add_u32 v22, v22, v23
    v_lshlrev_b32 v23, 3, v21
    v_add_u32 v22, v22, v23
    v_add_u32 v13, 98304, v22
    s_lshl_b32 s34, s25, 7
    s_lshl_b32 s32, s32, 6
    s_add_u32 s34, s34, s32
    s_lshl_b32 s35, s26, 6
    s_lshl_b32 s33, s33, 5
    s_add_u32 s35, s35, s33
    v_lshlrev_b32 v22, 2, v17
    v_add_u32 v22, s34, v22
    v_add_u32 v23, s35, v19
    v_lshlrev_b32 v22, 12, v22
    v_lshlrev_b32 v23, 2, v23
    v_add_u32 v14, v22, v23
    v_mov_b32 v112, 0
    v_mov_b32 v113, 0
    v_mov_b32 v114, 0
    v_mov_b32 v115, 0
    v_mov_b32 v116, 0
    v_mov_b32 v117, 0
    v_mov_b32 v118, 0
    v_mov_b32 v119, 0
    v_mov_b32 v120, 0
    v_mov_b32 v121, 0
    v_mov_b32 v122, 0
    v_mov_b32 v123, 0
    v_mov_b32 v124, 0
    v_mov_b32 v125, 0
    v_mov_b32 v126, 0
    v_mov_b32 v127, 0
    v_mov_b32 v128, 0
    v_mov_b32 v129, 0
    v_mov_b32 v130, 0
    v_mov_b32 v131, 0
    v_mov_b32 v132, 0
    v_mov_b32 v133, 0
    v_mov_b32 v134, 0
    v_mov_b32 v135, 0
    v_mov_b32 v136, 0
    v_mov_b32 v137, 0
    v_mov_b32 v138, 0
    v_mov_b32 v139, 0
    v_mov_b32 v140, 0
    v_mov_b32 v141, 0
    v_mov_b32 v142, 0
    v_mov_b32 v143, 0
    v_mov_b32 v144, 0
    v_mov_b32 v145, 0
    v_mov_b32 v146, 0
    v_mov_b32 v147, 0
    v_mov_b32 v148, 0
    v_mov_b32 v149, 0
    v_mov_b32 v150, 0
    v_mov_b32 v151, 0
    v_mov_b32 v152, 0
    v_mov_b32 v153, 0
    v_mov_b32 v154, 0
    v_mov_b32 v155, 0
    v_mov_b32 v156, 0
    v_mov_b32 v157, 0
    v_mov_b32 v158, 0
    v_mov_b32 v159, 0
    v_mov_b32 v160, 0
    v_mov_b32 v161, 0
    v_mov_b32 v162, 0
    v_mov_b32 v163, 0
    v_mov_b32 v164, 0
    v_mov_b32 v165, 0
    v_mov_b32 v166, 0
    v_mov_b32 v167, 0
    v_mov_b32 v168, 0
    v_mov_b32 v169, 0
    v_mov_b32 v170, 0
    v_mov_b32 v171, 0
    v_mov_b32 v172, 0
    v_mov_b32 v173, 0
    v_mov_b32 v174, 0
    v_mov_b32 v175, 0
    s_mov_b32 s42, 0
    s_mov_b32 s43, 0
L_cons2:
    v_lshlrev_b32 v223, 16, v223
    v_mul_f32 v223, 0.5, v223
    v_cvt_pk_bf16_f32 v223, v223, v223
    v_and_b32 v223, 0xffff, v223
    v_and_b32 v216, 31, v0
    s_and_b32 s33, s24, 1
    s_lshl_b32 s33, s33, 5
    v_add_u32 v216, s33, v216
    v_and_b32 v217, 1, v216
    v_lshlrev_b32 v217, 4, v217
    v_lshlrev_b32 v223, v217, v223
    v_lshrrev_b32 v217, 4, v216
    v_lshlrev_b32 v217, 2, v217
    v_bfe_u32 v218, v216, 1, 2
    v_add_u32 v217, v217, v218
    v_bfe_u32 v218, v216, 3, 1
    v_bfe_u32 v219, v0, 5, 1
    v_cmp_eq_u32 vcc, v218, v219
    v_mov_b32 v218, 99
    s_nop 0
    v_cndmask_b32 v217, v218, v217, vcc
    v_cmp_eq_u32 vcc, 0, v217
    s_nop 1
    v_cndmask_b32 v240, 0, v223, vcc
    v_cmp_eq_u32 vcc, 1, v217
    s_nop 1
    v_cndmask_b32 v241, 0, v223, vcc
    v_cmp_eq_u32 vcc, 2, v217
    s_nop 1
    v_cndmask_b32 v242, 0, v223, vcc
    v_cmp_eq_u32 vcc, 3, v217
    s_nop 1
    v_cndmask_b32 v243, 0, v223, vcc
    v_cmp_eq_u32 vcc, 4, v217
    s_nop 1
    v_cndmask_b32 v244, 0, v223, vcc
    v_cmp_eq_u32 vcc, 5, v217
    s_nop 1
    v_cndmask_b32 v245, 0, v223, vcc
    v_cmp_eq_u32 vcc, 6, v217
    s_nop 1
    v_cndmask_b32 v246, 0, v223, vcc
    v_cmp_eq_u32 vcc, 7, v217
    s_nop 1
    v_cndmask_b32 v247, 0, v223, vcc
    v_cmp_eq_u32 vcc, 8, v217
    s_nop 1
    v_cndmask_b32 v248, 0, v223, vcc
    v_cmp_eq_u32 vcc, 9, v217
    s_nop 1
    v_cndmask_b32 v249, 0, v223, vcc
    v_cmp_eq_u32 vcc, 10, v217
    s_nop 1
    v_cndmask_b32 v250, 0, v223, vcc
    v_cmp_eq_u32 vcc, 11, v217
    s_nop 1
    v_cndmask_b32 v251, 0, v223, vcc
    v_cmp_eq_u32 vcc, 12, v217
    s_nop 1
    v_cndmask_b32 v252, 0, v223, vcc
    v_cmp_eq_u32 vcc, 13, v217
    s_nop 1
    v_cndmask_b32 v253, 0, v223, vcc
    v_cmp_eq_u32 vcc, 14, v217
    s_nop 1
    v_cndmask_b32 v254, 0, v223, vcc
    v_cmp_eq_u32 vcc, 15, v217
    s_nop 1
    v_cndmask_b32 v255, 0, v223, vcc
    s_barrier
    ds_read_b64_tr_b16 v[16:17], v1 offset:0
    ds_read_b64_tr_b16 v[18:19], v2 offset:0
    ds_read_b128 v[48:51], v5 offset:0
    ds_read_b64_tr_b16 v[20:21], v1 offset:4096
    ds_read_b64_tr_b16 v[22:23], v2 offset:4096
    ds_read_b64_tr_b16 v[24:25], v1 offset:256
    ds_read_b64_tr_b16 v[26:27], v2 offset:256
    ds_read_b128 v[52:55], v6 offset:0
    ds_read_b64_tr_b16 v[28:29], v1 offset:4352
    ds_read_b64_tr_b16 v[30:31], v2 offset:4352
    ds_read_b64_tr_b16 v[32:33], v1 offset:512
    ds_read_b64_tr_b16 v[34:35], v2 offset:512
    ds_read_b128 v[56:59], v7 offset:0
    ds_read_b64_tr_b16 v[36:37], v1 offset:4608
    ds_read_b64_tr_b16 v[38:39], v2 offset:4608
    ds_read_b64_tr_b16 v[40:41], v1 offset:768
    ds_read_b64_tr_b16 v[42:43], v2 offset:768
    ds_read_b128 v[60:63], v8 offset:0
    ds_read_b64_tr_b16 v[44:45], v1 offset:4864
    ds_read_b64_tr_b16 v[46:47], v2 offset:4864
    s_mov_b32 s28, 0
L_c2_h:
    s_cmp_eq_u32 s28, 1
    s_cbranch_scc1 L_c2_hk6
    s_cmp_eq_u32 s28, 2
    s_cbranch_scc1 L_c2_hk12
L_c2_hr0:
    s_waitcnt lgkmcnt(15)
    v_mfma_f32_32x32x16_bf16 v[112:127], v[16:19], v[48:51], v[112:127]
    ds_read_b64_tr_b16 v[64:65], v1 offset:16384
    ds_read_b64_tr_b16 v[66:67], v2 offset:16384
    ds_read_b128 v[96:99], v5 offset:8192
    s_waitcnt lgkmcnt(15)
    v_mfma_f32_32x32x16_bf16 v[128:143], v[20:23], v[48:51], v[128:143]
    ds_read_b64_tr_b16 v[68:69], v1 offset:20480
    ds_read_b64_tr_b16 v[70:71], v2 offset:20480
    ds_read_b64_tr_b16 v[72:73], v1 offset:16640
    s_waitcnt lgkmcnt(15)
    v_mfma_f32_32x32x16_bf16 v[112:127], v[24:27], v[52:55], v[112:127]
    ds_read_b64_tr_b16 v[74:75], v2 offset:16640
    ds_read_b128 v[100:103], v6 offset:8192
    ds_read_b64_tr_b16 v[76:77], v1 offset:20736
    s_waitcnt lgkmcnt(15)
    v_mfma_f32_32x32x16_bf16 v[128:143], v[28:31], v[52:55], v[128:143]
    ds_read_b64_tr_b16 v[78:79], v2 offset:20736
    ds_read_b64_tr_b16 v[80:81], v1 offset:16896
    ds_read_b64_tr_b16 v[82:83], v2 offset:16896
    s_waitcnt lgkmcnt(15)
    v_mfma_f32_32x32x16_bf16 v[112:127], v[32:35], v[56:59], v[112:127]
    ds_read_b128 v[104:107], v7 offset:8192
    ds_read_b64_tr_b16 v[84:85], v1 offset:20992
    ds_read_b64_tr_b16 v[86:87], v2 offset:20992
    s_waitcnt lgkmcnt(15)
    v_mfma_f32_32x32x16_bf16 v[128:143], v[36:39], v[56:59], v[128:143]
    ds_read_b64_tr_b16 v[88:89], v1 offset:17152
    ds_read_b64_tr_b16 v[90:91], v2 offset:17152
    ds_read_b128 v[108:111], v8 offset:8192
    s_waitcnt lgkmcnt(15)
    v_mfma_f32_32x32x16_bf16 v[112:127], v[40:43], v[60:63], v[112:127]
    ds_read_b64_tr_b16 v[92:93], v1 offset:21248
    ds_read_b64_tr_b16 v[94:95], v2 offset:21248
    s_waitcnt lgkmcnt(15)
    v_mfma_f32_32x32x16_bf16 v[128:143], v[44:47], v[60:63], v[128:143]
    s_cmp_eq_u32 s28, 2
    s_cbranch_scc1 L_c2_hk13
L_c2_hr1:
    s_waitcnt lgkmcnt(15)
    v_mfma_f32_32x32x16_bf16 v[112:127], v[64:67], v[96:99], v[112:127]
    s_waitcnt lgkmcnt(15)
    v_mfma_f32_32x32x16_bf16 v[128:143], v[68:71], v[96:99], v[128:143]
    s_waitcnt lgkmcnt(0)
    s_barrier
    ds_read_b64_tr_b16 v[16:17], v1 offset:32768
    ds_read_b64_tr_b16 v[18:19], v2 offset:32768
    ds_read_b128 v[48:51], v5 offset:16384
    v_mfma_f32_32x32x16_bf16 v[112:127], v[72:75], v[100:103], v[112:127]
    ds_read_b64_tr_b16 v[20:21], v1 offset:36864
    ds_read_b64_tr_b16 v[22:23], v2 offset:36864
    ds_read_b64_tr_b16 v[24:25], v1 offset:33024
    v_mfma_f32_32x32x16_bf16 v[128:143], v[76:79], v[100:103], v[128:143]
    ds_read_b64_tr_b16 v[26:27], v2 offset:33024
    ds_read_b128 v[52:55], v6 offset:16384
    ds_read_b64_tr_b16 v[28:29], v1 offset:37120
    v_mfma_f32_32x32x16_bf16 v[112:127], v[80:83], v[104:107], v[112:127]
    ds_read_b64_tr_b16 v[30:31], v2 offset:37120
    ds_read_b64_tr_b16 v[32:33], v1 offset:33280
    ds_read_b64_tr_b16 v[34:35], v2 offset:33280
    v_mfma_f32_32x32x16_bf16 v[128:143], v[84:87], v[104:107], v[128:143]
    ds_read_b128 v[56:59], v7 offset:16384
    ds_read_b64_tr_b16 v[36:37], v1 offset:37376
    ds_read_b64_tr_b16 v[38:39], v2 offset:37376
    v_mfma_f32_32x32x16_bf16 v[112:127], v[88:91], v[108:111], v[112:127]
    ds_read_b64_tr_b16 v[40:41], v1 offset:33536
    ds_read_b64_tr_b16 v[42:43], v2 offset:33536
    ds_read_b128 v[60:63], v8 offset:16384
    v_mfma_f32_32x32x16_bf16 v[128:143], v[92:95], v[108:111], v[128:143]
    ds_read_b64_tr_b16 v[44:45], v1 offset:37632
    ds_read_b64_tr_b16 v[46:47], v2 offset:37632
    s_cmp_eq_u32 s28, 1
    s_cbranch_scc1 L_c2_hk8
L_c2_hr2:
    s_waitcnt lgkmcnt(15)
    v_mfma_f32_32x32x16_bf16 v[112:127], v[16:19], v[48:51], v[112:127]
    ds_read_b64_tr_b16 v[64:65], v3 offset:0
    ds_read_b64_tr_b16 v[66:67], v4 offset:0
    ds_read_b128 v[96:99], v5 offset:24576
    s_waitcnt lgkmcnt(15)
    v_mfma_f32_32x32x16_bf16 v[128:143], v[20:23], v[48:51], v[128:143]
    ds_read_b64_tr_b16 v[68:69], v3 offset:4096
    ds_read_b64_tr_b16 v[70:71], v4 offset:4096
    ds_read_b64_tr_b16 v[72:73], v3 offset:256
    s_waitcnt lgkmcnt(15)
    v_mfma_f32_32x32x16_bf16 v[112:127], v[24:27], v[52:55], v[112:127]
    ds_read_b64_tr_b16 v[74:75], v4 offset:256
    ds_read_b128 v[100:103], v6 offset:24576
    ds_read_b64_tr_b16 v[76:77], v3 offset:4352
    s_waitcnt lgkmcnt(15)
    v_mfma_f32_32x32x16_bf16 v[128:143], v[28:31], v[52:55], v[128:143]
    ds_read_b64_tr_b16 v[78:79], v4 offset:4352
    ds_read_b64_tr_b16 v[80:81], v3 offset:512
    ds_read_b64_tr_b16 v[82:83], v4 offset:512
    s_waitcnt lgkmcnt(15)
    v_mfma_f32_32x32x16_bf16 v[112:127], v[32:35], v[56:59], v[112:127]
    ds_read_b128 v[104:107], v7 offset:24576
    ds_read_b64_tr_b16 v[84:85], v3 offset:4608
    ds_read_b64_tr_b16 v[86:87], v4 offset:4608
    s_waitcnt lgkmcnt(15)
    v_mfma_f32_32x32x16_bf16 v[128:143], v[36:39], v[56:59], v[128:143]
    ds_read_b64_tr_b16 v[88:89], v3 offset:768
    ds_read_b64_tr_b16 v[90:91], v4 offset:768
    ds_read_b128 v[108:111], v8 offset:24576
    s_waitcnt lgkmcnt(15)
    v_mfma_f32_32x32x16_bf16 v[112:127], v[40:43], v[60:63], v[112:127]
    ds_read_b64_tr_b16 v[92:93], v3 offset:4864
    ds_read_b64_tr_b16 v[94:95], v4 offset:4864
    s_waitcnt lgkmcnt(15)
    v_mfma_f32_32x32x16_bf16 v[128:143], v[44:47], v[60:63], v[128:143]
    s_waitcnt lgkmcnt(15)
    v_mfma_f32_32x32x16_bf16 v[112:127], v[64:67], v[96:99], v[112:127]
    s_waitcnt lgkmcnt(15)
    v_mfma_f32_32x32x16_bf16 v[128:143], v[68:71], v[96:99], v[128:143]
    s_waitcnt lgkmcnt(0)
    s_barrier
    ds_read_b64_tr_b16 v[16:17], v3 offset:16384
    ds_read_b64_tr_b16 v[18:19], v4 offset:16384
    ds_read_b128 v[48:51], v5 offset:32768
    v_mfma_f32_32x32x16_bf16 v[112:127], v[72:75], v[100:103], v[112:127]
    ds_read_b64_tr_b16 v[20:21], v3 offset:20480
    ds_read_b64_tr_b16 v[22:23], v4 offset:20480
    ds_read_b64_tr_b16 v[24:25], v3 offset:16640
    v_mfma_f32_32x32x16_bf16 v[128:143], v[76:79], v[100:103], v[128:143]
    ds_read_b64_tr_b16 v[26:27], v4 offset:16640
    ds_read_b128 v[52:55], v6 offset:32768
    ds_read_b64_tr_b16 v[28:29], v3 offset:20736
    v_mfma_f32_32x32x16_bf16 v[112:127], v[80:83], v[104:107], v[112:127]
    ds_read_b64_tr_b16 v[30:31], v4 offset:20736
    ds_read_b64_tr_b16 v[32:33], v3 offset:16896
    ds_read_b64_tr_b16 v[34:35], v4 offset:16896
    v_mfma_f32_32x32x16_bf16 v[128:143], v[84:87], v[104:107], v[128:143]
    ds_read_b128 v[56:59], v7 offset:32768
    ds_read_b64_tr_b16 v[36:37], v3 offset:20992
    ds_read_b64_tr_b16 v[38:39], v4 offset:20992
    v_mfma_f32_32x32x16_bf16 v[112:127], v[88:91], v[108:111], v[112:127]
    ds_read_b64_tr_b16 v[40:41], v3 offset:17152
    ds_read_b64_tr_b16 v[42:43], v4 offset:17152
    ds_read_b128 v[60:63], v8 offset:32768
    v_mfma_f32_32x32x16_bf16 v[128:143], v[92:95], v[108:111], v[128:143]
    ds_read_b64_tr_b16 v[44:45], v3 offset:21248
    ds_read_b64_tr_b16 v[46:47], v4 offset:21248
    s_cmp_eq_u32 s28, 1
    s_cbranch_scc1 L_c2_hk10
L_c2_hr4:
    s_waitcnt lgkmcnt(15)
    v_mfma_f32_32x32x16_bf16 v[112:127], v[16:19], v[48:51], v[112:127]
    ds_read_b64_tr_b16 v[64:65], v3 offset:32768
    ds_read_b64_tr_b16 v[66:67], v4 offset:32768
    ds_read_b128 v[96:99], v5 offset:40960
    s_waitcnt lgkmcnt(15)
    v_mfma_f32_32x32x16_bf16 v[128:143], v[20:23], v[48:51], v[128:143]
    ds_read_b64_tr_b16 v[68:69], v3 offset:36864
    ds_read_b64_tr_b16 v[70:71], v4 offset:36864
    ds_read_b64_tr_b16 v[72:73], v3 offset:33024
    s_waitcnt lgkmcnt(15)
    v_mfma_f32_32x32x16_bf16 v[112:127], v[24:27], v[52:55], v[112:127]
    ds_read_b64_tr_b16 v[74:75], v4 offset:33024
    ds_read_b128 v[100:103], v6 offset:40960
    ds_read_b64_tr_b16 v[76:77], v3 offset:37120
    s_waitcnt lgkmcnt(15)
    v_mfma_f32_32x32x16_bf16 v[128:143], v[28:31], v[52:55], v[128:143]
    ds_read_b64_tr_b16 v[78:79], v4 offset:37120
    ds_read_b64_tr_b16 v[80:81], v3 offset:33280
    ds_read_b64_tr_b16 v[82:83], v4 offset:33280
    s_waitcnt lgkmcnt(15)
    v_mfma_f32_32x32x16_bf16 v[112:127], v[32:35], v[56:59], v[112:127]
    ds_read_b128 v[104:107], v7 offset:40960
    ds_read_b64_tr_b16 v[84:85], v3 offset:37376
    ds_read_b64_tr_b16 v[86:87], v4 offset:37376
    s_waitcnt lgkmcnt(15)
    v_mfma_f32_32x32x16_bf16 v[128:143], v[36:39], v[56:59], v[128:143]
    ds_read_b64_tr_b16 v[88:89], v3 offset:33536
    ds_read_b64_tr_b16 v[90:91], v4 offset:33536
    ds_read_b128 v[108:111], v8 offset:40960
    s_waitcnt lgkmcnt(15)
    v_mfma_f32_32x32x16_bf16 v[112:127], v[40:43], v[60:63], v[112:127]
    ds_read_b64_tr_b16 v[92:93], v3 offset:37632
    ds_read_b64_tr_b16 v[94:95], v4 offset:37632
    s_waitcnt lgkmcnt(15)
    v_mfma_f32_32x32x16_bf16 v[128:143], v[44:47], v[60:63], v[128:143]
    s_waitcnt lgkmcnt(15)
    v_mfma_f32_32x32x16_bf16 v[112:127], v[64:67], v[96:99], v[112:127]
    s_waitcnt lgkmcnt(15)
    v_mfma_f32_32x32x16_bf16 v[128:143], v[68:71], v[96:99], v[128:143]
    s_waitcnt lgkmcnt(0)
    s_barrier
    ds_read_b64_tr_b16 v[16:17], v1 offset:0
    ds_read_b64_tr_b16 v[18:19], v2 offset:0
    ds_read_b128 v[48:51], v5 offset:0
    v_mfma_f32_32x32x16_bf16 v[112:127], v[72:75], v[100:103], v[112:127]
    ds_read_b64_tr_b16 v[20:21], v1 offset:4096
    ds_read_b64_tr_b16 v[22:23], v2 offset:4096
    ds_read_b64_tr_b16 v[24:25], v1 offset:256
    v_mfma_f32_32x32x16_bf16 v[128:143], v[76:79], v[100:103], v[128:143]
    ds_read_b64_tr_b16 v[26:27], v2 offset:256
    ds_read_b128 v[52:55], v6 offset:0
    ds_read_b64_tr_b16 v[28:29], v1 offset:4352
    v_mfma_f32_32x32x16_bf16 v[112:127], v[80:83], v[104:107], v[112:127]
    ds_read_b64_tr_b16 v[30:31], v2 offset:4352
    ds_read_b64_tr_b16 v[32:33], v1 offset:512
    ds_read_b64_tr_b16 v[34:35], v2 offset:512
    v_mfma_f32_32x32x16_bf16 v[128:143], v[84:87], v[104:107], v[128:143]
    ds_read_b128 v[56:59], v7 offset:0
    ds_read_b64_tr_b16 v[36:37], v1 offset:4608
    ds_read_b64_tr_b16 v[38:39], v2 offset:4608
    v_mfma_f32_32x32x16_bf16 v[112:127], v[88:91], v[108:111], v[112:127]
    ds_read_b64_tr_b16 v[40:41], v1 offset:768
    ds_read_b64_tr_b16 v[42:43], v2 offset:768
    ds_read_b128 v[60:63], v8 offset:0
    v_mfma_f32_32x32x16_bf16 v[128:143], v[92:95], v[108:111], v[128:143]
    ds_read_b64_tr_b16 v[44:45], v1 offset:4864
    ds_read_b64_tr_b16 v[46:47], v2 offset:4864
    s_add_u32 s28, s28, 1
    s_cmp_lt_u32 s28, 5
    s_cbranch_scc1 L_c2_h
    s_waitcnt lgkmcnt(15)
    v_mfma_f32_32x32x16_bf16 v[112:127], v[16:19], v[48:51], v[112:127]
    ds_read_b64_tr_b16 v[64:65], v1 offset:16384
    ds_read_b64_tr_b16 v[66:67], v2 offset:16384
    ds_read_b128 v[96:99], v5 offset:8192
    s_waitcnt lgkmcnt(15)
    v_mfma_f32_32x32x16_bf16 v[128:143], v[20:23], v[48:51], v[128:143]
    ds_read_b64_tr_b16 v[68:69], v1 offset:20480
    ds_read_b64_tr_b16 v[70:71], v2 offset:20480
    ds_read_b64_tr_b16 v[72:73], v1 offset:16640
    s_waitcnt lgkmcnt(15)
    v_mfma_f32_32x32x16_bf16 v[112:127], v[24:27], v[52:55], v[112:127]
    ds_read_b64_tr_b16 v[74:75], v2 offset:16640
    ds_read_b128 v[100:103], v6 offset:8192
    ds_read_b64_tr_b16 v[76:77], v1 offset:20736
    s_waitcnt lgkmcnt(15)
    v_mfma_f32_32x32x16_bf16 v[128:143], v[28:31], v[52:55], v[128:143]
    ds_read_b64_tr_b16 v[78:79], v2 offset:20736
    ds_read_b64_tr_b16 v[80:81], v1 offset:16896
    ds_read_b64_tr_b16 v[82:83], v2 offset:16896
    s_waitcnt lgkmcnt(15)
    v_mfma_f32_32x32x16_bf16 v[112:127], v[32:35], v[56:59], v[112:127]
    ds_read_b128 v[104:107], v7 offset:8192
    ds_read_b64_tr_b16 v[84:85], v1 offset:20992
    ds_read_b64_tr_b16 v[86:87], v2 offset:20992
    s_waitcnt lgkmcnt(15)
    v_mfma_f32_32x32x16_bf16 v[128:143], v[36:39], v[56:59], v[128:143]
    ds_read_b64_tr_b16 v[88:89], v1 offset:17152
    ds_read_b64_tr_b16 v[90:91], v2 offset:17152
    ds_read_b128 v[108:111], v8 offset:8192
    s_waitcnt lgkmcnt(15)
    v_mfma_f32_32x32x16_bf16 v[112:127], v[40:43], v[60:63], v[112:127]
    ds_read_b64_tr_b16 v[92:93], v1 offset:21248
    ds_read_b64_tr_b16 v[94:95], v2 offset:21248
    s_waitcnt lgkmcnt(15)
    v_mfma_f32_32x32x16_bf16 v[128:143], v[44:47], v[60:63], v[128:143]
    s_waitcnt lgkmcnt(15)
    v_mfma_f32_32x32x16_bf16 v[112:127], v[64:67], v[96:99], v[112:127]
    s_waitcnt lgkmcnt(15)
    v_mfma_f32_32x32x16_bf16 v[128:143], v[68:71], v[96:99], v[128:143]
    s_waitcnt lgkmcnt(0)
    s_barrier
    v_mfma_f32_32x32x16_bf16 v[112:127], v[72:75], v[100:103], v[112:127]
    v_mfma_f32_32x32x16_bf16 v[128:143], v[76:79], v[100:103], v[128:143]
    v_mfma_f32_32x32x16_bf16 v[112:127], v[80:83], v[104:107], v[112:127]
    v_mfma_f32_32x32x16_bf16 v[128:143], v[84:87], v[104:107], v[128:143]
    v_mfma_f32_32x32x16_bf16 v[112:127], v[88:91], v[108:111], v[112:127]
    v_mfma_f32_32x32x16_bf16 v[128:143], v[92:95], v[108:111], v[128:143]
    v_add_u32 v216, 49152, v9
    v_add_u32 v217, 49152, v10
    v_add_u32 v218, 49152, v11
    v_add_u32 v219, 49152, v12
    ds_read_b128 v[16:19], v9 offset:32768
    ds_read_b128 v[20:23], v9 offset:36864
    ds_read_b128 v[24:27], v10 offset:32768
    ds_read_b128 v[28:31], v10 offset:36864
    ds_read_b128 v[32:35], v11 offset:32768
    ds_read_b128 v[36:39], v11 offset:36864
    ds_read_b128 v[40:43], v12 offset:32768
    ds_read_b128 v[44:47], v12 offset:36864
    s_waitcnt lgkmcnt(7)
    v_mfma_f32_32x32x16_bf16 v[112:127], v[16:19], v[240:243], v[112:127]
    ds_read_b128 v[64:67], v216 offset:0
    ds_read_b64_tr_b16 v[96:97], v13 offset:16384
    ds_read_b64_tr_b16 v[98:99], v13 offset:18432
    s_waitcnt lgkmcnt(9)
    v_mfma_f32_32x32x16_bf16 v[128:143], v[20:23], v[240:243], v[128:143]
    ds_read_b128 v[68:71], v216 offset:4096
    ds_read_b128 v[72:75], v217 offset:0
    ds_read_b64_tr_b16 v[100:101], v13 offset:17408
    s_waitcnt lgkmcnt(11)
    v_mfma_f32_32x32x16_bf16 v[112:127], v[24:27], v[244:247], v[112:127]
    ds_read_b64_tr_b16 v[102:103], v13 offset:19456
    ds_read_b128 v[76:79], v217 offset:4096
    ds_read_b128 v[80:83], v218 offset:0
    s_waitcnt lgkmcnt(13)
    v_mfma_f32_32x32x16_bf16 v[128:143], v[28:31], v[244:247], v[128:143]
    ds_read_b64_tr_b16 v[104:105], v13 offset:20480
    ds_read_b64_tr_b16 v[106:107], v13 offset:22528
    ds_read_b128 v[84:87], v218 offset:4096
    s_waitcnt lgkmcnt(15)
    v_mfma_f32_32x32x16_bf16 v[112:127], v[32:35], v[248:251], v[112:127]
    ds_read_b128 v[88:91], v219 offset:0
    ds_read_b64_tr_b16 v[108:109], v13 offset:21504
    ds_read_b64_tr_b16 v[110:111], v13 offset:23552
    s_waitcnt lgkmcnt(15)
    v_mfma_f32_32x32x16_bf16 v[128:143], v[36:39], v[248:251], v[128:143]
    ds_read_b128 v[92:95], v219 offset:4096
    s_waitcnt lgkmcnt(15)
    v_mfma_f32_32x32x16_bf16 v[112:127], v[40:43], v[252:255], v[112:127]
    s_waitcnt lgkmcnt(15)
    v_mfma_f32_32x32x16_bf16 v[128:143], v[44:47], v[252:255], v[128:143]
    s_nop 1
    s_lshr_b32 s32, s24, 1
    s_lshl_b32 s32, s32, 8
    s_add_u32 s32, s32, 147456
    v_bfe_u32 v221, v0, 5, 1
    v_lshlrev_b32 v221, 4, v221
    v_add_u32 v221, s32, v221
    ds_read_b128 v[224:227], v221 offset:0
    ds_read_b128 v[228:231], v221 offset:32
    ds_read_b128 v[232:235], v221 offset:64
    ds_read_b128 v[236:239], v221 offset:96
    ds_read_b128 v[240:243], v221 offset:128
    ds_read_b128 v[244:247], v221 offset:160
    ds_read_b128 v[248:251], v221 offset:192
    ds_read_b128 v[252:255], v221 offset:224
    s_waitcnt lgkmcnt(0)
    s_mov_b32 s36, 0xffff0000
    v_sub_f32 v176, 1.0, v224
    v_sub_f32 v177, 1.0, v225
    v_cvt_pk_bf16_f32 v177, v176, v177
    v_lshlrev_b32 v176, 16, v177
    v_and_b32 v177, s36, v177
    v_sub_f32 v178, 1.0, v226
    v_sub_f32 v179, 1.0, v227
    v_cvt_pk_bf16_f32 v179, v178, v179
    v_lshlrev_b32 v178, 16, v179
    v_and_b32 v179, s36, v179
    v_sub_f32 v180, 1.0, v228
    v_sub_f32 v181, 1.0, v229
    v_cvt_pk_bf16_f32 v181, v180, v181
    v_lshlrev_b32 v180, 16, v181
    v_and_b32 v181, s36, v181
    v_sub_f32 v182, 1.0, v230
    v_sub_f32 v183, 1.0, v231
    v_cvt_pk_bf16_f32 v183, v182, v183
    v_lshlrev_b32 v182, 16, v183
    v_and_b32 v183, s36, v183
    v_sub_f32 v184, 1.0, v232
    v_sub_f32 v185, 1.0, v233
    v_cvt_pk_bf16_f32 v185, v184, v185
    v_lshlrev_b32 v184, 16, v185
    v_and_b32 v185, s36, v185
    v_sub_f32 v186, 1.0, v234
    v_sub_f32 v187, 1.0, v235
    v_cvt_pk_bf16_f32 v187, v186, v187
    v_lshlrev_b32 v186, 16, v187
    v_and_b32 v187, s36, v187
    v_sub_f32 v188, 1.0, v236
    v_sub_f32 v189, 1.0, v237
    v_cvt_pk_bf16_f32 v189, v188, v189
    v_lshlrev_b32 v188, 16, v189
    v_and_b32 v189, s36, v189
    v_sub_f32 v190, 1.0, v238
    v_sub_f32 v191, 1.0, v239
    v_cvt_pk_bf16_f32 v191, v190, v191
    v_lshlrev_b32 v190, 16, v191
    v_and_b32 v191, s36, v191
    v_sub_f32 v192, 1.0, v240
    v_sub_f32 v193, 1.0, v241
    v_cvt_pk_bf16_f32 v193, v192, v193
    v_lshlrev_b32 v192, 16, v193
    v_and_b32 v193, s36, v193
    v_sub_f32 v194, 1.0, v242
    v_sub_f32 v195, 1.0, v243
    v_cvt_pk_bf16_f32 v195, v194, v195
    v_lshlrev_b32 v194, 16, v195
    v_and_b32 v195, s36, v195
    v_sub_f32 v196, 1.0, v244
    v_sub_f32 v197, 1.0, v245
    v_cvt_pk_bf16_f32 v197, v196, v197
    v_lshlrev_b32 v196, 16, v197
    v_and_b32 v197, s36, v197
    v_sub_f32 v198, 1.0, v246
    v_sub_f32 v199, 1.0, v247
    v_cvt_pk_bf16_f32 v199, v198, v199
    v_lshlrev_b32 v198, 16, v199
    v_and_b32 v199, s36, v199
    v_sub_f32 v200, 1.0, v248
    v_sub_f32 v201, 1.0, v249
    v_cvt_pk_bf16_f32 v201, v200, v201
    v_lshlrev_b32 v200, 16, v201
    v_and_b32 v201, s36, v201
    v_sub_f32 v202, 1.0, v250
    v_sub_f32 v203, 1.0, v251
    v_cvt_pk_bf16_f32 v203, v202, v203
    v_lshlrev_b32 v202, 16, v203
    v_and_b32 v203, s36, v203
    v_sub_f32 v204, 1.0, v252
    v_sub_f32 v205, 1.0, v253
    v_cvt_pk_bf16_f32 v205, v204, v205
    v_lshlrev_b32 v204, 16, v205
    v_and_b32 v205, s36, v205
    v_sub_f32 v206, 1.0, v254
    v_sub_f32 v207, 1.0, v255
    v_cvt_pk_bf16_f32 v207, v206, v207
    v_lshlrev_b32 v206, 16, v207
    v_and_b32 v207, s36, v207
    s_mov_b32 s28, 0
L_c2_o:
    s_waitcnt lgkmcnt(13)
    v_mfma_f32_32x32x16_bf16 v[144:159], v[64:67], v[96:99], v[144:159]
    s_waitcnt lgkmcnt(12)
    v_mfma_f32_32x32x16_bf16 v[160:175], v[68:71], v[96:99], v[160:175]
    s_waitcnt lgkmcnt(0)
    s_barrier
    ds_read_b128 v[16:19], v216 offset:16384
    ds_read_b64_tr_b16 v[48:49], v13 offset:24576
    ds_read_b64_tr_b16 v[50:51], v13 offset:26624
    v_mfma_f32_32x32x16_bf16 v[144:159], v[72:75], v[100:103], v[144:159]
    ds_read_b128 v[20:23], v216 offset:20480
    ds_read_b128 v[24:27], v217 offset:16384
    ds_read_b64_tr_b16 v[52:53], v13 offset:25600
    v_mfma_f32_32x32x16_bf16 v[160:175], v[76:79], v[100:103], v[160:175]
    ds_read_b64_tr_b16 v[54:55], v13 offset:27648
    ds_read_b128 v[28:31], v217 offset:20480
    ds_read_b128 v[32:35], v218 offset:16384
    v_mfma_f32_32x32x16_bf16 v[144:159], v[80:83], v[104:107], v[144:159]
    ds_read_b64_tr_b16 v[56:57], v13 offset:28672
    ds_read_b64_tr_b16 v[58:59], v13 offset:30720
    ds_read_b128 v[36:39], v218 offset:20480
    v_mfma_f32_32x32x16_bf16 v[160:175], v[84:87], v[104:107], v[160:175]
    ds_read_b128 v[40:43], v219 offset:16384
    ds_read_b64_tr_b16 v[60:61], v13 offset:29696
    ds_read_b64_tr_b16 v[62:63], v13 offset:31744
    v_mfma_f32_32x32x16_bf16 v[144:159], v[88:91], v[108:111], v[144:159]
    ds_read_b128 v[44:47], v219 offset:20480
    v_mfma_f32_32x32x16_bf16 v[160:175], v[92:95], v[108:111], v[160:175]
    s_waitcnt lgkmcnt(13)
    v_mfma_f32_32x32x16_bf16 v[144:159], v[16:19], v[48:51], v[144:159]
    ds_read_b128 v[64:67], v216 offset:32768
    ds_read_b64_tr_b16 v[96:97], v13 offset:32768
    ds_read_b64_tr_b16 v[98:99], v13 offset:34816
    s_waitcnt lgkmcnt(15)
    v_mfma_f32_32x32x16_bf16 v[160:175], v[20:23], v[48:51], v[160:175]
    ds_read_b128 v[68:71], v216 offset:36864
    ds_read_b128 v[72:75], v217 offset:32768
    ds_read_b64_tr_b16 v[100:101], v13 offset:33792
    s_waitcnt lgkmcnt(15)
    v_mfma_f32_32x32x16_bf16 v[144:159], v[24:27], v[52:55], v[144:159]
    ds_read_b64_tr_b16 v[102:103], v13 offset:35840
    ds_read_b128 v[76:79], v217 offset:36864
    ds_read_b128 v[80:83], v218 offset:32768
    s_waitcnt lgkmcnt(15)
    v_mfma_f32_32x32x16_bf16 v[160:175], v[28:31], v[52:55], v[160:175]
    ds_read_b64_tr_b16 v[104:105], v13 offset:36864
    ds_read_b64_tr_b16 v[106:107], v13 offset:38912
    ds_read_b128 v[84:87], v218 offset:36864
    s_waitcnt lgkmcnt(15)
    v_mfma_f32_32x32x16_bf16 v[144:159], v[32:35], v[56:59], v[144:159]
    ds_read_b128 v[88:91], v219 offset:32768
    ds_read_b64_tr_b16 v[108:109], v13 offset:37888
    ds_read_b64_tr_b16 v[110:111], v13 offset:39936
    s_waitcnt lgkmcnt(15)
    v_mfma_f32_32x32x16_bf16 v[160:175], v[36:39], v[56:59], v[160:175]
    ds_read_b128 v[92:95], v219 offset:36864
    s_waitcnt lgkmcnt(15)
    v_mfma_f32_32x32x16_bf16 v[144:159], v[40:43], v[60:63], v[144:159]
    s_waitcnt lgkmcnt(15)
    v_mfma_f32_32x32x16_bf16 v[160:175], v[44:47], v[60:63], v[160:175]
    s_waitcnt lgkmcnt(13)
    v_mfma_f32_32x32x16_bf16 v[144:159], v[64:67], v[96:99], v[144:159]
    s_waitcnt lgkmcnt(12)
    v_mfma_f32_32x32x16_bf16 v[160:175], v[68:71], v[96:99], v[160:175]
    s_waitcnt lgkmcnt(0)
    s_barrier
    ds_read_b128 v[16:19], v9 offset:0
    ds_read_b64_tr_b16 v[48:49], v13 offset:40960
    ds_read_b64_tr_b16 v[50:51], v13 offset:43008
    v_mfma_f32_32x32x16_bf16 v[144:159], v[72:75], v[100:103], v[144:159]
    ds_read_b128 v[20:23], v9 offset:4096
    ds_read_b128 v[24:27], v10 offset:0
    ds_read_b64_tr_b16 v[52:53], v13 offset:41984
    v_mfma_f32_32x32x16_bf16 v[160:175], v[76:79], v[100:103], v[160:175]
    ds_read_b64_tr_b16 v[54:55], v13 offset:44032
    ds_read_b128 v[28:31], v10 offset:4096
    ds_read_b128 v[32:35], v11 offset:0
    v_mfma_f32_32x32x16_bf16 v[144:159], v[80:83], v[104:107], v[144:159]
    ds_read_b64_tr_b16 v[56:57], v13 offset:45056
    ds_read_b64_tr_b16 v[58:59], v13 offset:47104
    ds_read_b128 v[36:39], v11 offset:4096
    v_mfma_f32_32x32x16_bf16 v[160:175], v[84:87], v[104:107], v[160:175]
    ds_read_b128 v[40:43], v12 offset:0
    ds_read_b64_tr_b16 v[60:61], v13 offset:46080
    ds_read_b64_tr_b16 v[62:63], v13 offset:48128
    v_mfma_f32_32x32x16_bf16 v[144:159], v[88:91], v[108:111], v[144:159]
    ds_read_b128 v[44:47], v12 offset:4096
    v_mfma_f32_32x32x16_bf16 v[160:175], v[92:95], v[108:111], v[160:175]
    s_waitcnt lgkmcnt(13)
    v_mfma_f32_32x32x16_bf16 v[144:159], v[16:19], v[48:51], v[144:159]
    ds_read_b128 v[64:67], v9 offset:16384
    ds_read_b64_tr_b16 v[96:97], v13 offset:0
    ds_read_b64_tr_b16 v[98:99], v13 offset:2048
    s_waitcnt lgkmcnt(15)
    v_mfma_f32_32x32x16_bf16 v[160:175], v[20:23], v[48:51], v[160:175]
    ds_read_b128 v[68:71], v9 offset:20480
    ds_read_b128 v[72:75], v10 offset:16384
    ds_read_b64_tr_b16 v[100:101], v13 offset:1024
    s_waitcnt lgkmcnt(15)
    v_mfma_f32_32x32x16_bf16 v[144:159], v[24:27], v[52:55], v[144:159]
    ds_read_b64_tr_b16 v[102:103], v13 offset:3072
    ds_read_b128 v[76:79], v10 offset:20480
    ds_read_b128 v[80:83], v11 offset:16384
    s_waitcnt lgkmcnt(15)
    v_mfma_f32_32x32x16_bf16 v[160:175], v[28:31], v[52:55], v[160:175]
    ds_read_b64_tr_b16 v[104:105], v13 offset:4096
    ds_read_b64_tr_b16 v[106:107], v13 offset:6144
    ds_read_b128 v[84:87], v11 offset:20480
    s_waitcnt lgkmcnt(15)
    v_mfma_f32_32x32x16_bf16 v[144:159], v[32:35], v[56:59], v[144:159]
    ds_read_b128 v[88:91], v12 offset:16384
    ds_read_b64_tr_b16 v[108:109], v13 offset:5120
    ds_read_b64_tr_b16 v[110:111], v13 offset:7168
    s_waitcnt lgkmcnt(15)
    v_mfma_f32_32x32x16_bf16 v[160:175], v[36:39], v[56:59], v[160:175]
    ds_read_b128 v[92:95], v12 offset:20480
    s_waitcnt lgkmcnt(15)
    v_mfma_f32_32x32x16_bf16 v[144:159], v[40:43], v[60:63], v[144:159]
    s_waitcnt lgkmcnt(15)
    v_mfma_f32_32x32x16_bf16 v[160:175], v[44:47], v[60:63], v[160:175]
    s_waitcnt lgkmcnt(13)
    v_mfma_f32_32x32x16_bf16 v[144:159], v[64:67], v[96:99], v[144:159]
    s_waitcnt lgkmcnt(12)
    v_mfma_f32_32x32x16_bf16 v[160:175], v[68:71], v[96:99], v[160:175]
    s_waitcnt lgkmcnt(0)
    s_barrier
    ds_read_b128 v[16:19], v9 offset:32768
    ds_read_b64_tr_b16 v[48:49], v13 offset:8192
    ds_read_b64_tr_b16 v[50:51], v13 offset:10240
    v_mfma_f32_32x32x16_bf16 v[144:159], v[72:75], v[100:103], v[144:159]
    ds_read_b128 v[20:23], v9 offset:36864
    ds_read_b128 v[24:27], v10 offset:32768
    ds_read_b64_tr_b16 v[52:53], v13 offset:9216
    v_mfma_f32_32x32x16_bf16 v[160:175], v[76:79], v[100:103], v[160:175]
    ds_read_b64_tr_b16 v[54:55], v13 offset:11264
    ds_read_b128 v[28:31], v10 offset:36864
    ds_read_b128 v[32:35], v11 offset:32768
    v_mfma_f32_32x32x16_bf16 v[144:159], v[80:83], v[104:107], v[144:159]
    ds_read_b64_tr_b16 v[56:57], v13 offset:12288
    ds_read_b64_tr_b16 v[58:59], v13 offset:14336
    ds_read_b128 v[36:39], v11 offset:36864
    v_mfma_f32_32x32x16_bf16 v[160:175], v[84:87], v[104:107], v[160:175]
    ds_read_b128 v[40:43], v12 offset:32768
    ds_read_b64_tr_b16 v[60:61], v13 offset:13312
    ds_read_b64_tr_b16 v[62:63], v13 offset:15360
    v_mfma_f32_32x32x16_bf16 v[144:159], v[88:91], v[108:111], v[144:159]
    ds_read_b128 v[44:47], v12 offset:36864
    v_mfma_f32_32x32x16_bf16 v[160:175], v[92:95], v[108:111], v[160:175]
    s_waitcnt lgkmcnt(13)
    v_mfma_f32_32x32x16_bf16 v[144:159], v[16:19], v[48:51], v[144:159]
    ds_read_b128 v[64:67], v216 offset:0
    ds_read_b64_tr_b16 v[96:97], v13 offset:16384
    ds_read_b64_tr_b16 v[98:99], v13 offset:18432
    s_waitcnt lgkmcnt(15)
    v_mfma_f32_32x32x16_bf16 v[160:175], v[20:23], v[48:51], v[160:175]
    ds_read_b128 v[68:71], v216 offset:4096
    ds_read_b128 v[72:75], v217 offset:0
    ds_read_b64_tr_b16 v[100:101], v13 offset:17408
    s_waitcnt lgkmcnt(15)
    v_mfma_f32_32x32x16_bf16 v[144:159], v[24:27], v[52:55], v[144:159]
    ds_read_b64_tr_b16 v[102:103], v13 offset:19456
    ds_read_b128 v[76:79], v217 offset:4096
    ds_read_b128 v[80:83], v218 offset:0
    s_waitcnt lgkmcnt(15)
    v_mfma_f32_32x32x16_bf16 v[160:175], v[28:31], v[52:55], v[160:175]
    ds_read_b64_tr_b16 v[104:105], v13 offset:20480
    ds_read_b64_tr_b16 v[106:107], v13 offset:22528
    ds_read_b128 v[84:87], v218 offset:4096
    s_waitcnt lgkmcnt(15)
    v_mfma_f32_32x32x16_bf16 v[144:159], v[32:35], v[56:59], v[144:159]
    ds_read_b128 v[88:91], v219 offset:0
    ds_read_b64_tr_b16 v[108:109], v13 offset:21504
    ds_read_b64_tr_b16 v[110:111], v13 offset:23552
    s_waitcnt lgkmcnt(15)
    v_mfma_f32_32x32x16_bf16 v[160:175], v[36:39], v[56:59], v[160:175]
    ds_read_b128 v[92:95], v219 offset:4096
    s_waitcnt lgkmcnt(15)
    v_mfma_f32_32x32x16_bf16 v[144:159], v[40:43], v[60:63], v[144:159]
    s_waitcnt lgkmcnt(15)
    v_mfma_f32_32x32x16_bf16 v[160:175], v[44:47], v[60:63], v[160:175]
    s_add_u32 s28, s28, 1
    s_cmp_lt_u32 s28, 2
    s_cbranch_scc1 L_c2_o
    s_waitcnt lgkmcnt(13)
    v_mfma_f32_32x32x16_bf16 v[144:159], v[64:67], v[96:99], v[144:159]
    s_waitcnt lgkmcnt(12)
    v_mfma_f32_32x32x16_bf16 v[160:175], v[68:71], v[96:99], v[160:175]
    s_waitcnt lgkmcnt(0)
    s_barrier
    ds_read_b128 v[16:19], v216 offset:16384
    ds_read_b64_tr_b16 v[48:49], v13 offset:24576
    ds_read_b64_tr_b16 v[50:51], v13 offset:26624
    v_mfma_f32_32x32x16_bf16 v[144:159], v[72:75], v[100:103], v[144:159]
    ds_read_b128 v[20:23], v216 offset:20480
    ds_read_b128 v[24:27], v217 offset:16384
    ds_read_b64_tr_b16 v[52:53], v13 offset:25600
    v_mfma_f32_32x32x16_bf16 v[160:175], v[76:79], v[100:103], v[160:175]
    ds_read_b64_tr_b16 v[54:55], v13 offset:27648
    ds_read_b128 v[28:31], v217 offset:20480
    ds_read_b128 v[32:35], v218 offset:16384
    v_mfma_f32_32x32x16_bf16 v[144:159], v[80:83], v[104:107], v[144:159]
    ds_read_b64_tr_b16 v[56:57], v13 offset:28672
    ds_read_b64_tr_b16 v[58:59], v13 offset:30720
    ds_read_b128 v[36:39], v218 offset:20480
    v_mfma_f32_32x32x16_bf16 v[160:175], v[84:87], v[104:107], v[160:175]
    ds_read_b128 v[40:43], v219 offset:16384
    ds_read_b64_tr_b16 v[60:61], v13 offset:29696
    ds_read_b64_tr_b16 v[62:63], v13 offset:31744
    v_mfma_f32_32x32x16_bf16 v[144:159], v[88:91], v[108:111], v[144:159]
    ds_read_b128 v[44:47], v219 offset:20480
    v_mfma_f32_32x32x16_bf16 v[160:175], v[92:95], v[108:111], v[160:175]
    s_waitcnt lgkmcnt(13)
    v_mfma_f32_32x32x16_bf16 v[144:159], v[16:19], v[48:51], v[144:159]
    ds_read_b128 v[64:67], v216 offset:32768
    ds_read_b64_tr_b16 v[96:97], v13 offset:32768
    ds_read_b64_tr_b16 v[98:99], v13 offset:34816
    s_waitcnt lgkmcnt(15)
    v_mfma_f32_32x32x16_bf16 v[160:175], v[20:23], v[48:51], v[160:175]
    ds_read_b128 v[68:71], v216 offset:36864
    ds_read_b128 v[72:75], v217 offset:32768
    ds_read_b64_tr_b16 v[100:101], v13 offset:33792
    s_waitcnt lgkmcnt(15)
    v_mfma_f32_32x32x16_bf16 v[144:159], v[24:27], v[52:55], v[144:159]
    ds_read_b64_tr_b16 v[102:103], v13 offset:35840
    ds_read_b128 v[76:79], v217 offset:36864
    ds_read_b128 v[80:83], v218 offset:32768
    s_waitcnt lgkmcnt(15)
    v_mfma_f32_32x32x16_bf16 v[160:175], v[28:31], v[52:55], v[160:175]
    ds_read_b64_tr_b16 v[104:105], v13 offset:36864
    ds_read_b64_tr_b16 v[106:107], v13 offset:38912
    ds_read_b128 v[84:87], v218 offset:36864
    s_waitcnt lgkmcnt(15)
    v_mfma_f32_32x32x16_bf16 v[144:159], v[32:35], v[56:59], v[144:159]
    ds_read_b128 v[88:91], v219 offset:32768
    ds_read_b64_tr_b16 v[108:109], v13 offset:37888
    ds_read_b64_tr_b16 v[110:111], v13 offset:39936
    s_waitcnt lgkmcnt(15)
    v_mfma_f32_32x32x16_bf16 v[160:175], v[36:39], v[56:59], v[160:175]
    ds_read_b128 v[92:95], v219 offset:36864
    s_waitcnt lgkmcnt(15)
    v_mfma_f32_32x32x16_bf16 v[144:159], v[40:43], v[60:63], v[144:159]
    s_waitcnt lgkmcnt(15)
    v_mfma_f32_32x32x16_bf16 v[160:175], v[44:47], v[60:63], v[160:175]
    s_waitcnt lgkmcnt(13)
    v_mfma_f32_32x32x16_bf16 v[144:159], v[64:67], v[96:99], v[144:159]
    s_waitcnt lgkmcnt(12)
    v_mfma_f32_32x32x16_bf16 v[160:175], v[68:71], v[96:99], v[160:175]
    s_waitcnt lgkmcnt(0)
    s_barrier
    ds_read_b128 v[16:19], v9 offset:0
    ds_read_b64_tr_b16 v[48:49], v13 offset:40960
    ds_read_b64_tr_b16 v[50:51], v13 offset:43008
    v_mfma_f32_32x32x16_bf16 v[144:159], v[72:75], v[100:103], v[144:159]
    ds_read_b128 v[20:23], v9 offset:4096
    ds_read_b128 v[24:27], v10 offset:0
    ds_read_b64_tr_b16 v[52:53], v13 offset:41984
    v_mfma_f32_32x32x16_bf16 v[160:175], v[76:79], v[100:103], v[160:175]
    ds_read_b64_tr_b16 v[54:55], v13 offset:44032
    ds_read_b128 v[28:31], v10 offset:4096
    ds_read_b128 v[32:35], v11 offset:0
    v_mfma_f32_32x32x16_bf16 v[144:159], v[80:83], v[104:107], v[144:159]
    ds_read_b64_tr_b16 v[56:57], v13 offset:45056
    ds_read_b64_tr_b16 v[58:59], v13 offset:47104
    ds_read_b128 v[36:39], v11 offset:4096
    v_mfma_f32_32x32x16_bf16 v[160:175], v[84:87], v[104:107], v[160:175]
    ds_read_b128 v[40:43], v12 offset:0
    ds_read_b64_tr_b16 v[60:61], v13 offset:46080
    ds_read_b64_tr_b16 v[62:63], v13 offset:48128
    v_mfma_f32_32x32x16_bf16 v[144:159], v[88:91], v[108:111], v[144:159]
    ds_read_b128 v[44:47], v12 offset:4096
    v_mfma_f32_32x32x16_bf16 v[160:175], v[92:95], v[108:111], v[160:175]
    s_waitcnt lgkmcnt(13)
    v_mfma_f32_32x32x16_bf16 v[144:159], v[16:19], v[48:51], v[144:159]
    s_waitcnt lgkmcnt(12)
    v_mfma_f32_32x32x16_bf16 v[160:175], v[20:23], v[48:51], v[160:175]
    s_waitcnt lgkmcnt(0)
    s_barrier
    v_mfma_f32_32x32x16_bf16 v[144:159], v[24:27], v[52:55], v[144:159]
    v_mfma_f32_32x32x16_bf16 v[160:175], v[28:31], v[52:55], v[160:175]
    v_mfma_f32_32x32x16_bf16 v[144:159], v[32:35], v[56:59], v[144:159]
    v_mfma_f32_32x32x16_bf16 v[160:175], v[36:39], v[56:59], v[160:175]
    v_mfma_f32_32x32x16_bf16 v[144:159], v[40:43], v[60:63], v[144:159]
    v_mfma_f32_32x32x16_bf16 v[160:175], v[44:47], v[60:63], v[160:175]
    s_waitcnt lgkmcnt(0)
    s_nop 15
    s_nop 3
    s_mov_b32 s36, 0xffff0000
    s_mov_b32 s37, 0
    s_mov_b32 s38, 4096
    v_cvt_pk_bf16_f32 v145, v144, v145
    v_pk_add_f32 v[112:113], v[112:113], v[112:113]
    v_lshlrev_b32 v144, 16, v145
    v_and_b32 v145, s36, v145
    v_pk_mul_f32 v[144:145], v[176:177], v[144:145]
    v_cvt_pk_bf16_f32 v145, v144, v145
    v_lshlrev_b32 v144, 16, v145
    v_and_b32 v145, s36, v145
    v_pk_fma_f32 v[112:113], v[224:225], v[112:113], v[144:145]
    buffer_store_dword v112, v14, s[60:63], s37 offen
    buffer_store_dword v113, v14, s[60:63], s38 offen
    s_mov_b32 s37, 8192
    s_mov_b32 s38, 12288
    v_cvt_pk_bf16_f32 v147, v146, v147
    v_pk_add_f32 v[114:115], v[114:115], v[114:115]
    v_lshlrev_b32 v146, 16, v147
    v_and_b32 v147, s36, v147
    v_pk_mul_f32 v[146:147], v[178:179], v[146:147]
    v_cvt_pk_bf16_f32 v147, v146, v147
    v_lshlrev_b32 v146, 16, v147
    v_and_b32 v147, s36, v147
    v_pk_fma_f32 v[114:115], v[226:227], v[114:115], v[146:147]
    buffer_store_dword v114, v14, s[60:63], s37 offen
    buffer_store_dword v115, v14, s[60:63], s38 offen
    s_mov_b32 s37, 32768
    s_mov_b32 s38, 36864
    v_cvt_pk_bf16_f32 v149, v148, v149
    v_pk_add_f32 v[116:117], v[116:117], v[116:117]
    v_lshlrev_b32 v148, 16, v149
    v_and_b32 v149, s36, v149
    v_pk_mul_f32 v[148:149], v[180:181], v[148:149]
    v_cvt_pk_bf16_f32 v149, v148, v149
    v_lshlrev_b32 v148, 16, v149
    v_and_b32 v149, s36, v149
    v_pk_fma_f32 v[116:117], v[228:229], v[116:117], v[148:149]
    buffer_store_dword v116, v14, s[60:63], s37 offen
    buffer_store_dword v117, v14, s[60:63], s38 offen
    s_mov_b32 s37, 40960
    s_mov_b32 s38, 45056
    v_cvt_pk_bf16_f32 v151, v150, v151
    v_pk_add_f32 v[118:119], v[118:119], v[118:119]
    v_lshlrev_b32 v150, 16, v151
    v_and_b32 v151, s36, v151
    v_pk_mul_f32 v[150:151], v[182:183], v[150:151]
    v_cvt_pk_bf16_f32 v151, v150, v151
    v_lshlrev_b32 v150, 16, v151
    v_and_b32 v151, s36, v151
    v_pk_fma_f32 v[118:119], v[230:231], v[118:119], v[150:151]
    buffer_store_dword v118, v14, s[60:63], s37 offen
    buffer_store_dword v119, v14, s[60:63], s38 offen
    s_mov_b32 s37, 65536
    s_mov_b32 s38, 69632
    v_cvt_pk_bf16_f32 v153, v152, v153
    v_pk_add_f32 v[120:121], v[120:121], v[120:121]
    v_lshlrev_b32 v152, 16, v153
    v_and_b32 v153, s36, v153
    v_pk_mul_f32 v[152:153], v[184:185], v[152:153]
    v_cvt_pk_bf16_f32 v153, v152, v153
    v_lshlrev_b32 v152, 16, v153
    v_and_b32 v153, s36, v153
    v_pk_fma_f32 v[120:121], v[232:233], v[120:121], v[152:153]
    buffer_store_dword v120, v14, s[60:63], s37 offen
    buffer_store_dword v121, v14, s[60:63], s38 offen
    s_mov_b32 s37, 73728
    s_mov_b32 s38, 77824
    v_cvt_pk_bf16_f32 v155, v154, v155
    v_pk_add_f32 v[122:123], v[122:123], v[122:123]
    v_lshlrev_b32 v154, 16, v155
    v_and_b32 v155, s36, v155
    v_pk_mul_f32 v[154:155], v[186:187], v[154:155]
    v_cvt_pk_bf16_f32 v155, v154, v155
    v_lshlrev_b32 v154, 16, v155
    v_and_b32 v155, s36, v155
    v_pk_fma_f32 v[122:123], v[234:235], v[122:123], v[154:155]
    buffer_store_dword v122, v14, s[60:63], s37 offen
    buffer_store_dword v123, v14, s[60:63], s38 offen
    s_mov_b32 s37, 98304
    s_mov_b32 s38, 102400
    v_cvt_pk_bf16_f32 v157, v156, v157
    v_pk_add_f32 v[124:125], v[124:125], v[124:125]
    v_lshlrev_b32 v156, 16, v157
    v_and_b32 v157, s36, v157
    v_pk_mul_f32 v[156:157], v[188:189], v[156:157]
    v_cvt_pk_bf16_f32 v157, v156, v157
    v_lshlrev_b32 v156, 16, v157
    v_and_b32 v157, s36, v157
    v_pk_fma_f32 v[124:125], v[236:237], v[124:125], v[156:157]
    buffer_store_dword v124, v14, s[60:63], s37 offen
    buffer_store_dword v125, v14, s[60:63], s38 offen
    s_mov_b32 s37, 106496
    s_mov_b32 s38, 110592
    v_cvt_pk_bf16_f32 v159, v158, v159
    v_pk_add_f32 v[126:127], v[126:127], v[126:127]
    v_lshlrev_b32 v158, 16, v159
    v_and_b32 v159, s36, v159
    v_pk_mul_f32 v[158:159], v[190:191], v[158:159]
    v_cvt_pk_bf16_f32 v159, v158, v159
    v_lshlrev_b32 v158, 16, v159
    v_and_b32 v159, s36, v159
    v_pk_fma_f32 v[126:127], v[238:239], v[126:127], v[158:159]
    buffer_store_dword v126, v14, s[60:63], s37 offen
    buffer_store_dword v127, v14, s[60:63], s38 offen
    s_mov_b32 s37, 131072
    s_mov_b32 s38, 135168
    v_cvt_pk_bf16_f32 v161, v160, v161
    v_pk_add_f32 v[128:129], v[128:129], v[128:129]
    v_lshlrev_b32 v160, 16, v161
    v_and_b32 v161, s36, v161
    v_pk_mul_f32 v[160:161], v[192:193], v[160:161]
    v_cvt_pk_bf16_f32 v161, v160, v161
    v_lshlrev_b32 v160, 16, v161
    v_and_b32 v161, s36, v161
    v_pk_fma_f32 v[128:129], v[240:241], v[128:129], v[160:161]
    buffer_store_dword v128, v14, s[60:63], s37 offen
    buffer_store_dword v129, v14, s[60:63], s38 offen
    s_mov_b32 s37, 139264
    s_mov_b32 s38, 143360
    v_cvt_pk_bf16_f32 v163, v162, v163
    v_pk_add_f32 v[130:131], v[130:131], v[130:131]
    v_lshlrev_b32 v162, 16, v163
    v_and_b32 v163, s36, v163
    v_pk_mul_f32 v[162:163], v[194:195], v[162:163]
    v_cvt_pk_bf16_f32 v163, v162, v163
    v_lshlrev_b32 v162, 16, v163
    v_and_b32 v163, s36, v163
    v_pk_fma_f32 v[130:131], v[242:243], v[130:131], v[162:163]
    buffer_store_dword v130, v14, s[60:63], s37 offen
    buffer_store_dword v131, v14, s[60:63], s38 offen
    s_mov_b32 s37, 163840
    s_mov_b32 s38, 167936
    v_cvt_pk_bf16_f32 v165, v164, v165
    v_pk_add_f32 v[132:133], v[132:133], v[132:133]
    v_lshlrev_b32 v164, 16, v165
    v_and_b32 v165, s36, v165
    v_pk_mul_f32 v[164:165], v[196:197], v[164:165]
    v_cvt_pk_bf16_f32 v165, v164, v165
    v_lshlrev_b32 v164, 16, v165
    v_and_b32 v165, s36, v165
    v_pk_fma_f32 v[132:133], v[244:245], v[132:133], v[164:165]
    buffer_store_dword v132, v14, s[60:63], s37 offen
    buffer_store_dword v133, v14, s[60:63], s38 offen
    s_mov_b32 s37, 172032
    s_mov_b32 s38, 176128
    v_cvt_pk_bf16_f32 v167, v166, v167
    v_pk_add_f32 v[134:135], v[134:135], v[134:135]
    v_lshlrev_b32 v166, 16, v167
    v_and_b32 v167, s36, v167
    v_pk_mul_f32 v[166:167], v[198:199], v[166:167]
    v_cvt_pk_bf16_f32 v167, v166, v167
    v_lshlrev_b32 v166, 16, v167
    v_and_b32 v167, s36, v167
    v_pk_fma_f32 v[134:135], v[246:247], v[134:135], v[166:167]
    buffer_store_dword v134, v14, s[60:63], s37 offen
    buffer_store_dword v135, v14, s[60:63], s38 offen
    s_mov_b32 s37, 196608
    s_mov_b32 s38, 200704
    v_cvt_pk_bf16_f32 v169, v168, v169
    v_pk_add_f32 v[136:137], v[136:137], v[136:137]
    v_lshlrev_b32 v168, 16, v169
    v_and_b32 v169, s36, v169
    v_pk_mul_f32 v[168:169], v[200:201], v[168:169]
    v_cvt_pk_bf16_f32 v169, v168, v169
    v_lshlrev_b32 v168, 16, v169
    v_and_b32 v169, s36, v169
    v_pk_fma_f32 v[136:137], v[248:249], v[136:137], v[168:169]
    buffer_store_dword v136, v14, s[60:63], s37 offen
    buffer_store_dword v137, v14, s[60:63], s38 offen
    s_mov_b32 s37, 204800
    s_mov_b32 s38, 208896
    v_cvt_pk_bf16_f32 v171, v170, v171
    v_pk_add_f32 v[138:139], v[138:139], v[138:139]
    v_lshlrev_b32 v170, 16, v171
    v_and_b32 v171, s36, v171
    v_pk_mul_f32 v[170:171], v[202:203], v[170:171]
    v_cvt_pk_bf16_f32 v171, v170, v171
    v_lshlrev_b32 v170, 16, v171
    v_and_b32 v171, s36, v171
    v_pk_fma_f32 v[138:139], v[250:251], v[138:139], v[170:171]
    buffer_store_dword v138, v14, s[60:63], s37 offen
    buffer_store_dword v139, v14, s[60:63], s38 offen
    s_mov_b32 s37, 229376
    s_mov_b32 s38, 233472
    v_cvt_pk_bf16_f32 v173, v172, v173
    v_pk_add_f32 v[140:141], v[140:141], v[140:141]
    v_lshlrev_b32 v172, 16, v173
    v_and_b32 v173, s36, v173
    v_pk_mul_f32 v[172:173], v[204:205], v[172:173]
    v_cvt_pk_bf16_f32 v173, v172, v173
    v_lshlrev_b32 v172, 16, v173
    v_and_b32 v173, s36, v173
    v_pk_fma_f32 v[140:141], v[252:253], v[140:141], v[172:173]
    buffer_store_dword v140, v14, s[60:63], s37 offen
    buffer_store_dword v141, v14, s[60:63], s38 offen
    s_mov_b32 s37, 237568
    s_mov_b32 s38, 241664
    v_cvt_pk_bf16_f32 v175, v174, v175
    v_pk_add_f32 v[142:143], v[142:143], v[142:143]
    v_lshlrev_b32 v174, 16, v175
    v_and_b32 v175, s36, v175
    v_pk_mul_f32 v[174:175], v[206:207], v[174:175]
    v_cvt_pk_bf16_f32 v175, v174, v175
    v_lshlrev_b32 v174, 16, v175
    v_and_b32 v175, s36, v175
    v_pk_fma_f32 v[142:143], v[254:255], v[142:143], v[174:175]
    buffer_store_dword v142, v14, s[60:63], s37 offen
    buffer_store_dword v143, v14, s[60:63], s38 offen
    s_endpgm
L_helper:
    s_mov_b32 s47, 40
    s_cmp_eq_u32 s24, 5
    s_cselect_b32 s47, 48, s47
    s_cmp_eq_u32 s24, 6
    s_cselect_b32 s47, 88, s47
    s_load_dwordx2 s[88:89], s[0:1], s47
    s_mov_b32 s90, 2097152
    s_cmp_eq_u32 s24, 7
    s_cselect_b32 s90, 0, s90
    s_mov_b32 s91, 0x20000
    s_cmp_eq_u32 s27, 1
    s_cbranch_scc1 L_helpB
    s_cmp_eq_u32 s24, 5
    s_cbranch_scc1 L_helpA1
    s_sub_u32 s32, s24, 4
    v_and_b32 v1, 63, v0
    v_lshrrev_b32 v2, 3, v1
    v_and_b32 v3, 7, v1
    v_lshrrev_b32 v4, 2, v2
    v_lshlrev_b32 v4, 4, v4
    v_and_b32 v5, 1, v2
    v_lshlrev_b32 v5, 3, v5
    v_add_u32 v4, v4, v5
    v_bfe_u32 v5, v2, 1, 1
    v_add_u32 v4, v4, v5
    s_lshl_b32 s33, s25, 8
    s_lshl_b32 s34, s32, 6
    s_add_u32 s33, s33, s34
    v_add_u32 v4, s33, v4
    v_lshlrev_b32 v4, 11, v4
    v_lshrrev_b32 v5, 1, v2
    v_xor_b32 v5, v3, v5
    v_lshlrev_b32 v5, 4, v5
    v_add_u32 v4, v4, v5
    v_add_u32 v10, 0, v4
    v_xor_b32 v11, 64, v4
    v_add_u32 v11, 65536, v11
    v_add_u32 v12, 4096, v4
    v_xor_b32 v13, 64, v4
    v_add_u32 v13, 69632, v13
    v_add_u32 v14, 8192, v4
    v_xor_b32 v15, 64, v4
    v_add_u32 v15, 73728, v15
    v_add_u32 v16, 12288, v4
    v_xor_b32 v17, 64, v4
    v_add_u32 v17, 77824, v17
    s_lshl_b32 s33, s26, 6
    s_lshl_b32 s34, s32, 4
    s_add_u32 s33, s33, s34
    v_add_u32 v6, s33, v2
    v_lshlrev_b32 v6, 11, v6
    v_lshrrev_b32 v7, 1, v2
    v_xor_b32 v7, v3, v7
    v_lshlrev_b32 v7, 4, v7
    v_add_u32 v18, v6, v7
    v_xor_b32 v19, 64, v18
    v_add_u32 v19, 16384, v19
    v_lshrrev_b32 v6, 2, v1
    s_lshl_b32 s34, s32, 4
    v_add_u32 v6, s34, v6
    s_movk_i32 s35, 6144
    v_mul_lo_u32 v6, v6, s35
    v_and_b32 v7, 3, v1
    v_lshrrev_b32 v8, 5, v1
    v_lshlrev_b32 v8, 1, v8
    v_xor_b32 v7, v7, v8
    v_lshlrev_b32 v7, 4, v7
    v_add_u32 v6, v6, v7
    s_lshl_b32 s34, s26, 7
    s_lshl_b32 s35, s27, 6
    s_add_u32 s34, s34, s35
    v_add_u32 v20, s34, v6
    s_lshl_b32 s44, s32, 13
    s_lshl_b32 s45, s32, 11
    s_lshl_b32 s46, s32, 10
    s_mov_b32 s29, 0
    s_mul_i32 s33, s25, 0
    s_and_b32 s33, s33, 15
    s_lshl_b32 s40, s33, 7
    s_mul_i32 s41, s33, 393216
    s_add_u32 s42, s41, 2048
    s_add_u32 s43, s41, 4096
    s_waitcnt lgkmcnt(0)
    s_add_u32 s32, s29, s44
    s_mov_b32 m0, s32
    s_nop 0
    buffer_load_dwordx4 v10, s[4:7], s40 offen lds
    s_add_u32 m0, s32, 1024
    s_nop 0
    buffer_load_dwordx4 v11, s[4:7], s40 offen lds
    s_add_u32 m0, s32, 2048
    s_nop 0
    buffer_load_dwordx4 v12, s[4:7], s40 offen lds
    s_add_u32 m0, s32, 3072
    s_nop 0
    buffer_load_dwordx4 v13, s[4:7], s40 offen lds
    s_add_u32 m0, s32, 4096
    s_nop 0
    buffer_load_dwordx4 v14, s[4:7], s40 offen lds
    s_add_u32 m0, s32, 5120
    s_nop 0
    buffer_load_dwordx4 v15, s[4:7], s40 offen lds
    s_add_u32 m0, s32, 6144
    s_nop 0
    buffer_load_dwordx4 v16, s[4:7], s40 offen lds
    s_add_u32 m0, s32, 7168
    s_nop 0
    buffer_load_dwordx4 v17, s[4:7], s40 offen lds
    s_add_u32 s32, s29, s45
    s_add_u32 m0, s32, 32768
    s_nop 0
    buffer_load_dwordx4 v18, s[8:11], s40 offen lds
    s_add_u32 m0, s32, 33792
    s_nop 0
    buffer_load_dwordx4 v19, s[8:11], s40 offen lds
    s_add_u32 m0, s32, 40960
    s_nop 0
    buffer_load_dwordx4 v18, s[12:15], s40 offen lds
    s_add_u32 m0, s32, 41984
    s_nop 0
    buffer_load_dwordx4 v19, s[12:15], s40 offen lds
    s_add_u32 s32, s29, s46
    s_add_u32 m0, s32, 49152
    s_nop 0
    buffer_load_dwordx4 v20, s[16:19], s41 offen lds
    s_add_u32 s40, s40, 128
    s_add_u32 s41, s41, 393216
    s_add_u32 s42, s42, 393216
    s_add_u32 s43, s43, 393216
    s_cmp_eq_u32 s40, 2048
    s_cselect_b32 s40, 0, s40
    s_cselect_b32 s41, 0, s41
    s_cselect_b32 s42, 2048, s42
    s_cselect_b32 s43, 4096, s43
    s_add_u32 s29, s29, 53248
    s_cmp_eq_u32 s29, 159744
    s_cselect_b32 s29, 0, s29
    s_add_u32 s32, s29, s44
    s_mov_b32 m0, s32
    s_nop 0
    buffer_load_dwordx4 v10, s[4:7], s40 offen lds
    s_add_u32 m0, s32, 1024
    s_nop 0
    buffer_load_dwordx4 v11, s[4:7], s40 offen lds
    s_add_u32 m0, s32, 2048
    s_nop 0
    buffer_load_dwordx4 v12, s[4:7], s40 offen lds
    s_add_u32 m0, s32, 3072
    s_nop 0
    buffer_load_dwordx4 v13, s[4:7], s40 offen lds
    s_add_u32 m0, s32, 4096
    s_nop 0
    buffer_load_dwordx4 v14, s[4:7], s40 offen lds
    s_add_u32 m0, s32, 5120
    s_nop 0
    buffer_load_dwordx4 v15, s[4:7], s40 offen lds
    s_add_u32 m0, s32, 6144
    s_nop 0
    buffer_load_dwordx4 v16, s[4:7], s40 offen lds
    s_add_u32 m0, s32, 7168
    s_nop 0
    buffer_load_dwordx4 v17, s[4:7], s40 offen lds
    s_add_u32 s32, s29, s45
    s_add_u32 m0, s32, 32768
    s_nop 0
    buffer_load_dwordx4 v18, s[8:11], s40 offen lds
    s_add_u32 m0, s32, 33792
    s_nop 0
    buffer_load_dwordx4 v19, s[8:11], s40 offen lds
    s_add_u32 m0, s32, 40960
    s_nop 0
    buffer_load_dwordx4 v18, s[12:15], s40 offen lds
    s_add_u32 m0, s32, 41984
    s_nop 0
    buffer_load_dwordx4 v19, s[12:15], s40 offen lds
    s_add_u32 s32, s29, s46
    s_add_u32 m0, s32, 49152
    s_nop 0
    buffer_load_dwordx4 v20, s[16:19], s41 offen lds
    s_add_u32 s40, s40, 128
    s_add_u32 s41, s41, 393216
    s_add_u32 s42, s42, 393216
    s_add_u32 s43, s43, 393216
    s_cmp_eq_u32 s40, 2048
    s_cselect_b32 s40, 0, s40
    s_cselect_b32 s41, 0, s41
    s_cselect_b32 s42, 2048, s42
    s_cselect_b32 s43, 4096, s43
    s_add_u32 s29, s29, 53248
    s_cmp_eq_u32 s29, 159744
    s_cselect_b32 s29, 0, s29
    s_mov_b32 s96, s16
    s_mov_b32 s97, s17
    s_mov_b32 s98, 6291456
    s_mov_b32 s99, 0x20000
    s_mov_b32 s95, 786432
    s_cmp_eq_u32 s24, 4
    s_cselect_b32 s96, s4, s96
    s_cselect_b32 s97, s5, s97
    s_cselect_b32 s98, 4194304, s98
    s_cselect_b32 s95, 256, s95
    s_cmp_eq_u32 s24, 5
    s_cselect_b32 s96, s8, s96
    s_cselect_b32 s97, s9, s97
    s_cselect_b32 s98, 2097152, s98
    s_cselect_b32 s95, 256, s95
    s_cmp_eq_u32 s24, 6
    s_cselect_b32 s96, s12, s96
    s_cselect_b32 s97, s13, s97
    s_cselect_b32 s98, 2097152, s98
    s_cselect_b32 s95, 256, s95
    v_and_b32 v240, 63, v0
    s_add_u32 s33, s31, 0
    s_and_b32 s33, s33, 31
    s_lshl_b32 s32, s3, 5
    s_add_u32 s32, s32, s33
    s_lshl_b32 s32, s32, 3
    v_and_b32 v243, 7, v240
    v_add_u32 v243, s32, v243
    v_lshlrev_b32 v243, 11, v243
    v_bfe_u32 v244, v240, 3, 1
    v_lshlrev_b32 v244, 7, v244
    v_add_u32 v243, v243, v244
    s_lshl_b32 s32, s2, 2
    v_and_b32 v245, 3, v240
    v_add_u32 v245, s32, v245
    v_lshlrev_b32 v245, 11, v245
    v_bfe_u32 v244, v240, 2, 1
    v_lshlrev_b32 v244, 7, v244
    v_add_u32 v245, v245, v244
    v_min_u32 v246, 23, v240
    v_cmp_lt_u32 vcc, 11, v246
    v_subrev_u32 v244, 12, v246
    s_nop 0
    v_cndmask_b32 v246, v246, v244, vcc
    s_mul_i32 s32, s2, 12
    v_add_u32 v246, s32, v246
    v_lshlrev_b32 v246, 7, v246
    v_mov_b32 v244, 393216
    v_cndmask_b32 v244, 0, v244, vcc
    v_add_u32 v246, v246, v244
    s_cmp_eq_u32 s24, 4
    s_cselect_b64 vcc, -1, 0
    v_cndmask_b32 v245, v245, v243, vcc
    s_cmp_eq_u32 s24, 7
    s_cselect_b64 vcc, -1, 0
    v_cndmask_b32 v241, v245, v246, vcc
    s_lshr_b32 s94, s95, 1
    s_mul_i32 s94, s94, 3
    v_lshlrev_b32 v242, 7, v240
    v_min_u32 v247, 63, v240
    v_lshlrev_b32 v247, 7, v247
    s_lshl_b32 s47, s2, 13
    s_cmp_eq_u32 s24, 7
    s_cselect_b32 s58, 341, 341
    buffer_load_dword v243, v241, s[96:99], s94 offen
    s_add_u32 s94, s94, s95
    buffer_load_dword v243, v241, s[96:99], s94 offen
    s_add_u32 s94, s94, s95
    s_waitcnt vmcnt(15)
    s_barrier
    s_add_u32 s32, s29, s44
    s_mov_b32 m0, s32
    s_nop 0
    buffer_load_dwordx4 v10, s[4:7], s40 offen lds
    s_add_u32 m0, s32, 1024
    s_nop 0
    buffer_load_dwordx4 v11, s[4:7], s40 offen lds
    s_add_u32 m0, s32, 2048
    s_nop 0
    buffer_load_dwordx4 v12, s[4:7], s40 offen lds
    s_add_u32 m0, s32, 3072
    s_nop 0
    buffer_load_dwordx4 v13, s[4:7], s40 offen lds
    s_add_u32 m0, s32, 4096
    s_nop 0
    buffer_load_dwordx4 v14, s[4:7], s40 offen lds
    s_add_u32 m0, s32, 5120
    s_nop 0
    buffer_load_dwordx4 v15, s[4:7], s40 offen lds
    s_add_u32 m0, s32, 6144
    s_nop 0
    buffer_load_dwordx4 v16, s[4:7], s40 offen lds
    s_add_u32 m0, s32, 7168
    s_nop 0
    buffer_load_dwordx4 v17, s[4:7], s40 offen lds
    s_add_u32 s32, s29, s45
    s_add_u32 m0, s32, 32768
    s_nop 0
    buffer_load_dwordx4 v18, s[8:11], s40 offen lds
    s_add_u32 m0, s32, 33792
    s_nop 0
    buffer_load_dwordx4 v19, s[8:11], s40 offen lds
    s_add_u32 m0, s32, 40960
    s_nop 0
    buffer_load_dwordx4 v18, s[12:15], s40 offen lds
    s_add_u32 m0, s32, 41984
    s_nop 0
    buffer_load_dwordx4 v19, s[12:15], s40 offen lds
    s_add_u32 s32, s29, s46
    s_add_u32 m0, s32, 49152
    s_nop 0
    buffer_load_dwordx4 v20, s[16:19], s41 offen lds
    s_add_u32 s40, s40, 128
    s_add_u32 s41, s41, 393216
    s_add_u32 s42, s42, 393216
    s_add_u32 s43, s43, 393216
    s_cmp_eq_u32 s40, 2048
    s_cselect_b32 s40, 0, s40
    s_cselect_b32 s41, 0, s41
    s_cselect_b32 s42, 2048, s42
    s_cselect_b32 s43, 4096, s43
    s_add_u32 s29, s29, 53248
    s_cmp_eq_u32 s29, 159744
    s_cselect_b32 s29, 0, s29
    s_waitcnt vmcnt(15)
    s_barrier
    s_add_u32 s32, s29, s44
    s_mov_b32 m0, s32
    s_nop 0
    buffer_load_dwordx4 v10, s[4:7], s40 offen lds
    s_add_u32 m0, s32, 1024
    s_nop 0
    buffer_load_dwordx4 v11, s[4:7], s40 offen lds
    s_add_u32 m0, s32, 2048
    s_nop 0
    buffer_load_dwordx4 v12, s[4:7], s40 offen lds
    s_add_u32 m0, s32, 3072
    s_nop 0
    buffer_load_dwordx4 v13, s[4:7], s40 offen lds
    s_add_u32 m0, s32, 4096
    s_nop 0
    buffer_load_dwordx4 v14, s[4:7], s40 offen lds
    s_add_u32 m0, s32, 5120
    s_nop 0
    buffer_load_dwordx4 v15, s[4:7], s40 offen lds
    s_add_u32 m0, s32, 6144
    s_nop 0
    buffer_load_dwordx4 v16, s[4:7], s40 offen lds
    s_add_u32 m0, s32, 7168
    s_nop 0
    buffer_load_dwordx4 v17, s[4:7], s40 offen lds
    s_add_u32 s32, s29, s45
    s_add_u32 m0, s32, 32768
    s_nop 0
    buffer_load_dwordx4 v18, s[8:11], s40 offen lds
    s_add_u32 m0, s32, 33792
    s_nop 0
    buffer_load_dwordx4 v19, s[8:11], s40 offen lds
    s_add_u32 m0, s32, 40960
    s_nop 0
    buffer_load_dwordx4 v18, s[12:15], s40 offen lds
    s_add_u32 m0, s32, 41984
    s_nop 0
    buffer_load_dwordx4 v19, s[12:15], s40 offen lds
    s_add_u32 s32, s29, s46
    s_add_u32 m0, s32, 49152
    s_nop 0
    buffer_load_dwordx4 v20, s[16:19], s41 offen lds
    s_add_u32 s40, s40, 128
    s_add_u32 s41, s41, 393216
    s_add_u32 s42, s42, 393216
    s_add_u32 s43, s43, 393216
    s_cmp_eq_u32 s40, 2048
    s_cselect_b32 s40, 0, s40
    s_cselect_b32 s41, 0, s41
    s_cselect_b32 s42, 2048, s42
    s_cselect_b32 s43, 4096, s43
    s_add_u32 s29, s29, 53248
    s_cmp_eq_u32 s29, 159744
    s_cselect_b32 s29, 0, s29
    s_mov_b32 s28, 0
    s_lshr_b32 s36, s58, s28
    s_bitcmp1_b32 s36, 0
    s_cselect_b32 s36, s94, 0x80000000
    s_cselect_b32 s37, s95, 0
    buffer_load_dword v243, v241, s[96:99], s36 offen
    s_add_u32 s94, s94, s37
    s_lshr_b32 s36, 4096, s28
    s_bitcmp1_b32 s36, 0
    s_cselect_b32 s36, s47, 0x80000000
    s_cselect_b32 s37, 8192, 0
    buffer_load_dword v244, v247, s[88:91], s36 offen
    s_add_u32 s47, s47, s37
    s_waitcnt vmcnt(15)
    s_mov_b32 s28, 1
L_ploopAx:
    s_barrier
    s_add_u32 s32, s29, s44
    s_mov_b32 m0, s32
    s_nop 0
    buffer_load_dwordx4 v10, s[4:7], s40 offen lds
    s_add_u32 m0, s32, 1024
    s_nop 0
    buffer_load_dwordx4 v11, s[4:7], s40 offen lds
    s_add_u32 m0, s32, 2048
    s_nop 0
    buffer_load_dwordx4 v12, s[4:7], s40 offen lds
    s_add_u32 m0, s32, 3072
    s_nop 0
    buffer_load_dwordx4 v13, s[4:7], s40 offen lds
    s_add_u32 m0, s32, 4096
    s_nop 0
    buffer_load_dwordx4 v14, s[4:7], s40 offen lds
    s_add_u32 m0, s32, 5120
    s_nop 0
    buffer_load_dwordx4 v15, s[4:7], s40 offen lds
    s_add_u32 m0, s32, 6144
    s_nop 0
    buffer_load_dwordx4 v16, s[4:7], s40 offen lds
    s_add_u32 m0, s32, 7168
    s_nop 0
    buffer_load_dwordx4 v17, s[4:7], s40 offen lds
    s_add_u32 s32, s29, s45
    s_add_u32 m0, s32, 32768
    s_nop 0
    buffer_load_dwordx4 v18, s[8:11], s40 offen lds
    s_add_u32 m0, s32, 33792
    s_nop 0
    buffer_load_dwordx4 v19, s[8:11], s40 offen lds
    s_add_u32 m0, s32, 40960
    s_nop 0
    buffer_load_dwordx4 v18, s[12:15], s40 offen lds
    s_add_u32 m0, s32, 41984
    s_nop 0
    buffer_load_dwordx4 v19, s[12:15], s40 offen lds
    s_add_u32 s32, s29, s46
    s_add_u32 m0, s32, 49152
    s_nop 0
    buffer_load_dwordx4 v20, s[16:19], s41 offen lds
    s_add_u32 s40, s40, 128
    s_add_u32 s41, s41, 393216
    s_add_u32 s42, s42, 393216
    s_add_u32 s43, s43, 393216
    s_cmp_eq_u32 s40, 2048
    s_cselect_b32 s40, 0, s40
    s_cselect_b32 s41, 0, s41
    s_cselect_b32 s42, 2048, s42
    s_cselect_b32 s43, 4096, s43
    s_add_u32 s29, s29, 53248
    s_cmp_eq_u32 s29, 159744
    s_cselect_b32 s29, 0, s29
    s_lshr_b32 s36, s58, s28
    s_bitcmp1_b32 s36, 0
    s_cselect_b32 s36, s94, 0x80000000
    s_cselect_b32 s37, s95, 0
    buffer_load_dword v243, v241, s[96:99], s36 offen
    s_add_u32 s94, s94, s37
    s_lshr_b32 s36, 4096, s28
    s_bitcmp1_b32 s36, 0
    s_cselect_b32 s36, s47, 0x80000000
    s_cselect_b32 s37, 8192, 0
    buffer_load_dword v244, v247, s[88:91], s36 offen
    s_add_u32 s47, s47, s37
    s_waitcnt vmcnt(17)
    s_add_u32 s28, s28, 1
    s_cmp_lt_u32 s28, 13
    s_cbranch_scc1 L_ploopAx
    s_barrier
    s_waitcnt vmcnt(0)
    s_cmp_lg_u32 s24, 7
    s_cbranch_scc1 L_cp_2
    s_getpc_b64 s[32:33]
L_pc_3:
    s_sub_u32 s32, s32, L_pc_3-gated_mix__ssm_conv_s5__linear_attn_block__prompt_kernel
    s_subb_u32 s33, s33, 0
    s_lshl_b32 s34, s31, 4
    v_and_b32 v245, 15, v0
    v_add_u32 v245, s34, v245
    v_lshlrev_b32 v245, 7, v245
    v_min_u32 v245, L_end-gated_mix__ssm_conv_s5__linear_attn_block__prompt_kernel, v245
    global_load_dword v246, v245, s[32:33]
L_cp_2:
    s_barrier
    s_barrier
L_helpA_join:
    v_mov_b32 v2, 159768
    ds_read_b32 v4, v2
    s_waitcnt lgkmcnt(0)
    v_readfirstlane_b32 s68, v4
    s_barrier
    s_load_dwordx2 s[8:9], s[0:1], 40
    s_mov_b32 s10, 2097152
    s_mov_b32 s11, 0x20000
    s_load_dwordx2 s[12:13], s[0:1], 48
    s_mov_b32 s14, 2097152
    s_mov_b32 s15, 0x20000
    s_load_dwordx2 s[16:17], s[0:1], 88
    s_mov_b32 s18, 2097152
    s_mov_b32 s19, 0x20000
    s_load_dwordx2 s[60:61], s[0:1], 104
    s_mov_b32 s62, 8388608
    s_mov_b32 s63, 0x20000
    s_load_dwordx2 s[64:65], s[0:1], 64
    s_mov_b32 s66, 2048
    s_mov_b32 s67, 0x20000
    s_mov_b32 s73, s26
    s_mov_b32 s71, s25
    s_lshl_b32 s72, s26, 1
    s_add_u32 s72, s72, s27
    s_lshr_b32 s32, s31, 4
    s_lshl_b32 s25, s3, 1
    s_add_u32 s25, s25, s32
    s_and_b32 s26, s31, 15
    s_waitcnt lgkmcnt(0)
    v_and_b32 v1, 63, v0
    v_lshrrev_b32 v2, 3, v1
    v_and_b32 v3, 7, v1
    s_lshl_b32 s33, s26, 6
    v_add_u32 v4, s33, v2
    v_lshlrev_b32 v4, 11, v4
    v_lshrrev_b32 v5, 1, v2
    v_xor_b32 v5, v3, v5
    v_lshlrev_b32 v5, 4, v5
    v_add_u32 v6, v4, v5
    v_xor_b32 v7, 64, v6
    v_add_u32 v10, 0, v6
    v_add_u32 v11, 16384, v7
    v_add_u32 v12, 32768, v6
    v_add_u32 v13, 49152, v7
    v_add_u32 v14, 65536, v6
    v_add_u32 v15, 81920, v7
    v_add_u32 v16, 98304, v6
    v_add_u32 v17, 114688, v7
    v_lshlrev_b32 v4, 11, v2
    v_bfe_u32 v5, v2, 1, 1
    v_lshlrev_b32 v5, 2, v5
    v_xor_b32 v5, v3, v5
    v_lshlrev_b32 v5, 4, v5
    v_add_u32 v4, v4, v5
    s_lshl_b32 s33, s26, 7
    v_add_u32 v6, s33, v4
    v_add_u32 v20, 0, v6
    v_add_u32 v21, 16384, v6
    v_add_u32 v22, 32768, v6
    v_add_u32 v23, 49152, v6
    v_add_u32 v24, 65536, v6
    v_add_u32 v25, 81920, v6
    v_add_u32 v26, 98304, v6
    v_add_u32 v27, 114688, v6
    s_barrier
    s_barrier
    s_cmp_lg_u32 s24, 6
    s_cbranch_scc1 L_nb_4
    s_mov_b32 s41, 0
    s_mov_b32 s43, 98304
    s_mov_b32 m0, s43
    s_nop 0
    buffer_load_dwordx4 v10, s[8:11], s41 offen lds
    s_add_u32 m0, s43, 1024
    s_nop 0
    buffer_load_dwordx4 v11, s[8:11], s41 offen lds
    s_add_u32 m0, s43, 2048
    s_nop 0
    buffer_load_dwordx4 v12, s[8:11], s41 offen lds
    s_add_u32 m0, s43, 3072
    s_nop 0
    buffer_load_dwordx4 v13, s[8:11], s41 offen lds
    s_add_u32 m0, s43, 4096
    s_nop 0
    buffer_load_dwordx4 v14, s[8:11], s41 offen lds
    s_add_u32 m0, s43, 5120
    s_nop 0
    buffer_load_dwordx4 v15, s[8:11], s41 offen lds
    s_add_u32 m0, s43, 6144
    s_nop 0
    buffer_load_dwordx4 v16, s[8:11], s41 offen lds
    s_add_u32 m0, s43, 7168
    s_nop 0
    buffer_load_dwordx4 v17, s[8:11], s41 offen lds
    s_add_u32 s41, s41, 128
    s_add_u32 s43, s43, 8192
    s_cmp_ge_u32 s43, 147456
    s_cselect_b32 s32, 49152, 0
    s_sub_u32 s43, s43, s32
    s_mov_b32 m0, s43
    s_nop 0
    buffer_load_dwordx4 v10, s[8:11], s41 offen lds
    s_add_u32 m0, s43, 1024
    s_nop 0
    buffer_load_dwordx4 v11, s[8:11], s41 offen lds
    s_add_u32 m0, s43, 2048
    s_nop 0
    buffer_load_dwordx4 v12, s[8:11], s41 offen lds
    s_add_u32 m0, s43, 3072
    s_nop 0
    buffer_load_dwordx4 v13, s[8:11], s41 offen lds
    s_add_u32 m0, s43, 4096
    s_nop 0
    buffer_load_dwordx4 v14, s[8:11], s41 offen lds
    s_add_u32 m0, s43, 5120
    s_nop 0
    buffer_load_dwordx4 v15, s[8:11], s41 offen lds
    s_add_u32 m0, s43, 6144
    s_nop 0
    buffer_load_dwordx4 v16, s[8:11], s41 offen lds
    s_add_u32 m0, s43, 7168
    s_nop 0
    buffer_load_dwordx4 v17, s[8:11], s41 offen lds
    s_add_u32 s41, s41, 128
    s_add_u32 s43, s43, 8192
    s_cmp_ge_u32 s43, 147456
    s_cselect_b32 s32, 49152, 0
    s_sub_u32 s43, s43, s32
    s_mov_b32 m0, s43
    s_nop 0
    buffer_load_dwordx4 v10, s[8:11], s41 offen lds
    s_add_u32 m0, s43, 1024
    s_nop 0
    buffer_load_dwordx4 v11, s[8:11], s41 offen lds
    s_add_u32 m0, s43, 2048
    s_nop 0
    buffer_load_dwordx4 v12, s[8:11], s41 offen lds
    s_add_u32 m0, s43, 3072
    s_nop 0
    buffer_load_dwordx4 v13, s[8:11], s41 offen lds
    s_add_u32 m0, s43, 4096
    s_nop 0
    buffer_load_dwordx4 v14, s[8:11], s41 offen lds
    s_add_u32 m0, s43, 5120
    s_nop 0
    buffer_load_dwordx4 v15, s[8:11], s41 offen lds
    s_add_u32 m0, s43, 6144
    s_nop 0
    buffer_load_dwordx4 v16, s[8:11], s41 offen lds
    s_add_u32 m0, s43, 7168
    s_nop 0
    buffer_load_dwordx4 v17, s[8:11], s41 offen lds
    s_add_u32 s41, s41, 128
    s_add_u32 s43, s43, 8192
    s_cmp_ge_u32 s43, 147456
    s_cselect_b32 s32, 49152, 0
    s_sub_u32 s43, s43, s32
    s_mov_b32 m0, s43
    s_nop 0
    buffer_load_dwordx4 v10, s[8:11], s41 offen lds
    s_add_u32 m0, s43, 1024
    s_nop 0
    buffer_load_dwordx4 v11, s[8:11], s41 offen lds
    s_add_u32 m0, s43, 2048
    s_nop 0
    buffer_load_dwordx4 v12, s[8:11], s41 offen lds
    s_add_u32 m0, s43, 3072
    s_nop 0
    buffer_load_dwordx4 v13, s[8:11], s41 offen lds
    s_add_u32 m0, s43, 4096
    s_nop 0
    buffer_load_dwordx4 v14, s[8:11], s41 offen lds
    s_add_u32 m0, s43, 5120
    s_nop 0
    buffer_load_dwordx4 v15, s[8:11], s41 offen lds
    s_add_u32 m0, s43, 6144
    s_nop 0
    buffer_load_dwordx4 v16, s[8:11], s41 offen lds
    s_add_u32 m0, s43, 7168
    s_nop 0
    buffer_load_dwordx4 v17, s[8:11], s41 offen lds
    s_add_u32 s41, s41, 128
    s_add_u32 s43, s43, 8192
    s_cmp_ge_u32 s43, 147456
    s_cselect_b32 s32, 49152, 0
    s_sub_u32 s43, s43, s32
L_nb_4:
    s_cmp_eq_u32 s24, 6
    s_cbranch_scc1 L_p2_bl
    s_cmp_eq_u32 s24, 7
    s_cbranch_scc1 L_p2_h3
    s_branch L_p2_al
L_helpA1:
    s_load_dwordx2 s[76:77], s[0:1], 8
    s_mov_b32 s78, 2048
    s_mov_b32 s79, 0x20000
    s_load_dwordx2 s[80:81], s[0:1], 16
    s_mov_b32 s82, 2048
    s_mov_b32 s83, 0x20000
    s_load_dwordx2 s[84:85], s[0:1], 56
    s_mov_b32 s86, 2048
    s_mov_b32 s87, 0x20000
    s_sub_u32 s32, s24, 4
    v_and_b32 v1, 63, v0
    v_lshrrev_b32 v2, 3, v1
    v_and_b32 v3, 7, v1
    v_lshrrev_b32 v4, 2, v2
    v_lshlrev_b32 v4, 4, v4
    v_and_b32 v5, 1, v2
    v_lshlrev_b32 v5, 3, v5
    v_add_u32 v4, v4, v5
    v_bfe_u32 v5, v2, 1, 1
    v_add_u32 v4, v4, v5
    s_lshl_b32 s33, s25, 8
    s_lshl_b32 s34, s32, 6
    s_add_u32 s33, s33, s34
    v_add_u32 v4, s33, v4
    v_lshlrev_b32 v4, 11, v4
    v_lshrrev_b32 v5, 1, v2
    v_xor_b32 v5, v3, v5
    v_lshlrev_b32 v5, 4, v5
    v_add_u32 v4, v4, v5
    v_add_u32 v10, 0, v4
    v_xor_b32 v11, 64, v4
    v_add_u32 v11, 65536, v11
    v_add_u32 v12, 4096, v4
    v_xor_b32 v13, 64, v4
    v_add_u32 v13, 69632, v13
    v_add_u32 v14, 8192, v4
    v_xor_b32 v15, 64, v4
    v_add_u32 v15, 73728, v15
    v_add_u32 v16, 12288, v4
    v_xor_b32 v17, 64, v4
    v_add_u32 v17, 77824, v17
    s_lshl_b32 s33, s26, 6
    s_lshl_b32 s34, s32, 4
    s_add_u32 s33, s33, s34
    v_add_u32 v6, s33, v2
    v_lshlrev_b32 v6, 11, v6
    v_lshrrev_b32 v7, 1, v2
    v_xor_b32 v7, v3, v7
    v_lshlrev_b32 v7, 4, v7
    v_add_u32 v18, v6, v7
    v_xor_b32 v19, 64, v18
    v_add_u32 v19, 16384, v19
    v_lshrrev_b32 v6, 2, v1
    s_lshl_b32 s34, s32, 4
    v_add_u32 v6, s34, v6
    s_movk_i32 s35, 6144
    v_mul_lo_u32 v6, v6, s35
    v_and_b32 v7, 3, v1
    v_lshrrev_b32 v8, 5, v1
    v_lshlrev_b32 v8, 1, v8
    v_xor_b32 v7, v7, v8
    v_lshlrev_b32 v7, 4, v7
    v_add_u32 v6, v6, v7
    s_lshl_b32 s34, s26, 7
    s_lshl_b32 s35, s27, 6
    s_add_u32 s34, s34, s35
    v_add_u32 v20, s34, v6
    s_lshl_b32 s44, s32, 13
    s_lshl_b32 s45, s32, 11
    s_lshl_b32 s46, s32, 10
    s_mov_b32 s29, 0
    s_mul_i32 s33, s25, 0
    s_and_b32 s33, s33, 15
    s_lshl_b32 s40, s33, 7
    s_mul_i32 s41, s33, 393216
    s_add_u32 s42, s41, 2048
    s_add_u32 s43, s41, 4096
    s_waitcnt lgkmcnt(0)
    s_mov_b32 s69, 266665984
    s_buffer_load_dword s68, s[20:23], s69
    s_add_u32 s32, s29, s44
    s_mov_b32 m0, s32
    s_nop 0
    buffer_load_dwordx4 v10, s[4:7], s40 offen lds
    s_add_u32 m0, s32, 1024
    s_nop 0
    buffer_load_dwordx4 v11, s[4:7], s40 offen lds
    s_add_u32 m0, s32, 2048
    s_nop 0
    buffer_load_dwordx4 v12, s[4:7], s40 offen lds
    s_add_u32 m0, s32, 3072
    s_nop 0
    buffer_load_dwordx4 v13, s[4:7], s40 offen lds
    s_add_u32 m0, s32, 4096
    s_nop 0
    buffer_load_dwordx4 v14, s[4:7], s40 offen lds
    s_add_u32 m0, s32, 5120
    s_nop 0
    buffer_load_dwordx4 v15, s[4:7], s40 offen lds
    s_add_u32 m0, s32, 6144
    s_nop 0
    buffer_load_dwordx4 v16, s[4:7], s40 offen lds
    s_add_u32 m0, s32, 7168
    s_nop 0
    buffer_load_dwordx4 v17, s[4:7], s40 offen lds
    s_add_u32 s32, s29, s45
    s_add_u32 m0, s32, 32768
    s_nop 0
    buffer_load_dwordx4 v18, s[8:11], s40 offen lds
    s_add_u32 m0, s32, 33792
    s_nop 0
    buffer_load_dwordx4 v19, s[8:11], s40 offen lds
    s_add_u32 m0, s32, 40960
    s_nop 0
    buffer_load_dwordx4 v18, s[12:15], s40 offen lds
    s_add_u32 m0, s32, 41984
    s_nop 0
    buffer_load_dwordx4 v19, s[12:15], s40 offen lds
    s_add_u32 s32, s29, s46
    s_add_u32 m0, s32, 49152
    s_nop 0
    buffer_load_dwordx4 v20, s[16:19], s41 offen lds
    s_add_u32 s40, s40, 128
    s_add_u32 s41, s41, 393216
    s_add_u32 s42, s42, 393216
    s_add_u32 s43, s43, 393216
    s_cmp_eq_u32 s40, 2048
    s_cselect_b32 s40, 0, s40
    s_cselect_b32 s41, 0, s41
    s_cselect_b32 s42, 2048, s42
    s_cselect_b32 s43, 4096, s43
    s_add_u32 s29, s29, 53248
    s_cmp_eq_u32 s29, 159744
    s_cselect_b32 s29, 0, s29
    s_add_u32 s32, s29, s44
    s_mov_b32 m0, s32
    s_nop 0
    buffer_load_dwordx4 v10, s[4:7], s40 offen lds
    s_add_u32 m0, s32, 1024
    s_nop 0
    buffer_load_dwordx4 v11, s[4:7], s40 offen lds
    s_add_u32 m0, s32, 2048
    s_nop 0
    buffer_load_dwordx4 v12, s[4:7], s40 offen lds
    s_add_u32 m0, s32, 3072
    s_nop 0
    buffer_load_dwordx4 v13, s[4:7], s40 offen lds
    s_add_u32 m0, s32, 4096
    s_nop 0
    buffer_load_dwordx4 v14, s[4:7], s40 offen lds
    s_add_u32 m0, s32, 5120
    s_nop 0
    buffer_load_dwordx4 v15, s[4:7], s40 offen lds
    s_add_u32 m0, s32, 6144
    s_nop 0
    buffer_load_dwordx4 v16, s[4:7], s40 offen lds
    s_add_u32 m0, s32, 7168
    s_nop 0
    buffer_load_dwordx4 v17, s[4:7], s40 offen lds
    s_add_u32 s32, s29, s45
    s_add_u32 m0, s32, 32768
    s_nop 0
    buffer_load_dwordx4 v18, s[8:11], s40 offen lds
    s_add_u32 m0, s32, 33792
    s_nop 0
    buffer_load_dwordx4 v19, s[8:11], s40 offen lds
    s_add_u32 m0, s32, 40960
    s_nop 0
    buffer_load_dwordx4 v18, s[12:15], s40 offen lds
    s_add_u32 m0, s32, 41984
    s_nop 0
    buffer_load_dwordx4 v19, s[12:15], s40 offen lds
    s_add_u32 s32, s29, s46
    s_add_u32 m0, s32, 49152
    s_nop 0
    buffer_load_dwordx4 v20, s[16:19], s41 offen lds
    s_add_u32 s40, s40, 128
    s_add_u32 s41, s41, 393216
    s_add_u32 s42, s42, 393216
    s_add_u32 s43, s43, 393216
    s_cmp_eq_u32 s40, 2048
    s_cselect_b32 s40, 0, s40
    s_cselect_b32 s41, 0, s41
    s_cselect_b32 s42, 2048, s42
    s_cselect_b32 s43, 4096, s43
    s_add_u32 s29, s29, 53248
    s_cmp_eq_u32 s29, 159744
    s_cselect_b32 s29, 0, s29
    s_mov_b32 s96, s16
    s_mov_b32 s97, s17
    s_mov_b32 s98, 6291456
    s_mov_b32 s99, 0x20000
    s_mov_b32 s95, 786432
    s_cmp_eq_u32 s24, 4
    s_cselect_b32 s96, s4, s96
    s_cselect_b32 s97, s5, s97
    s_cselect_b32 s98, 4194304, s98
    s_cselect_b32 s95, 256, s95
    s_cmp_eq_u32 s24, 5
    s_cselect_b32 s96, s8, s96
    s_cselect_b32 s97, s9, s97
    s_cselect_b32 s98, 2097152, s98
    s_cselect_b32 s95, 256, s95
    s_cmp_eq_u32 s24, 6
    s_cselect_b32 s96, s12, s96
    s_cselect_b32 s97, s13, s97
    s_cselect_b32 s98, 2097152, s98
    s_cselect_b32 s95, 256, s95
    v_and_b32 v240, 63, v0
    s_add_u32 s33, s31, 0
    s_and_b32 s33, s33, 31
    s_lshl_b32 s32, s3, 5
    s_add_u32 s32, s32, s33
    s_lshl_b32 s32, s32, 3
    v_and_b32 v243, 7, v240
    v_add_u32 v243, s32, v243
    v_lshlrev_b32 v243, 11, v243
    v_bfe_u32 v244, v240, 3, 1
    v_lshlrev_b32 v244, 7, v244
    v_add_u32 v243, v243, v244
    s_lshl_b32 s32, s2, 2
    v_and_b32 v245, 3, v240
    v_add_u32 v245, s32, v245
    v_lshlrev_b32 v245, 11, v245
    v_bfe_u32 v244, v240, 2, 1
    v_lshlrev_b32 v244, 7, v244
    v_add_u32 v245, v245, v244
    v_min_u32 v246, 23, v240
    v_cmp_lt_u32 vcc, 11, v246
    v_subrev_u32 v244, 12, v246
    s_nop 0
    v_cndmask_b32 v246, v246, v244, vcc
    s_mul_i32 s32, s2, 12
    v_add_u32 v246, s32, v246
    v_lshlrev_b32 v246, 7, v246
    v_mov_b32 v244, 393216
    v_cndmask_b32 v244, 0, v244, vcc
    v_add_u32 v246, v246, v244
    s_cmp_eq_u32 s24, 4
    s_cselect_b64 vcc, -1, 0
    v_cndmask_b32 v245, v245, v243, vcc
    s_cmp_eq_u32 s24, 7
    s_cselect_b64 vcc, -1, 0
    v_cndmask_b32 v241, v245, v246, vcc
    s_lshr_b32 s94, s95, 1
    s_mul_i32 s94, s94, 3
    v_lshlrev_b32 v242, 7, v240
    v_min_u32 v247, 63, v240
    v_lshlrev_b32 v247, 7, v247
    s_lshl_b32 s47, s2, 13
    s_cmp_eq_u32 s24, 7
    s_cselect_b32 s58, 341, 341
    buffer_load_dword v243, v241, s[96:99], s94 offen
    s_add_u32 s94, s94, s95
    buffer_load_dword v243, v241, s[96:99], s94 offen
    s_add_u32 s94, s94, s95
    s_waitcnt vmcnt(15)
    s_barrier
    s_add_u32 s32, s29, s44
    s_mov_b32 m0, s32
    s_nop 0
    buffer_load_dwordx4 v10, s[4:7], s40 offen lds
    s_add_u32 m0, s32, 1024
    s_nop 0
    buffer_load_dwordx4 v11, s[4:7], s40 offen lds
    s_add_u32 m0, s32, 2048
    s_nop 0
    buffer_load_dwordx4 v12, s[4:7], s40 offen lds
    s_add_u32 m0, s32, 3072
    s_nop 0
    buffer_load_dwordx4 v13, s[4:7], s40 offen lds
    s_add_u32 m0, s32, 4096
    s_nop 0
    buffer_load_dwordx4 v14, s[4:7], s40 offen lds
    s_add_u32 m0, s32, 5120
    s_nop 0
    buffer_load_dwordx4 v15, s[4:7], s40 offen lds
    s_add_u32 m0, s32, 6144
    s_nop 0
    buffer_load_dwordx4 v16, s[4:7], s40 offen lds
    s_add_u32 m0, s32, 7168
    s_nop 0
    buffer_load_dwordx4 v17, s[4:7], s40 offen lds
    s_add_u32 s32, s29, s45
    s_add_u32 m0, s32, 32768
    s_nop 0
    buffer_load_dwordx4 v18, s[8:11], s40 offen lds
    s_add_u32 m0, s32, 33792
    s_nop 0
    buffer_load_dwordx4 v19, s[8:11], s40 offen lds
    s_add_u32 m0, s32, 40960
    s_nop 0
    buffer_load_dwordx4 v18, s[12:15], s40 offen lds
    s_add_u32 m0, s32, 41984
    s_nop 0
    buffer_load_dwordx4 v19, s[12:15], s40 offen lds
    s_add_u32 s32, s29, s46
    s_add_u32 m0, s32, 49152
    s_nop 0
    buffer_load_dwordx4 v20, s[16:19], s41 offen lds
    s_add_u32 s40, s40, 128
    s_add_u32 s41, s41, 393216
    s_add_u32 s42, s42, 393216
    s_add_u32 s43, s43, 393216
    s_cmp_eq_u32 s40, 2048
    s_cselect_b32 s40, 0, s40
    s_cselect_b32 s41, 0, s41
    s_cselect_b32 s42, 2048, s42
    s_cselect_b32 s43, 4096, s43
    s_add_u32 s29, s29, 53248
    s_cmp_eq_u32 s29, 159744
    s_cselect_b32 s29, 0, s29
    s_lshl_b32 s32, s26, 7
    v_and_b32 v67, 63, v0
    v_lshlrev_b32 v67, 1, v67
    v_add_u32 v67, s32, v67
    buffer_load_ushort v64, v67, s[76:79], 0 offen
    buffer_load_ushort v65, v67, s[80:83], 0 offen
    buffer_load_ushort v66, v67, s[84:87], 0 offen
    s_waitcnt vmcnt(18)
    s_barrier
    s_add_u32 s32, s29, s44
    s_mov_b32 m0, s32
    s_nop 0
    buffer_load_dwordx4 v10, s[4:7], s40 offen lds
    s_add_u32 m0, s32, 1024
    s_nop 0
    buffer_load_dwordx4 v11, s[4:7], s40 offen lds
    s_add_u32 m0, s32, 2048
    s_nop 0
    buffer_load_dwordx4 v12, s[4:7], s40 offen lds
    s_add_u32 m0, s32, 3072
    s_nop 0
    buffer_load_dwordx4 v13, s[4:7], s40 offen lds
    s_add_u32 m0, s32, 4096
    s_nop 0
    buffer_load_dwordx4 v14, s[4:7], s40 offen lds
    s_add_u32 m0, s32, 5120
    s_nop 0
    buffer_load_dwordx4 v15, s[4:7], s40 offen lds
    s_add_u32 m0, s32, 6144
    s_nop 0
    buffer_load_dwordx4 v16, s[4:7], s40 offen lds
    s_add_u32 m0, s32, 7168
    s_nop 0
    buffer_load_dwordx4 v17, s[4:7], s40 offen lds
    s_add_u32 s32, s29, s45
    s_add_u32 m0, s32, 32768
    s_nop 0
    buffer_load_dwordx4 v18, s[8:11], s40 offen lds
    s_add_u32 m0, s32, 33792
    s_nop 0
    buffer_load_dwordx4 v19, s[8:11], s40 offen lds
    s_add_u32 m0, s32, 40960
    s_nop 0
    buffer_load_dwordx4 v18, s[12:15], s40 offen lds
    s_add_u32 m0, s32, 41984
    s_nop 0
    buffer_load_dwordx4 v19, s[12:15], s40 offen lds
    s_add_u32 s32, s29, s46
    s_add_u32 m0, s32, 49152
    s_nop 0
    buffer_load_dwordx4 v20, s[16:19], s41 offen lds
    s_add_u32 s40, s40, 128
    s_add_u32 s41, s41, 393216
    s_add_u32 s42, s42, 393216
    s_add_u32 s43, s43, 393216
    s_cmp_eq_u32 s40, 2048
    s_cselect_b32 s40, 0, s40
    s_cselect_b32 s41, 0, s41
    s_cselect_b32 s42, 2048, s42
    s_cselect_b32 s43, 4096, s43
    s_add_u32 s29, s29, 53248
    s_cmp_eq_u32 s29, 159744
    s_cselect_b32 s29, 0, s29
    s_mov_b32 s28, 0
    s_lshr_b32 s36, s58, s28
    s_bitcmp1_b32 s36, 0
    s_cselect_b32 s36, s94, 0x80000000
    s_cselect_b32 s37, s95, 0
    buffer_load_dword v243, v241, s[96:99], s36 offen
    s_add_u32 s94, s94, s37
    s_lshr_b32 s36, 4096, s28
    s_bitcmp1_b32 s36, 0
    s_cselect_b32 s36, s47, 0x80000000
    s_cselect_b32 s37, 8192, 0
    buffer_load_dword v244, v247, s[88:91], s36 offen
    s_add_u32 s47, s47, s37
    s_waitcnt vmcnt(18)
    s_waitcnt lgkmcnt(0)
    s_mul_i32 s68, s68, 0x9E3779B1
    s_add_u32 s68, s68, 0x7F4A7C15
    s_cmp_eq_u32 s68, 0
    s_cselect_b32 s68, 1, s68
    v_mov_b32 v86, s68
    v_mov_b32 v87, 0
    v_mov_b32 v89, 159768
    s_mov_b64 s[74:75], exec
    s_mov_b64 exec, 1
    ds_write_b64 v89, v[86:87]
    s_mov_b64 exec, s[74:75]
    s_waitcnt lgkmcnt(0)
    s_barrier
    s_add_u32 s32, s29, s44
    s_mov_b32 m0, s32
    s_nop 0
    buffer_load_dwordx4 v10, s[4:7], s40 offen lds
    s_add_u32 m0, s32, 1024
    s_nop 0
    buffer_load_dwordx4 v11, s[4:7], s40 offen lds
    s_add_u32 m0, s32, 2048
    s_nop 0
    buffer_load_dwordx4 v12, s[4:7], s40 offen lds
    s_add_u32 m0, s32, 3072
    s_nop 0
    buffer_load_dwordx4 v13, s[4:7], s40 offen lds
    s_add_u32 m0, s32, 4096
    s_nop 0
    buffer_load_dwordx4 v14, s[4:7], s40 offen lds
    s_add_u32 m0, s32, 5120
    s_nop 0
    buffer_load_dwordx4 v15, s[4:7], s40 offen lds
    s_add_u32 m0, s32, 6144
    s_nop 0
    buffer_load_dwordx4 v16, s[4:7], s40 offen lds
    s_add_u32 m0, s32, 7168
    s_nop 0
    buffer_load_dwordx4 v17, s[4:7], s40 offen lds
    s_add_u32 s32, s29, s45
    s_add_u32 m0, s32, 32768
    s_nop 0
    buffer_load_dwordx4 v18, s[8:11], s40 offen lds
    s_add_u32 m0, s32, 33792
    s_nop 0
    buffer_load_dwordx4 v19, s[8:11], s40 offen lds
    s_add_u32 m0, s32, 40960
    s_nop 0
    buffer_load_dwordx4 v18, s[12:15], s40 offen lds
    s_add_u32 m0, s32, 41984
    s_nop 0
    buffer_load_dwordx4 v19, s[12:15], s40 offen lds
    s_add_u32 s32, s29, s46
    s_add_u32 m0, s32, 49152
    s_nop 0
    buffer_load_dwordx4 v20, s[16:19], s41 offen lds
    s_add_u32 s40, s40, 128
    s_add_u32 s41, s41, 393216
    s_add_u32 s42, s42, 393216
    s_add_u32 s43, s43, 393216
    s_cmp_eq_u32 s40, 2048
    s_cselect_b32 s40, 0, s40
    s_cselect_b32 s41, 0, s41
    s_cselect_b32 s42, 2048, s42
    s_cselect_b32 s43, 4096, s43
    s_add_u32 s29, s29, 53248
    s_cmp_eq_u32 s29, 159744
    s_cselect_b32 s29, 0, s29
    s_mov_b32 s28, 1
    s_lshr_b32 s36, s58, s28
    s_bitcmp1_b32 s36, 0
    s_cselect_b32 s36, s94, 0x80000000
    s_cselect_b32 s37, s95, 0
    buffer_load_dword v243, v241, s[96:99], s36 offen
    s_add_u32 s94, s94, s37
    s_lshr_b32 s36, 4096, s28
    s_bitcmp1_b32 s36, 0
    s_cselect_b32 s36, s47, 0x80000000
    s_cselect_b32 s37, 8192, 0
    buffer_load_dword v244, v247, s[88:91], s36 offen
    s_add_u32 s47, s47, s37
    s_waitcnt vmcnt(17)
    s_getreg_b32 s93, hwreg(HW_REG_XCC_ID, 0, 4)
    s_lshl_b32 s32, s3, 5
    s_add_u32 s32, s32, s31
    s_lshl_b32 s32, s32, 3
    s_add_u32 s32, s32, 266600448
    v_mov_b32 v86, s93
    v_mov_b32 v87, s68
    v_mov_b32 v88, s32
    s_mov_b64 s[74:75], exec
    s_mov_b64 exec, 1
    buffer_store_dwordx2 v[86:87], v88, s[20:23], 0 offen sc1
    s_mov_b64 exec, s[74:75]
    v_lshlrev_b32 v64, 16, v64
    v_lshlrev_b32 v65, 16, v65
    v_lshlrev_b32 v66, 16, v66
    v_mul_f32 v66, 0x3fb8aa3b, v66
    v_exp_f32 v66, v66
    s_nop 0
    v_cvt_pk_bf16_f32 v68, v66, v66
    v_lshlrev_b32 v66, 16, v68
    v_mul_f32 v68, v66, v64
    v_mul_f32 v69, v66, v65
    v_mul_f32 v68, 0x3fb8aa3b, v68
    v_exp_f32 v68, v68
    v_mul_f32 v69, 0.15915494, v69
    v_fract_f32 v69, v69
    v_sin_f32 v74, v69
    v_cos_f32 v75, v69
    s_nop 0
    v_mul_f32 v76, v68, v75
    v_mul_f32 v77, v68, v74
    s_barrier
    s_add_u32 s32, s29, s44
    s_mov_b32 m0, s32
    s_nop 0
    buffer_load_dwordx4 v10, s[4:7], s40 offen lds
    s_add_u32 m0, s32, 1024
    s_nop 0
    buffer_load_dwordx4 v11, s[4:7], s40 offen lds
    s_add_u32 m0, s32, 2048
    s_nop 0
    buffer_load_dwordx4 v12, s[4:7], s40 offen lds
    s_add_u32 m0, s32, 3072
    s_nop 0
    buffer_load_dwordx4 v13, s[4:7], s40 offen lds
    s_add_u32 m0, s32, 4096
    s_nop 0
    buffer_load_dwordx4 v14, s[4:7], s40 offen lds
    s_add_u32 m0, s32, 5120
    s_nop 0
    buffer_load_dwordx4 v15, s[4:7], s40 offen lds
    s_add_u32 m0, s32, 6144
    s_nop 0
    buffer_load_dwordx4 v16, s[4:7], s40 offen lds
    s_add_u32 m0, s32, 7168
    s_nop 0
    buffer_load_dwordx4 v17, s[4:7], s40 offen lds
    s_add_u32 s32, s29, s45
    s_add_u32 m0, s32, 32768
    s_nop 0
    buffer_load_dwordx4 v18, s[8:11], s40 offen lds
    s_add_u32 m0, s32, 33792
    s_nop 0
    buffer_load_dwordx4 v19, s[8:11], s40 offen lds
    s_add_u32 m0, s32, 40960
    s_nop 0
    buffer_load_dwordx4 v18, s[12:15], s40 offen lds
    s_add_u32 m0, s32, 41984
    s_nop 0
    buffer_load_dwordx4 v19, s[12:15], s40 offen lds
    s_add_u32 s32, s29, s46
    s_add_u32 m0, s32, 49152
    s_nop 0
    buffer_load_dwordx4 v20, s[16:19], s41 offen lds
    s_add_u32 s40, s40, 128
    s_add_u32 s41, s41, 393216
    s_add_u32 s42, s42, 393216
    s_add_u32 s43, s43, 393216
    s_cmp_eq_u32 s40, 2048
    s_cselect_b32 s40, 0, s40
    s_cselect_b32 s41, 0, s41
    s_cselect_b32 s42, 2048, s42
    s_cselect_b32 s43, 4096, s43
    s_add_u32 s29, s29, 53248
    s_cmp_eq_u32 s29, 159744
    s_cselect_b32 s29, 0, s29
    s_mov_b32 s28, 2
    s_lshr_b32 s36, s58, s28
    s_bitcmp1_b32 s36, 0
    s_cselect_b32 s36, s94, 0x80000000
    s_cselect_b32 s37, s95, 0
    buffer_load_dword v243, v241, s[96:99], s36 offen
    s_add_u32 s94, s94, s37
    s_lshr_b32 s36, 4096, s28
    s_bitcmp1_b32 s36, 0
    s_cselect_b32 s36, s47, 0x80000000
    s_cselect_b32 s37, 8192, 0
    buffer_load_dword v244, v247, s[88:91], s36 offen
    s_add_u32 s47, s47, s37
    s_waitcnt vmcnt(17)
    v_add_f32 v74, -1.0, v76
    v_mul_f32 v75, v64, v64
    v_fma_f32 v75, v65, v65, v75
    v_rcp_f32 v75, v75
    v_mul_f32 v80, v74, v64
    v_fma_f32 v80, v77, v65, v80
    v_mul_f32 v81, v77, v64
    v_fma_f32 v81, -v74, v65, v81
    v_mul_f32 v80, v80, v75
    v_mul_f32 v81, v81, v75
    v_mov_b32 v232, v80
    v_mov_b32 v233, v81
    v_mul_f32 v82, v76, v77
    v_mul_f32 v83, v77, v77
    v_fma_f32 v78, v76, v76, -v83
    v_add_f32 v79, v82, v82
    v_mul_f32 v82, v78, v79
    v_mul_f32 v83, v79, v79
    v_fma_f32 v78, v78, v78, -v83
    s_barrier
    s_add_u32 s32, s29, s44
    s_mov_b32 m0, s32
    s_nop 0
    buffer_load_dwordx4 v10, s[4:7], s40 offen lds
    s_add_u32 m0, s32, 1024
    s_nop 0
    buffer_load_dwordx4 v11, s[4:7], s40 offen lds
    s_add_u32 m0, s32, 2048
    s_nop 0
    buffer_load_dwordx4 v12, s[4:7], s40 offen lds
    s_add_u32 m0, s32, 3072
    s_nop 0
    buffer_load_dwordx4 v13, s[4:7], s40 offen lds
    s_add_u32 m0, s32, 4096
    s_nop 0
    buffer_load_dwordx4 v14, s[4:7], s40 offen lds
    s_add_u32 m0, s32, 5120
    s_nop 0
    buffer_load_dwordx4 v15, s[4:7], s40 offen lds
    s_add_u32 m0, s32, 6144
    s_nop 0
    buffer_load_dwordx4 v16, s[4:7], s40 offen lds
    s_add_u32 m0, s32, 7168
    s_nop 0
    buffer_load_dwordx4 v17, s[4:7], s40 offen lds
    s_add_u32 s32, s29, s45
    s_add_u32 m0, s32, 32768
    s_nop 0
    buffer_load_dwordx4 v18, s[8:11], s40 offen lds
    s_add_u32 m0, s32, 33792
    s_nop 0
    buffer_load_dwordx4 v19, s[8:11], s40 offen lds
    s_add_u32 m0, s32, 40960
    s_nop 0
    buffer_load_dwordx4 v18, s[12:15], s40 offen lds
    s_add_u32 m0, s32, 41984
    s_nop 0
    buffer_load_dwordx4 v19, s[12:15], s40 offen lds
    s_add_u32 s32, s29, s46
    s_add_u32 m0, s32, 49152
    s_nop 0
    buffer_load_dwordx4 v20, s[16:19], s41 offen lds
    s_add_u32 s40, s40, 128
    s_add_u32 s41, s41, 393216
    s_add_u32 s42, s42, 393216
    s_add_u32 s43, s43, 393216
    s_cmp_eq_u32 s40, 2048
    s_cselect_b32 s40, 0, s40
    s_cselect_b32 s41, 0, s41
    s_cselect_b32 s42, 2048, s42
    s_cselect_b32 s43, 4096, s43
    s_add_u32 s29, s29, 53248
    s_cmp_eq_u32 s29, 159744
    s_cselect_b32 s29, 0, s29
    s_mov_b32 s28, 3
    s_lshr_b32 s36, s58, s28
    s_bitcmp1_b32 s36, 0
    s_cselect_b32 s36, s94, 0x80000000
    s_cselect_b32 s37, s95, 0
    buffer_load_dword v243, v241, s[96:99], s36 offen
    s_add_u32 s94, s94, s37
    s_lshr_b32 s36, 4096, s28
    s_bitcmp1_b32 s36, 0
    s_cselect_b32 s36, s47, 0x80000000
    s_cselect_b32 s37, 8192, 0
    buffer_load_dword v244, v247, s[88:91], s36 offen
    s_add_u32 s47, s47, s37
    s_waitcnt vmcnt(17)
    v_add_f32 v79, v82, v82
    v_mul_f32 v82, v78, v79
    v_mul_f32 v83, v79, v79
    v_fma_f32 v78, v78, v78, -v83
    v_add_f32 v79, v82, v82
    v_mul_f32 v82, v78, v79
    v_mul_f32 v83, v79, v79
    v_fma_f32 v70, v78, v78, -v83
    v_add_f32 v71, v82, v82
    v_mul_f32 v82, v70, v71
    v_mul_f32 v83, v71, v71
    v_fma_f32 v72, v70, v70, -v83
    v_add_f32 v73, v82, v82
    v_mul_f32 v82, v72, v73
    v_mul_f32 v83, v73, v73
    v_fma_f32 v72, v72, v72, -v83
    v_add_f32 v73, v82, v82
    v_mul_f32 v82, v72, v73
    v_mul_f32 v83, v73, v73
    s_barrier
    s_add_u32 s32, s29, s44
    s_mov_b32 m0, s32
    s_nop 0
    buffer_load_dwordx4 v10, s[4:7], s40 offen lds
    s_add_u32 m0, s32, 1024
    s_nop 0
    buffer_load_dwordx4 v11, s[4:7], s40 offen lds
    s_add_u32 m0, s32, 2048
    s_nop 0
    buffer_load_dwordx4 v12, s[4:7], s40 offen lds
    s_add_u32 m0, s32, 3072
    s_nop 0
    buffer_load_dwordx4 v13, s[4:7], s40 offen lds
    s_add_u32 m0, s32, 4096
    s_nop 0
    buffer_load_dwordx4 v14, s[4:7], s40 offen lds
    s_add_u32 m0, s32, 5120
    s_nop 0
    buffer_load_dwordx4 v15, s[4:7], s40 offen lds
    s_add_u32 m0, s32, 6144
    s_nop 0
    buffer_load_dwordx4 v16, s[4:7], s40 offen lds
    s_add_u32 m0, s32, 7168
    s_nop 0
    buffer_load_dwordx4 v17, s[4:7], s40 offen lds
    s_add_u32 s32, s29, s45
    s_add_u32 m0, s32, 32768
    s_nop 0
    buffer_load_dwordx4 v18, s[8:11], s40 offen lds
    s_add_u32 m0, s32, 33792
    s_nop 0
    buffer_load_dwordx4 v19, s[8:11], s40 offen lds
    s_add_u32 m0, s32, 40960
    s_nop 0
    buffer_load_dwordx4 v18, s[12:15], s40 offen lds
    s_add_u32 m0, s32, 41984
    s_nop 0
    buffer_load_dwordx4 v19, s[12:15], s40 offen lds
    s_add_u32 s32, s29, s46
    s_add_u32 m0, s32, 49152
    s_nop 0
    buffer_load_dwordx4 v20, s[16:19], s41 offen lds
    s_add_u32 s40, s40, 128
    s_add_u32 s41, s41, 393216
    s_add_u32 s42, s42, 393216
    s_add_u32 s43, s43, 393216
    s_cmp_eq_u32 s40, 2048
    s_cselect_b32 s40, 0, s40
    s_cselect_b32 s41, 0, s41
    s_cselect_b32 s42, 2048, s42
    s_cselect_b32 s43, 4096, s43
    s_add_u32 s29, s29, 53248
    s_cmp_eq_u32 s29, 159744
    s_cselect_b32 s29, 0, s29
    s_mov_b32 s28, 4
    s_lshr_b32 s36, s58, s28
    s_bitcmp1_b32 s36, 0
    s_cselect_b32 s36, s94, 0x80000000
    s_cselect_b32 s37, s95, 0
    buffer_load_dword v243, v241, s[96:99], s36 offen
    s_add_u32 s94, s94, s37
    s_lshr_b32 s36, 4096, s28
    s_bitcmp1_b32 s36, 0
    s_cselect_b32 s36, s47, 0x80000000
    s_cselect_b32 s37, 8192, 0
    buffer_load_dword v244, v247, s[88:91], s36 offen
    s_add_u32 s47, s47, s37
    s_waitcnt vmcnt(17)
    v_fma_f32 v72, v72, v72, -v83
    v_add_f32 v73, v82, v82
    v_mul_f32 v82, v72, v73
    v_mul_f32 v83, v73, v73
    v_fma_f32 v72, v72, v72, -v83
    v_add_f32 v73, v82, v82
    v_and_b32 v82, 63, v0
    v_lshlrev_b32 v82, 5, v82
    v_add_u32 v82, 159744, v82
    ds_write_b128 v82, v[76:79]
    ds_write_b64 v82, v[80:81] offset:16
    v_mov_b32 v200, 1.0
    v_mov_b32 v201, 0
    v_mov_b32 v202, v70
    v_mov_b32 v203, v71
    v_mul_f32 v204, v202, v70
    v_mul_f32 v205, v202, v71
    v_fma_f32 v204, -v203, v71, v204
    v_fma_f32 v205, v203, v70, v205
    s_barrier
    s_add_u32 s32, s29, s44
    s_mov_b32 m0, s32
    s_nop 0
    buffer_load_dwordx4 v10, s[4:7], s40 offen lds
    s_add_u32 m0, s32, 1024
    s_nop 0
    buffer_load_dwordx4 v11, s[4:7], s40 offen lds
    s_add_u32 m0, s32, 2048
    s_nop 0
    buffer_load_dwordx4 v12, s[4:7], s40 offen lds
    s_add_u32 m0, s32, 3072
    s_nop 0
    buffer_load_dwordx4 v13, s[4:7], s40 offen lds
    s_add_u32 m0, s32, 4096
    s_nop 0
    buffer_load_dwordx4 v14, s[4:7], s40 offen lds
    s_add_u32 m0, s32, 5120
    s_nop 0
    buffer_load_dwordx4 v15, s[4:7], s40 offen lds
    s_add_u32 m0, s32, 6144
    s_nop 0
    buffer_load_dwordx4 v16, s[4:7], s40 offen lds
    s_add_u32 m0, s32, 7168
    s_nop 0
    buffer_load_dwordx4 v17, s[4:7], s40 offen lds
    s_add_u32 s32, s29, s45
    s_add_u32 m0, s32, 32768
    s_nop 0
    buffer_load_dwordx4 v18, s[8:11], s40 offen lds
    s_add_u32 m0, s32, 33792
    s_nop 0
    buffer_load_dwordx4 v19, s[8:11], s40 offen lds
    s_add_u32 m0, s32, 40960
    s_nop 0
    buffer_load_dwordx4 v18, s[12:15], s40 offen lds
    s_add_u32 m0, s32, 41984
    s_nop 0
    buffer_load_dwordx4 v19, s[12:15], s40 offen lds
    s_add_u32 s32, s29, s46
    s_add_u32 m0, s32, 49152
    s_nop 0
    buffer_load_dwordx4 v20, s[16:19], s41 offen lds
    s_add_u32 s40, s40, 128
    s_add_u32 s41, s41, 393216
    s_add_u32 s42, s42, 393216
    s_add_u32 s43, s43, 393216
    s_cmp_eq_u32 s40, 2048
    s_cselect_b32 s40, 0, s40
    s_cselect_b32 s41, 0, s41
    s_cselect_b32 s42, 2048, s42
    s_cselect_b32 s43, 4096, s43
    s_add_u32 s29, s29, 53248
    s_cmp_eq_u32 s29, 159744
    s_cselect_b32 s29, 0, s29
    s_mov_b32 s28, 5
    s_lshr_b32 s36, s58, s28
    s_bitcmp1_b32 s36, 0
    s_cselect_b32 s36, s94, 0x80000000
    s_cselect_b32 s37, s95, 0
    buffer_load_dword v243, v241, s[96:99], s36 offen
    s_add_u32 s94, s94, s37
    s_lshr_b32 s36, 4096, s28
    s_bitcmp1_b32 s36, 0
    s_cselect_b32 s36, s47, 0x80000000
    s_cselect_b32 s37, 8192, 0
    buffer_load_dword v244, v247, s[88:91], s36 offen
    s_add_u32 s47, s47, s37
    s_waitcnt vmcnt(17)
    v_mul_f32 v206, v204, v70
    v_mul_f32 v207, v204, v71
    v_fma_f32 v206, -v205, v71, v206
    v_fma_f32 v207, v205, v70, v207
    v_mul_f32 v208, v206, v70
    v_mul_f32 v209, v206, v71
    v_fma_f32 v208, -v207, v71, v208
    v_fma_f32 v209, v207, v70, v209
    v_mul_f32 v210, v208, v70
    v_mul_f32 v211, v208, v71
    v_fma_f32 v210, -v209, v71, v210
    v_fma_f32 v211, v209, v70, v211
    v_mul_f32 v212, v210, v70
    v_mul_f32 v213, v210, v71
    v_fma_f32 v212, -v211, v71, v212
    v_fma_f32 v213, v211, v70, v213
    v_mul_f32 v214, v212, v70
    v_mul_f32 v215, v212, v71
    v_fma_f32 v214, -v213, v71, v214
    s_barrier
    s_add_u32 s32, s29, s44
    s_mov_b32 m0, s32
    s_nop 0
    buffer_load_dwordx4 v10, s[4:7], s40 offen lds
    s_add_u32 m0, s32, 1024
    s_nop 0
    buffer_load_dwordx4 v11, s[4:7], s40 offen lds
    s_add_u32 m0, s32, 2048
    s_nop 0
    buffer_load_dwordx4 v12, s[4:7], s40 offen lds
    s_add_u32 m0, s32, 3072
    s_nop 0
    buffer_load_dwordx4 v13, s[4:7], s40 offen lds
    s_add_u32 m0, s32, 4096
    s_nop 0
    buffer_load_dwordx4 v14, s[4:7], s40 offen lds
    s_add_u32 m0, s32, 5120
    s_nop 0
    buffer_load_dwordx4 v15, s[4:7], s40 offen lds
    s_add_u32 m0, s32, 6144
    s_nop 0
    buffer_load_dwordx4 v16, s[4:7], s40 offen lds
    s_add_u32 m0, s32, 7168
    s_nop 0
    buffer_load_dwordx4 v17, s[4:7], s40 offen lds
    s_add_u32 s32, s29, s45
    s_add_u32 m0, s32, 32768
    s_nop 0
    buffer_load_dwordx4 v18, s[8:11], s40 offen lds
    s_add_u32 m0, s32, 33792
    s_nop 0
    buffer_load_dwordx4 v19, s[8:11], s40 offen lds
    s_add_u32 m0, s32, 40960
    s_nop 0
    buffer_load_dwordx4 v18, s[12:15], s40 offen lds
    s_add_u32 m0, s32, 41984
    s_nop 0
    buffer_load_dwordx4 v19, s[12:15], s40 offen lds
    s_add_u32 s32, s29, s46
    s_add_u32 m0, s32, 49152
    s_nop 0
    buffer_load_dwordx4 v20, s[16:19], s41 offen lds
    s_add_u32 s40, s40, 128
    s_add_u32 s41, s41, 393216
    s_add_u32 s42, s42, 393216
    s_add_u32 s43, s43, 393216
    s_cmp_eq_u32 s40, 2048
    s_cselect_b32 s40, 0, s40
    s_cselect_b32 s41, 0, s41
    s_cselect_b32 s42, 2048, s42
    s_cselect_b32 s43, 4096, s43
    s_add_u32 s29, s29, 53248
    s_cmp_eq_u32 s29, 159744
    s_cselect_b32 s29, 0, s29
    s_mov_b32 s28, 6
    s_lshr_b32 s36, s58, s28
    s_bitcmp1_b32 s36, 0
    s_cselect_b32 s36, s94, 0x80000000
    s_cselect_b32 s37, s95, 0
    buffer_load_dword v243, v241, s[96:99], s36 offen
    s_add_u32 s94, s94, s37
    s_lshr_b32 s36, 4096, s28
    s_bitcmp1_b32 s36, 0
    s_cselect_b32 s36, s47, 0x80000000
    s_cselect_b32 s37, 8192, 0
    buffer_load_dword v244, v247, s[88:91], s36 offen
    s_add_u32 s47, s47, s37
    s_waitcnt vmcnt(17)
    v_fma_f32 v215, v213, v70, v215
    v_mul_f32 v216, v214, v70
    v_mul_f32 v217, v214, v71
    v_fma_f32 v216, -v215, v71, v216
    v_fma_f32 v217, v215, v70, v217
    v_mul_f32 v218, v216, v70
    v_mul_f32 v219, v216, v71
    v_fma_f32 v218, -v217, v71, v218
    v_fma_f32 v219, v217, v70, v219
    v_mul_f32 v220, v218, v70
    v_mul_f32 v221, v218, v71
    v_fma_f32 v220, -v219, v71, v220
    v_fma_f32 v221, v219, v70, v221
    v_mul_f32 v222, v220, v70
    v_mul_f32 v223, v220, v71
    v_fma_f32 v222, -v221, v71, v222
    v_fma_f32 v223, v221, v70, v223
    v_mul_f32 v224, v222, v70
    v_mul_f32 v225, v222, v71
    s_barrier
    s_add_u32 s32, s29, s44
    s_mov_b32 m0, s32
    s_nop 0
    buffer_load_dwordx4 v10, s[4:7], s40 offen lds
    s_add_u32 m0, s32, 1024
    s_nop 0
    buffer_load_dwordx4 v11, s[4:7], s40 offen lds
    s_add_u32 m0, s32, 2048
    s_nop 0
    buffer_load_dwordx4 v12, s[4:7], s40 offen lds
    s_add_u32 m0, s32, 3072
    s_nop 0
    buffer_load_dwordx4 v13, s[4:7], s40 offen lds
    s_add_u32 m0, s32, 4096
    s_nop 0
    buffer_load_dwordx4 v14, s[4:7], s40 offen lds
    s_add_u32 m0, s32, 5120
    s_nop 0
    buffer_load_dwordx4 v15, s[4:7], s40 offen lds
    s_add_u32 m0, s32, 6144
    s_nop 0
    buffer_load_dwordx4 v16, s[4:7], s40 offen lds
    s_add_u32 m0, s32, 7168
    s_nop 0
    buffer_load_dwordx4 v17, s[4:7], s40 offen lds
    s_add_u32 s32, s29, s45
    s_add_u32 m0, s32, 32768
    s_nop 0
    buffer_load_dwordx4 v18, s[8:11], s40 offen lds
    s_add_u32 m0, s32, 33792
    s_nop 0
    buffer_load_dwordx4 v19, s[8:11], s40 offen lds
    s_add_u32 m0, s32, 40960
    s_nop 0
    buffer_load_dwordx4 v18, s[12:15], s40 offen lds
    s_add_u32 m0, s32, 41984
    s_nop 0
    buffer_load_dwordx4 v19, s[12:15], s40 offen lds
    s_add_u32 s32, s29, s46
    s_add_u32 m0, s32, 49152
    s_nop 0
    buffer_load_dwordx4 v20, s[16:19], s41 offen lds
    s_add_u32 s40, s40, 128
    s_add_u32 s41, s41, 393216
    s_add_u32 s42, s42, 393216
    s_add_u32 s43, s43, 393216
    s_cmp_eq_u32 s40, 2048
    s_cselect_b32 s40, 0, s40
    s_cselect_b32 s41, 0, s41
    s_cselect_b32 s42, 2048, s42
    s_cselect_b32 s43, 4096, s43
    s_add_u32 s29, s29, 53248
    s_cmp_eq_u32 s29, 159744
    s_cselect_b32 s29, 0, s29
    s_mov_b32 s28, 7
    s_lshr_b32 s36, s58, s28
    s_bitcmp1_b32 s36, 0
    s_cselect_b32 s36, s94, 0x80000000
    s_cselect_b32 s37, s95, 0
    buffer_load_dword v243, v241, s[96:99], s36 offen
    s_add_u32 s94, s94, s37
    s_lshr_b32 s36, 4096, s28
    s_bitcmp1_b32 s36, 0
    s_cselect_b32 s36, s47, 0x80000000
    s_cselect_b32 s37, 8192, 0
    buffer_load_dword v244, v247, s[88:91], s36 offen
    s_add_u32 s47, s47, s37
    s_waitcnt vmcnt(17)
    v_fma_f32 v224, -v223, v71, v224
    v_fma_f32 v225, v223, v70, v225
    v_mul_f32 v226, v224, v70
    v_mul_f32 v227, v224, v71
    v_fma_f32 v226, -v225, v71, v226
    v_fma_f32 v227, v225, v70, v227
    v_mul_f32 v228, v226, v70
    v_mul_f32 v229, v226, v71
    v_fma_f32 v228, -v227, v71, v228
    v_fma_f32 v229, v227, v70, v229
    v_mul_f32 v230, v228, v70
    v_mul_f32 v231, v228, v71
    v_fma_f32 v230, -v229, v71, v230
    v_fma_f32 v231, v229, v70, v231
    s_waitcnt lgkmcnt(0)
    s_barrier
    s_add_u32 s32, s29, s44
    s_mov_b32 m0, s32
    s_nop 0
    buffer_load_dwordx4 v10, s[4:7], s40 offen lds
    s_add_u32 m0, s32, 1024
    s_nop 0
    buffer_load_dwordx4 v11, s[4:7], s40 offen lds
    s_add_u32 m0, s32, 2048
    s_nop 0
    buffer_load_dwordx4 v12, s[4:7], s40 offen lds
    s_add_u32 m0, s32, 3072
    s_nop 0
    buffer_load_dwordx4 v13, s[4:7], s40 offen lds
    s_add_u32 m0, s32, 4096
    s_nop 0
    buffer_load_dwordx4 v14, s[4:7], s40 offen lds
    s_add_u32 m0, s32, 5120
    s_nop 0
    buffer_load_dwordx4 v15, s[4:7], s40 offen lds
    s_add_u32 m0, s32, 6144
    s_nop 0
    buffer_load_dwordx4 v16, s[4:7], s40 offen lds
    s_add_u32 m0, s32, 7168
    s_nop 0
    buffer_load_dwordx4 v17, s[4:7], s40 offen lds
    s_add_u32 s32, s29, s45
    s_add_u32 m0, s32, 32768
    s_nop 0
    buffer_load_dwordx4 v18, s[8:11], s40 offen lds
    s_add_u32 m0, s32, 33792
    s_nop 0
    buffer_load_dwordx4 v19, s[8:11], s40 offen lds
    s_add_u32 m0, s32, 40960
    s_nop 0
    buffer_load_dwordx4 v18, s[12:15], s40 offen lds
    s_add_u32 m0, s32, 41984
    s_nop 0
    buffer_load_dwordx4 v19, s[12:15], s40 offen lds
    s_add_u32 s32, s29, s46
    s_add_u32 m0, s32, 49152
    s_nop 0
    buffer_load_dwordx4 v20, s[16:19], s41 offen lds
    s_add_u32 s40, s40, 128
    s_add_u32 s41, s41, 393216
    s_add_u32 s42, s42, 393216
    s_add_u32 s43, s43, 393216
    s_cmp_eq_u32 s40, 2048
    s_cselect_b32 s40, 0, s40
    s_cselect_b32 s41, 0, s41
    s_cselect_b32 s42, 2048, s42
    s_cselect_b32 s43, 4096, s43
    s_add_u32 s29, s29, 53248
    s_cmp_eq_u32 s29, 159744
    s_cselect_b32 s29, 0, s29
    s_mov_b32 s28, 8
    s_lshr_b32 s36, s58, s28
    s_bitcmp1_b32 s36, 0
    s_cselect_b32 s36, s94, 0x80000000
    s_cselect_b32 s37, s95, 0
    buffer_load_dword v243, v241, s[96:99], s36 offen
    s_add_u32 s94, s94, s37
    s_lshr_b32 s36, 4096, s28
    s_bitcmp1_b32 s36, 0
    s_cselect_b32 s36, s47, 0x80000000
    s_cselect_b32 s37, 8192, 0
    buffer_load_dword v244, v247, s[88:91], s36 offen
    s_add_u32 s47, s47, s37
    s_waitcnt vmcnt(17)
    s_lshl_b32 s32, s25, 8
    s_add_u32 s87, s32, 266600448
    v_and_b32 v84, 31, v0
    v_lshlrev_b32 v84, 3, v84
    buffer_load_dwordx2 v[86:87], v84, s[20:23], s87 offen sc1
    s_barrier
    s_add_u32 s32, s29, s44
    s_mov_b32 m0, s32
    s_nop 0
    buffer_load_dwordx4 v10, s[4:7], s40 offen lds
    s_add_u32 m0, s32, 1024
    s_nop 0
    buffer_load_dwordx4 v11, s[4:7], s40 offen lds
    s_add_u32 m0, s32, 2048
    s_nop 0
    buffer_load_dwordx4 v12, s[4:7], s40 offen lds
    s_add_u32 m0, s32, 3072
    s_nop 0
    buffer_load_dwordx4 v13, s[4:7], s40 offen lds
    s_add_u32 m0, s32, 4096
    s_nop 0
    buffer_load_dwordx4 v14, s[4:7], s40 offen lds
    s_add_u32 m0, s32, 5120
    s_nop 0
    buffer_load_dwordx4 v15, s[4:7], s40 offen lds
    s_add_u32 m0, s32, 6144
    s_nop 0
    buffer_load_dwordx4 v16, s[4:7], s40 offen lds
    s_add_u32 m0, s32, 7168
    s_nop 0
    buffer_load_dwordx4 v17, s[4:7], s40 offen lds
    s_add_u32 s32, s29, s45
    s_add_u32 m0, s32, 32768
    s_nop 0
    buffer_load_dwordx4 v18, s[8:11], s40 offen lds
    s_add_u32 m0, s32, 33792
    s_nop 0
    buffer_load_dwordx4 v19, s[8:11], s40 offen lds
    s_add_u32 m0, s32, 40960
    s_nop 0
    buffer_load_dwordx4 v18, s[12:15], s40 offen lds
    s_add_u32 m0, s32, 41984
    s_nop 0
    buffer_load_dwordx4 v19, s[12:15], s40 offen lds
    s_add_u32 s32, s29, s46
    s_add_u32 m0, s32, 49152
    s_nop 0
    buffer_load_dwordx4 v20, s[16:19], s41 offen lds
    s_add_u32 s40, s40, 128
    s_add_u32 s41, s41, 393216
    s_add_u32 s42, s42, 393216
    s_add_u32 s43, s43, 393216
    s_cmp_eq_u32 s40, 2048
    s_cselect_b32 s40, 0, s40
    s_cselect_b32 s41, 0, s41
    s_cselect_b32 s42, 2048, s42
    s_cselect_b32 s43, 4096, s43
    s_add_u32 s29, s29, 53248
    s_cmp_eq_u32 s29, 159744
    s_cselect_b32 s29, 0, s29
    s_mov_b32 s28, 9
    s_lshr_b32 s36, s58, s28
    s_bitcmp1_b32 s36, 0
    s_cselect_b32 s36, s94, 0x80000000
    s_cselect_b32 s37, s95, 0
    buffer_load_dword v243, v241, s[96:99], s36 offen
    s_add_u32 s94, s94, s37
    s_lshr_b32 s36, 4096, s28
    s_bitcmp1_b32 s36, 0
    s_cselect_b32 s36, s47, 0x80000000
    s_cselect_b32 s37, 8192, 0
    buffer_load_dword v244, v247, s[88:91], s36 offen
    s_add_u32 s47, s47, s37
    s_waitcnt vmcnt(17)
    s_waitcnt vmcnt(15)
    s_mov_b32 s33, 0
L_xc_5:
    v_cmp_eq_u32 vcc, s68, v87
    s_cmp_eq_u64 vcc, exec
    s_cbranch_scc1 L_xcok_6
    buffer_load_dwordx2 v[86:87], v84, s[20:23], s87 offen sc1
    s_waitcnt vmcnt(0)
    s_add_u32 s33, s33, 1
    s_cmp_lt_u32 s33, 131072
    s_cbranch_scc1 L_xc_5
L_xcok_6:
    v_cmp_eq_u32 vcc, s93, v86
    s_cmp_eq_u64 vcc, exec
    s_cselect_b32 s92, 0, 1
    s_mov_b32 s28, 10
L_ploopAy:
    s_barrier
    s_add_u32 s32, s29, s44
    s_mov_b32 m0, s32
    s_nop 0
    buffer_load_dwordx4 v10, s[4:7], s40 offen lds
    s_add_u32 m0, s32, 1024
    s_nop 0
    buffer_load_dwordx4 v11, s[4:7], s40 offen lds
    s_add_u32 m0, s32, 2048
    s_nop 0
    buffer_load_dwordx4 v12, s[4:7], s40 offen lds
    s_add_u32 m0, s32, 3072
    s_nop 0
    buffer_load_dwordx4 v13, s[4:7], s40 offen lds
    s_add_u32 m0, s32, 4096
    s_nop 0
    buffer_load_dwordx4 v14, s[4:7], s40 offen lds
    s_add_u32 m0, s32, 5120
    s_nop 0
    buffer_load_dwordx4 v15, s[4:7], s40 offen lds
    s_add_u32 m0, s32, 6144
    s_nop 0
    buffer_load_dwordx4 v16, s[4:7], s40 offen lds
    s_add_u32 m0, s32, 7168
    s_nop 0
    buffer_load_dwordx4 v17, s[4:7], s40 offen lds
    s_add_u32 s32, s29, s45
    s_add_u32 m0, s32, 32768
    s_nop 0
    buffer_load_dwordx4 v18, s[8:11], s40 offen lds
    s_add_u32 m0, s32, 33792
    s_nop 0
    buffer_load_dwordx4 v19, s[8:11], s40 offen lds
    s_add_u32 m0, s32, 40960
    s_nop 0
    buffer_load_dwordx4 v18, s[12:15], s40 offen lds
    s_add_u32 m0, s32, 41984
    s_nop 0
    buffer_load_dwordx4 v19, s[12:15], s40 offen lds
    s_add_u32 s32, s29, s46
    s_add_u32 m0, s32, 49152
    s_nop 0
    buffer_load_dwordx4 v20, s[16:19], s41 offen lds
    s_add_u32 s40, s40, 128
    s_add_u32 s41, s41, 393216
    s_add_u32 s42, s42, 393216
    s_add_u32 s43, s43, 393216
    s_cmp_eq_u32 s40, 2048
    s_cselect_b32 s40, 0, s40
    s_cselect_b32 s41, 0, s41
    s_cselect_b32 s42, 2048, s42
    s_cselect_b32 s43, 4096, s43
    s_add_u32 s29, s29, 53248
    s_cmp_eq_u32 s29, 159744
    s_cselect_b32 s29, 0, s29
    s_lshr_b32 s36, s58, s28
    s_bitcmp1_b32 s36, 0
    s_cselect_b32 s36, s94, 0x80000000
    s_cselect_b32 s37, s95, 0
    buffer_load_dword v243, v241, s[96:99], s36 offen
    s_add_u32 s94, s94, s37
    s_lshr_b32 s36, 4096, s28
    s_bitcmp1_b32 s36, 0
    s_cselect_b32 s36, s47, 0x80000000
    s_cselect_b32 s37, 8192, 0
    buffer_load_dword v244, v247, s[88:91], s36 offen
    s_add_u32 s47, s47, s37
    s_waitcnt vmcnt(17)
    s_add_u32 s28, s28, 1
    s_cmp_lt_u32 s28, 13
    s_cbranch_scc1 L_ploopAy
    s_barrier
    s_waitcnt vmcnt(0)
    s_cmp_lg_u32 s24, 7
    s_cbranch_scc1 L_cp_7
    s_getpc_b64 s[32:33]
L_pc_8:
    s_sub_u32 s32, s32, L_pc_8-gated_mix__ssm_conv_s5__linear_attn_block__prompt_kernel
    s_subb_u32 s33, s33, 0
    s_lshl_b32 s34, s31, 4
    v_and_b32 v245, 15, v0
    v_add_u32 v245, s34, v245
    v_lshlrev_b32 v245, 7, v245
    v_min_u32 v245, L_end-gated_mix__ssm_conv_s5__linear_attn_block__prompt_kernel, v245
    global_load_dword v246, v245, s[32:33]
L_cp_7:
    s_barrier
    s_barrier
    v_and_b32 v10, 63, v0
    v_lshlrev_b32 v10, 3, v10
    ds_write_b64 v10, v[200:201] offset:8192
    ds_write_b64 v10, v[202:203] offset:8704
    ds_write_b64 v10, v[204:205] offset:9216
    ds_write_b64 v10, v[206:207] offset:9728
    ds_write_b64 v10, v[208:209] offset:10240
    ds_write_b64 v10, v[210:211] offset:10752
    ds_write_b64 v10, v[212:213] offset:11264
    ds_write_b64 v10, v[214:215] offset:11776
    ds_write_b64 v10, v[216:217] offset:12288
    ds_write_b64 v10, v[218:219] offset:12800
    ds_write_b64 v10, v[220:221] offset:13312
    ds_write_b64 v10, v[222:223] offset:13824
    ds_write_b64 v10, v[224:225] offset:14336
    ds_write_b64 v10, v[226:227] offset:14848
    ds_write_b64 v10, v[228:229] offset:15360
    ds_write_b64 v10, v[230:231] offset:15872
    s_lshl_b32 s32, s26, 13
    s_add_u32 s32, s32, 266403840
    s_lshl_b32 s33, s25, 10
    s_add_u32 s33, s33, s32
    v_lshlrev_b32 v11, 1, v10
    v_add_u32 v18, 4096, v11
    v_mov_b32 v13, s68
    v_mov_b32 v15, s68
    s_waitcnt lgkmcnt(0)
    s_barrier
    ds_read_b64 v[100:101], v10 offset:0
    ds_read_b64 v[102:103], v10 offset:512
    ds_read_b64 v[104:105], v10 offset:1024
    ds_read_b64 v[106:107], v10 offset:1536
    ds_read_b64 v[108:109], v10 offset:2048
    ds_read_b64 v[110:111], v10 offset:2560
    ds_read_b64 v[112:113], v10 offset:3072
    ds_read_b64 v[114:115], v10 offset:3584
    ds_read_b64 v[116:117], v10 offset:4096
    ds_read_b64 v[118:119], v10 offset:4608
    ds_read_b64 v[120:121], v10 offset:5120
    ds_read_b64 v[122:123], v10 offset:5632
    ds_read_b64 v[124:125], v10 offset:6144
    ds_read_b64 v[126:127], v10 offset:6656
    ds_read_b64 v[128:129], v10 offset:7168
    ds_read_b64 v[130:131], v10 offset:7680
    s_waitcnt lgkmcnt(15)
    v_mov_b32 v142, v100
    v_mov_b32 v143, v101
    s_waitcnt lgkmcnt(14)
    v_fma_f32 v144, v70, v142, v102
    v_fma_f32 v145, v70, v143, v103
    v_fma_f32 v144, -v71, v143, v144
    v_fma_f32 v145, v71, v142, v145
    s_waitcnt lgkmcnt(13)
    v_fma_f32 v146, v70, v144, v104
    v_fma_f32 v147, v70, v145, v105
    v_fma_f32 v146, -v71, v145, v146
    v_fma_f32 v147, v71, v144, v147
    s_waitcnt lgkmcnt(12)
    v_fma_f32 v148, v70, v146, v106
    v_fma_f32 v149, v70, v147, v107
    v_fma_f32 v148, -v71, v147, v148
    v_fma_f32 v149, v71, v146, v149
    s_waitcnt lgkmcnt(11)
    v_fma_f32 v150, v70, v148, v108
    v_fma_f32 v151, v70, v149, v109
    v_fma_f32 v150, -v71, v149, v150
    v_fma_f32 v151, v71, v148, v151
    s_waitcnt lgkmcnt(10)
    v_fma_f32 v152, v70, v150, v110
    v_fma_f32 v153, v70, v151, v111
    v_fma_f32 v152, -v71, v151, v152
    v_fma_f32 v153, v71, v150, v153
    s_waitcnt lgkmcnt(9)
    v_fma_f32 v154, v70, v152, v112
    v_fma_f32 v155, v70, v153, v113
    v_fma_f32 v154, -v71, v153, v154
    v_fma_f32 v155, v71, v152, v155
    s_waitcnt lgkmcnt(8)
    v_fma_f32 v156, v70, v154, v114
    v_fma_f32 v157, v70, v155, v115
    v_fma_f32 v156, -v71, v155, v156
    v_fma_f32 v157, v71, v154, v157
    s_waitcnt lgkmcnt(7)
    v_fma_f32 v158, v70, v156, v116
    v_fma_f32 v159, v70, v157, v117
    v_fma_f32 v158, -v71, v157, v158
    v_fma_f32 v159, v71, v156, v159
    s_waitcnt lgkmcnt(6)
    v_fma_f32 v160, v70, v158, v118
    v_fma_f32 v161, v70, v159, v119
    v_fma_f32 v160, -v71, v159, v160
    v_fma_f32 v161, v71, v158, v161
    s_waitcnt lgkmcnt(5)
    v_fma_f32 v162, v70, v160, v120
    v_fma_f32 v163, v70, v161, v121
    v_fma_f32 v162, -v71, v161, v162
    v_fma_f32 v163, v71, v160, v163
    s_waitcnt lgkmcnt(4)
    v_fma_f32 v164, v70, v162, v122
    v_fma_f32 v165, v70, v163, v123
    v_fma_f32 v164, -v71, v163, v164
    v_fma_f32 v165, v71, v162, v165
    s_waitcnt lgkmcnt(3)
    v_fma_f32 v166, v70, v164, v124
    v_fma_f32 v167, v70, v165, v125
    v_fma_f32 v166, -v71, v165, v166
    v_fma_f32 v167, v71, v164, v167
    s_waitcnt lgkmcnt(2)
    v_fma_f32 v168, v70, v166, v126
    v_fma_f32 v169, v70, v167, v127
    v_fma_f32 v168, -v71, v167, v168
    v_fma_f32 v169, v71, v166, v169
    s_waitcnt lgkmcnt(1)
    v_fma_f32 v170, v70, v168, v128
    v_fma_f32 v171, v70, v169, v129
    v_fma_f32 v170, -v71, v169, v170
    v_fma_f32 v171, v71, v168, v171
    s_waitcnt lgkmcnt(0)
    v_fma_f32 v172, v70, v170, v130
    v_fma_f32 v173, v70, v171, v131
    v_fma_f32 v172, -v71, v171, v172
    v_fma_f32 v173, v71, v170, v173
    v_mov_b32 v12, v172
    v_mov_b32 v14, v173
    buffer_store_dwordx4 v[12:15], v11, s[20:23], s33 offen sc1
    v_mov_b32 v20, 0
    v_mov_b32 v21, 0
    s_cmp_lg_u32 s25, 0
    s_cbranch_scc1 L_nz_11
    v_mov_b32 v100, 0
    v_mov_b32 v101, 0
    v_mul_f32 v102, v142, v232
    v_mul_f32 v103, v142, v233
    v_fma_f32 v102, -v143, v233, v102
    v_fma_f32 v103, v143, v232, v103
    v_mul_f32 v104, v144, v232
    v_mul_f32 v105, v144, v233
    v_fma_f32 v104, -v145, v233, v104
    v_fma_f32 v105, v145, v232, v105
    v_mul_f32 v106, v146, v232
    v_mul_f32 v107, v146, v233
    v_fma_f32 v106, -v147, v233, v106
    v_fma_f32 v107, v147, v232, v107
    v_mul_f32 v108, v148, v232
    v_mul_f32 v109, v148, v233
    v_fma_f32 v108, -v149, v233, v108
    v_fma_f32 v109, v149, v232, v109
    v_mul_f32 v110, v150, v232
    v_mul_f32 v111, v150, v233
    v_fma_f32 v110, -v151, v233, v110
    v_fma_f32 v111, v151, v232, v111
    v_mul_f32 v112, v152, v232
    v_mul_f32 v113, v152, v233
    v_fma_f32 v112, -v153, v233, v112
    v_fma_f32 v113, v153, v232, v113
    v_mul_f32 v114, v154, v232
    v_mul_f32 v115, v154, v233
    v_fma_f32 v114, -v155, v233, v114
    v_fma_f32 v115, v155, v232, v115
    v_mul_f32 v116, v156, v232
    v_mul_f32 v117, v156, v233
    v_fma_f32 v116, -v157, v233, v116
    v_fma_f32 v117, v157, v232, v117
    v_mul_f32 v118, v158, v232
    v_mul_f32 v119, v158, v233
    v_fma_f32 v118, -v159, v233, v118
    v_fma_f32 v119, v159, v232, v119
    v_mul_f32 v120, v160, v232
    v_mul_f32 v121, v160, v233
    v_fma_f32 v120, -v161, v233, v120
    v_fma_f32 v121, v161, v232, v121
    v_mul_f32 v122, v162, v232
    v_mul_f32 v123, v162, v233
    v_fma_f32 v122, -v163, v233, v122
    v_fma_f32 v123, v163, v232, v123
    v_mul_f32 v124, v164, v232
    v_mul_f32 v125, v164, v233
    v_fma_f32 v124, -v165, v233, v124
    v_fma_f32 v125, v165, v232, v125
    v_mul_f32 v126, v166, v232
    v_mul_f32 v127, v166, v233
    v_fma_f32 v126, -v167, v233, v126
    v_fma_f32 v127, v167, v232, v127
    v_mul_f32 v128, v168, v232
    v_mul_f32 v129, v168, v233
    v_fma_f32 v128, -v169, v233, v128
    v_fma_f32 v129, v169, v232, v129
    v_mul_f32 v130, v170, v232
    v_mul_f32 v131, v170, v233
    v_fma_f32 v130, -v171, v233, v130
    v_fma_f32 v131, v171, v232, v131
    ds_write_b64 v10, v[100:101] offset:16384
    ds_write_b64 v10, v[102:103] offset:16896
    ds_write_b64 v10, v[104:105] offset:17408
    ds_write_b64 v10, v[106:107] offset:17920
    ds_write_b64 v10, v[108:109] offset:18432
    ds_write_b64 v10, v[110:111] offset:18944
    ds_write_b64 v10, v[112:113] offset:19456
    ds_write_b64 v10, v[114:115] offset:19968
    ds_write_b64 v10, v[116:117] offset:20480
    ds_write_b64 v10, v[118:119] offset:20992
    ds_write_b64 v10, v[120:121] offset:21504
    ds_write_b64 v10, v[122:123] offset:22016
    ds_write_b64 v10, v[124:125] offset:22528
    ds_write_b64 v10, v[126:127] offset:23040
    ds_write_b64 v10, v[128:129] offset:23552
    ds_write_b64 v10, v[130:131] offset:24064
    s_branch L_agg_9
L_nz_11:
    buffer_load_dwordx4 v[24:27], v11, s[20:23], s32 offen offset:0 sc1
    s_cmp_le_u32 s25, 1
    s_cbranch_scc1 L_iss_14
    buffer_load_dwordx4 v[28:31], v11, s[20:23], s32 offen offset:1024 sc1
    s_cmp_le_u32 s25, 2
    s_cbranch_scc1 L_iss_14
    buffer_load_dwordx4 v[32:35], v11, s[20:23], s32 offen offset:2048 sc1
    s_cmp_le_u32 s25, 3
    s_cbranch_scc1 L_iss_14
    buffer_load_dwordx4 v[36:39], v11, s[20:23], s32 offen offset:3072 sc1
    s_cmp_le_u32 s25, 4
    s_cbranch_scc1 L_iss_14
    buffer_load_dwordx4 v[40:43], v18, s[20:23], s32 offen offset:0 sc1
    s_cmp_le_u32 s25, 5
    s_cbranch_scc1 L_iss_14
    buffer_load_dwordx4 v[44:47], v18, s[20:23], s32 offen offset:1024 sc1
    s_cmp_le_u32 s25, 6
    s_cbranch_scc1 L_iss_14
    buffer_load_dwordx4 v[48:51], v18, s[20:23], s32 offen offset:2048 sc1
L_iss_14:
    v_mov_b32 v100, 0
    v_mov_b32 v101, 0
    v_mul_f32 v102, v142, v232
    v_mul_f32 v103, v142, v233
    v_fma_f32 v102, -v143, v233, v102
    v_fma_f32 v103, v143, v232, v103
    v_mul_f32 v104, v144, v232
    v_mul_f32 v105, v144, v233
    v_fma_f32 v104, -v145, v233, v104
    v_fma_f32 v105, v145, v232, v105
    v_mul_f32 v106, v146, v232
    v_mul_f32 v107, v146, v233
    v_fma_f32 v106, -v147, v233, v106
    v_fma_f32 v107, v147, v232, v107
    v_mul_f32 v108, v148, v232
    v_mul_f32 v109, v148, v233
    v_fma_f32 v108, -v149, v233, v108
    v_fma_f32 v109, v149, v232, v109
    v_mul_f32 v110, v150, v232
    v_mul_f32 v111, v150, v233
    v_fma_f32 v110, -v151, v233, v110
    v_fma_f32 v111, v151, v232, v111
    v_mul_f32 v112, v152, v232
    v_mul_f32 v113, v152, v233
    v_fma_f32 v112, -v153, v233, v112
    v_fma_f32 v113, v153, v232, v113
    v_mul_f32 v114, v154, v232
    v_mul_f32 v115, v154, v233
    v_fma_f32 v114, -v155, v233, v114
    v_fma_f32 v115, v155, v232, v115
    v_mul_f32 v116, v156, v232
    v_mul_f32 v117, v156, v233
    v_fma_f32 v116, -v157, v233, v116
    v_fma_f32 v117, v157, v232, v117
    v_mul_f32 v118, v158, v232
    v_mul_f32 v119, v158, v233
    v_fma_f32 v118, -v159, v233, v118
    v_fma_f32 v119, v159, v232, v119
    v_mul_f32 v120, v160, v232
    v_mul_f32 v121, v160, v233
    v_fma_f32 v120, -v161, v233, v120
    v_fma_f32 v121, v161, v232, v121
    v_mul_f32 v122, v162, v232
    v_mul_f32 v123, v162, v233
    v_fma_f32 v122, -v163, v233, v122
    v_fma_f32 v123, v163, v232, v123
    v_mul_f32 v124, v164, v232
    v_mul_f32 v125, v164, v233
    v_fma_f32 v124, -v165, v233, v124
    v_fma_f32 v125, v165, v232, v125
    v_mul_f32 v126, v166, v232
    v_mul_f32 v127, v166, v233
    v_fma_f32 v126, -v167, v233, v126
    v_fma_f32 v127, v167, v232, v127
    v_mul_f32 v128, v168, v232
    v_mul_f32 v129, v168, v233
    v_fma_f32 v128, -v169, v233, v128
    v_fma_f32 v129, v169, v232, v129
    v_mul_f32 v130, v170, v232
    v_mul_f32 v131, v170, v233
    v_fma_f32 v130, -v171, v233, v130
    v_fma_f32 v131, v171, v232, v131
    ds_write_b64 v10, v[100:101] offset:16384
    ds_write_b64 v10, v[102:103] offset:16896
    ds_write_b64 v10, v[104:105] offset:17408
    ds_write_b64 v10, v[106:107] offset:17920
    ds_write_b64 v10, v[108:109] offset:18432
    ds_write_b64 v10, v[110:111] offset:18944
    ds_write_b64 v10, v[112:113] offset:19456
    ds_write_b64 v10, v[114:115] offset:19968
    ds_write_b64 v10, v[116:117] offset:20480
    ds_write_b64 v10, v[118:119] offset:20992
    ds_write_b64 v10, v[120:121] offset:21504
    ds_write_b64 v10, v[122:123] offset:22016
    ds_write_b64 v10, v[124:125] offset:22528
    ds_write_b64 v10, v[126:127] offset:23040
    ds_write_b64 v10, v[128:129] offset:23552
    ds_write_b64 v10, v[130:131] offset:24064
    buffer_load_dwordx4 v[176:179], v11, s[20:23], s32 offen offset:0 sc1
    s_cmp_le_u32 s25, 1
    s_cbranch_scc1 L_iss_15
    buffer_load_dwordx4 v[180:183], v11, s[20:23], s32 offen offset:1024 sc1
    s_cmp_le_u32 s25, 2
    s_cbranch_scc1 L_iss_15
    buffer_load_dwordx4 v[184:187], v11, s[20:23], s32 offen offset:2048 sc1
    s_cmp_le_u32 s25, 3
    s_cbranch_scc1 L_iss_15
    buffer_load_dwordx4 v[188:191], v11, s[20:23], s32 offen offset:3072 sc1
    s_cmp_le_u32 s25, 4
    s_cbranch_scc1 L_iss_15
    buffer_load_dwordx4 v[192:195], v18, s[20:23], s32 offen offset:0 sc1
    s_cmp_le_u32 s25, 5
    s_cbranch_scc1 L_iss_15
    buffer_load_dwordx4 v[196:199], v18, s[20:23], s32 offen offset:1024 sc1
    s_cmp_le_u32 s25, 6
    s_cbranch_scc1 L_iss_15
    buffer_load_dwordx4 v[200:203], v18, s[20:23], s32 offen offset:2048 sc1
L_iss_15:
    s_mov_b32 s34, 0
L_poll_16:
    s_cmp_lg_u32 s25, 1
    s_cbranch_scc1 L_wn_18
    s_waitcnt vmcnt(1)
    s_branch L_we_17
L_wn_18:
    s_cmp_lg_u32 s25, 2
    s_cbranch_scc1 L_wn_19
    s_waitcnt vmcnt(2)
    s_branch L_we_17
L_wn_19:
    s_cmp_lg_u32 s25, 3
    s_cbranch_scc1 L_wn_20
    s_waitcnt vmcnt(3)
    s_branch L_we_17
L_wn_20:
    s_cmp_lg_u32 s25, 4
    s_cbranch_scc1 L_wn_21
    s_waitcnt vmcnt(4)
    s_branch L_we_17
L_wn_21:
    s_cmp_lg_u32 s25, 5
    s_cbranch_scc1 L_wn_22
    s_waitcnt vmcnt(5)
    s_branch L_we_17
L_wn_22:
    s_cmp_lg_u32 s25, 6
    s_cbranch_scc1 L_wn_23
    s_waitcnt vmcnt(6)
    s_branch L_we_17
L_wn_23:
    s_cmp_lg_u32 s25, 7
    s_cbranch_scc1 L_wn_24
    s_waitcnt vmcnt(7)
    s_branch L_we_17
L_wn_24:
    s_waitcnt vmcnt(0)
L_we_17:
    s_mov_b64 s[74:75], exec
    v_cmp_eq_u32 vcc, s68, v25
    s_and_b64 s[74:75], s[74:75], vcc
    v_cmp_eq_u32 vcc, s68, v27
    s_and_b64 s[74:75], s[74:75], vcc
    s_cmp_le_u32 s25, 1
    s_cbranch_scc1 L_chk_25
    v_cmp_eq_u32 vcc, s68, v29
    s_and_b64 s[74:75], s[74:75], vcc
    v_cmp_eq_u32 vcc, s68, v31
    s_and_b64 s[74:75], s[74:75], vcc
    s_cmp_le_u32 s25, 2
    s_cbranch_scc1 L_chk_25
    v_cmp_eq_u32 vcc, s68, v33
    s_and_b64 s[74:75], s[74:75], vcc
    v_cmp_eq_u32 vcc, s68, v35
    s_and_b64 s[74:75], s[74:75], vcc
    s_cmp_le_u32 s25, 3
    s_cbranch_scc1 L_chk_25
    v_cmp_eq_u32 vcc, s68, v37
    s_and_b64 s[74:75], s[74:75], vcc
    v_cmp_eq_u32 vcc, s68, v39
    s_and_b64 s[74:75], s[74:75], vcc
    s_cmp_le_u32 s25, 4
    s_cbranch_scc1 L_chk_25
    v_cmp_eq_u32 vcc, s68, v41
    s_and_b64 s[74:75], s[74:75], vcc
    v_cmp_eq_u32 vcc, s68, v43
    s_and_b64 s[74:75], s[74:75], vcc
    s_cmp_le_u32 s25, 5
    s_cbranch_scc1 L_chk_25
    v_cmp_eq_u32 vcc, s68, v45
    s_and_b64 s[74:75], s[74:75], vcc
    v_cmp_eq_u32 vcc, s68, v47
    s_and_b64 s[74:75], s[74:75], vcc
    s_cmp_le_u32 s25, 6
    s_cbranch_scc1 L_chk_25
    v_cmp_eq_u32 vcc, s68, v49
    s_and_b64 s[74:75], s[74:75], vcc
    v_cmp_eq_u32 vcc, s68, v51
    s_and_b64 s[74:75], s[74:75], vcc
L_chk_25:
    s_cmp_eq_u64 s[74:75], exec
    s_cbranch_scc1 L_okA_12
    buffer_load_dwordx4 v[24:27], v11, s[20:23], s32 offen offset:0 sc1
    s_cmp_le_u32 s25, 1
    s_cbranch_scc1 L_iss_26
    buffer_load_dwordx4 v[28:31], v11, s[20:23], s32 offen offset:1024 sc1
    s_cmp_le_u32 s25, 2
    s_cbranch_scc1 L_iss_26
    buffer_load_dwordx4 v[32:35], v11, s[20:23], s32 offen offset:2048 sc1
    s_cmp_le_u32 s25, 3
    s_cbranch_scc1 L_iss_26
    buffer_load_dwordx4 v[36:39], v11, s[20:23], s32 offen offset:3072 sc1
    s_cmp_le_u32 s25, 4
    s_cbranch_scc1 L_iss_26
    buffer_load_dwordx4 v[40:43], v18, s[20:23], s32 offen offset:0 sc1
    s_cmp_le_u32 s25, 5
    s_cbranch_scc1 L_iss_26
    buffer_load_dwordx4 v[44:47], v18, s[20:23], s32 offen offset:1024 sc1
    s_cmp_le_u32 s25, 6
    s_cbranch_scc1 L_iss_26
    buffer_load_dwordx4 v[48:51], v18, s[20:23], s32 offen offset:2048 sc1
L_iss_26:
    s_cmp_lg_u32 s25, 1
    s_cbranch_scc1 L_wn_28
    s_waitcnt vmcnt(1)
    s_branch L_we_27
L_wn_28:
    s_cmp_lg_u32 s25, 2
    s_cbranch_scc1 L_wn_29
    s_waitcnt vmcnt(2)
    s_branch L_we_27
L_wn_29:
    s_cmp_lg_u32 s25, 3
    s_cbranch_scc1 L_wn_30
    s_waitcnt vmcnt(3)
    s_branch L_we_27
L_wn_30:
    s_cmp_lg_u32 s25, 4
    s_cbranch_scc1 L_wn_31
    s_waitcnt vmcnt(4)
    s_branch L_we_27
L_wn_31:
    s_cmp_lg_u32 s25, 5
    s_cbranch_scc1 L_wn_32
    s_waitcnt vmcnt(5)
    s_branch L_we_27
L_wn_32:
    s_cmp_lg_u32 s25, 6
    s_cbranch_scc1 L_wn_33
    s_waitcnt vmcnt(6)
    s_branch L_we_27
L_wn_33:
    s_cmp_lg_u32 s25, 7
    s_cbranch_scc1 L_wn_34
    s_waitcnt vmcnt(7)
    s_branch L_we_27
L_wn_34:
    s_waitcnt vmcnt(0)
L_we_27:
    s_mov_b64 s[74:75], exec
    v_cmp_eq_u32 vcc, s68, v177
    s_and_b64 s[74:75], s[74:75], vcc
    v_cmp_eq_u32 vcc, s68, v179
    s_and_b64 s[74:75], s[74:75], vcc
    s_cmp_le_u32 s25, 1
    s_cbranch_scc1 L_chk_35
    v_cmp_eq_u32 vcc, s68, v181
    s_and_b64 s[74:75], s[74:75], vcc
    v_cmp_eq_u32 vcc, s68, v183
    s_and_b64 s[74:75], s[74:75], vcc
    s_cmp_le_u32 s25, 2
    s_cbranch_scc1 L_chk_35
    v_cmp_eq_u32 vcc, s68, v185
    s_and_b64 s[74:75], s[74:75], vcc
    v_cmp_eq_u32 vcc, s68, v187
    s_and_b64 s[74:75], s[74:75], vcc
    s_cmp_le_u32 s25, 3
    s_cbranch_scc1 L_chk_35
    v_cmp_eq_u32 vcc, s68, v189
    s_and_b64 s[74:75], s[74:75], vcc
    v_cmp_eq_u32 vcc, s68, v191
    s_and_b64 s[74:75], s[74:75], vcc
    s_cmp_le_u32 s25, 4
    s_cbranch_scc1 L_chk_35
    v_cmp_eq_u32 vcc, s68, v193
    s_and_b64 s[74:75], s[74:75], vcc
    v_cmp_eq_u32 vcc, s68, v195
    s_and_b64 s[74:75], s[74:75], vcc
    s_cmp_le_u32 s25, 5
    s_cbranch_scc1 L_chk_35
    v_cmp_eq_u32 vcc, s68, v197
    s_and_b64 s[74:75], s[74:75], vcc
    v_cmp_eq_u32 vcc, s68, v199
    s_and_b64 s[74:75], s[74:75], vcc
    s_cmp_le_u32 s25, 6
    s_cbranch_scc1 L_chk_35
    v_cmp_eq_u32 vcc, s68, v201
    s_and_b64 s[74:75], s[74:75], vcc
    v_cmp_eq_u32 vcc, s68, v203
    s_and_b64 s[74:75], s[74:75], vcc
L_chk_35:
    s_cmp_eq_u64 s[74:75], exec
    s_cbranch_scc1 L_okB_13
    buffer_load_dwordx4 v[176:179], v11, s[20:23], s32 offen offset:0 sc1
    s_cmp_le_u32 s25, 1
    s_cbranch_scc1 L_iss_36
    buffer_load_dwordx4 v[180:183], v11, s[20:23], s32 offen offset:1024 sc1
    s_cmp_le_u32 s25, 2
    s_cbranch_scc1 L_iss_36
    buffer_load_dwordx4 v[184:187], v11, s[20:23], s32 offen offset:2048 sc1
    s_cmp_le_u32 s25, 3
    s_cbranch_scc1 L_iss_36
    buffer_load_dwordx4 v[188:191], v11, s[20:23], s32 offen offset:3072 sc1
    s_cmp_le_u32 s25, 4
    s_cbranch_scc1 L_iss_36
    buffer_load_dwordx4 v[192:195], v18, s[20:23], s32 offen offset:0 sc1
    s_cmp_le_u32 s25, 5
    s_cbranch_scc1 L_iss_36
    buffer_load_dwordx4 v[196:199], v18, s[20:23], s32 offen offset:1024 sc1
    s_cmp_le_u32 s25, 6
    s_cbranch_scc1 L_iss_36
    buffer_load_dwordx4 v[200:203], v18, s[20:23], s32 offen offset:2048 sc1
L_iss_36:
    s_add_u32 s34, s34, 1
    s_cmp_lt_u32 s34, 131072
    s_cbranch_scc1 L_poll_16
    s_branch L_okA_12
L_okB_13:
    v_fma_f32 v16, v72, v20, v176
    v_fma_f32 v17, v72, v21, v178
    v_fma_f32 v16, -v73, v21, v16
    v_fma_f32 v21, v73, v20, v17
    v_mov_b32 v20, v16
    s_cmp_le_u32 s25, 1
    s_cbranch_scc1 L_agg_9
    v_fma_f32 v16, v72, v20, v180
    v_fma_f32 v17, v72, v21, v182
    v_fma_f32 v16, -v73, v21, v16
    v_fma_f32 v21, v73, v20, v17
    v_mov_b32 v20, v16
    s_cmp_le_u32 s25, 2
    s_cbranch_scc1 L_agg_9
    v_fma_f32 v16, v72, v20, v184
    v_fma_f32 v17, v72, v21, v186
    v_fma_f32 v16, -v73, v21, v16
    v_fma_f32 v21, v73, v20, v17
    v_mov_b32 v20, v16
    s_cmp_le_u32 s25, 3
    s_cbranch_scc1 L_agg_9
    v_fma_f32 v16, v72, v20, v188
    v_fma_f32 v17, v72, v21, v190
    v_fma_f32 v16, -v73, v21, v16
    v_fma_f32 v21, v73, v20, v17
    v_mov_b32 v20, v16
    s_cmp_le_u32 s25, 4
    s_cbranch_scc1 L_agg_9
    v_fma_f32 v16, v72, v20, v192
    v_fma_f32 v17, v72, v21, v194
    v_fma_f32 v16, -v73, v21, v16
    v_fma_f32 v21, v73, v20, v17
    v_mov_b32 v20, v16
    s_cmp_le_u32 s25, 5
    s_cbranch_scc1 L_agg_9
    v_fma_f32 v16, v72, v20, v196
    v_fma_f32 v17, v72, v21, v198
    v_fma_f32 v16, -v73, v21, v16
    v_fma_f32 v21, v73, v20, v17
    v_mov_b32 v20, v16
    s_cmp_le_u32 s25, 6
    s_cbranch_scc1 L_agg_9
    v_fma_f32 v16, v72, v20, v200
    v_fma_f32 v17, v72, v21, v202
    v_fma_f32 v16, -v73, v21, v16
    v_fma_f32 v21, v73, v20, v17
    v_mov_b32 v20, v16
    s_branch L_agg_9
L_okA_12:
    v_fma_f32 v16, v72, v20, v24
    v_fma_f32 v17, v72, v21, v26
    v_fma_f32 v16, -v73, v21, v16
    v_fma_f32 v21, v73, v20, v17
    v_mov_b32 v20, v16
    s_cmp_le_u32 s25, 1
    s_cbranch_scc1 L_agg_9
    v_fma_f32 v16, v72, v20, v28
    v_fma_f32 v17, v72, v21, v30
    v_fma_f32 v16, -v73, v21, v16
    v_fma_f32 v21, v73, v20, v17
    v_mov_b32 v20, v16
    s_cmp_le_u32 s25, 2
    s_cbranch_scc1 L_agg_9
    v_fma_f32 v16, v72, v20, v32
    v_fma_f32 v17, v72, v21, v34
    v_fma_f32 v16, -v73, v21, v16
    v_fma_f32 v21, v73, v20, v17
    v_mov_b32 v20, v16
    s_cmp_le_u32 s25, 3
    s_cbranch_scc1 L_agg_9
    v_fma_f32 v16, v72, v20, v36
    v_fma_f32 v17, v72, v21, v38
    v_fma_f32 v16, -v73, v21, v16
    v_fma_f32 v21, v73, v20, v17
    v_mov_b32 v20, v16
    s_cmp_le_u32 s25, 4
    s_cbranch_scc1 L_agg_9
    v_fma_f32 v16, v72, v20, v40
    v_fma_f32 v17, v72, v21, v42
    v_fma_f32 v16, -v73, v21, v16
    v_fma_f32 v21, v73, v20, v17
    v_mov_b32 v20, v16
    s_cmp_le_u32 s25, 5
    s_cbranch_scc1 L_agg_9
    v_fma_f32 v16, v72, v20, v44
    v_fma_f32 v17, v72, v21, v46
    v_fma_f32 v16, -v73, v21, v16
    v_fma_f32 v21, v73, v20, v17
    v_mov_b32 v20, v16
    s_cmp_le_u32 s25, 6
    s_cbranch_scc1 L_agg_9
    v_fma_f32 v16, v72, v20, v48
    v_fma_f32 v17, v72, v21, v50
    v_fma_f32 v16, -v73, v21, v16
    v_fma_f32 v21, v73, v20, v17
    v_mov_b32 v20, v16
L_agg_9:
    v_mul_f32 v22, v20, v232
    v_mul_f32 v23, v20, v233
    v_fma_f32 v22, -v21, v233, v22
    v_fma_f32 v23, v21, v232, v23
    ds_write_b64 v10, v[22:23] offset:24576
    s_waitcnt lgkmcnt(0)
    s_barrier
    s_waitcnt vmcnt(0)
    s_load_dwordx2 s[8:9], s[0:1], 40
    s_mov_b32 s10, 2097152
    s_mov_b32 s11, 0x20000
    s_load_dwordx2 s[12:13], s[0:1], 48
    s_mov_b32 s14, 2097152
    s_mov_b32 s15, 0x20000
    s_load_dwordx2 s[16:17], s[0:1], 88
    s_mov_b32 s18, 2097152
    s_mov_b32 s19, 0x20000
    s_load_dwordx2 s[60:61], s[0:1], 104
    s_mov_b32 s62, 8388608
    s_mov_b32 s63, 0x20000
    s_load_dwordx2 s[64:65], s[0:1], 64
    s_mov_b32 s66, 2048
    s_mov_b32 s67, 0x20000
    s_mov_b32 s73, s26
    s_mov_b32 s71, s25
    s_lshl_b32 s72, s26, 1
    s_add_u32 s72, s72, s27
    s_lshr_b32 s32, s31, 4
    s_lshl_b32 s25, s3, 1
    s_add_u32 s25, s25, s32
    s_and_b32 s26, s31, 15
    s_waitcnt lgkmcnt(0)
    s_sub_u32 s32, s24, 4
    v_and_b32 v1, 63, v0
    v_lshrrev_b32 v2, 3, v1
    v_and_b32 v3, 7, v1
    s_lshl_b32 s33, s25, 4
    s_lshl_b32 s34, s32, 3
    s_add_u32 s33, s33, s34
    s_lshl_b32 s33, s33, 10
    v_lshlrev_b32 v4, 4, v1
    v_xor_b32 v5, 0, v4
    v_add_u32 v5, s33, v5
    v_add_u32 v10, 0, v5
    v_xor_b32 v5, 64, v4
    v_add_u32 v5, s33, v5
    v_add_u32 v11, 1024, v5
    v_xor_b32 v5, 128, v4
    v_add_u32 v5, s33, v5
    v_add_u32 v12, 2048, v5
    v_xor_b32 v5, 192, v4
    v_add_u32 v5, s33, v5
    v_add_u32 v13, 3072, v5
    v_xor_b32 v5, 0, v4
    v_add_u32 v5, s33, v5
    v_add_u32 v14, 4096, v5
    v_xor_b32 v5, 64, v4
    v_add_u32 v5, s33, v5
    v_add_u32 v15, 5120, v5
    v_xor_b32 v5, 128, v4
    v_add_u32 v5, s33, v5
    v_add_u32 v16, 6144, v5
    v_xor_b32 v5, 192, v4
    v_add_u32 v5, s33, v5
    v_add_u32 v17, 7168, v5
    s_lshl_b32 s33, s25, 7
    s_lshl_b32 s34, s32, 6
    s_add_u32 s33, s33, s34
    v_add_u32 v4, s33, v2
    v_lshlrev_b32 v4, 11, v4
    v_lshrrev_b32 v5, 1, v2
    v_xor_b32 v5, v3, v5
    v_lshlrev_b32 v5, 4, v5
    v_add_u32 v6, v4, v5
    v_xor_b32 v7, 64, v6
    v_add_u32 v20, 0, v6
    v_add_u32 v21, 16384, v7
    v_add_u32 v22, 32768, v6
    v_add_u32 v23, 49152, v7
    v_add_u32 v24, 65536, v6
    v_add_u32 v25, 81920, v7
    v_add_u32 v26, 98304, v6
    v_add_u32 v27, 114688, v7
    s_lshl_b32 s44, s32, 13
    s_mov_b32 s42, 0
    s_barrier
    s_lshl_b32 s32, s71, 7
    s_lshl_b32 s33, s73, 2
    s_add_u32 s32, s32, s33
    s_add_u32 s32, s32, 266608640
    v_mov_b32 v2, s68
    v_mov_b32 v3, s32
    s_mov_b64 s[74:75], exec
    s_mov_b64 exec, 1
    s_cmp_lg_u32 s92, 0
    s_cbranch_scc1 L_fg_37
    buffer_store_dword v2, v3, s[20:23], 0 offen
    s_branch L_fe_38
L_fg_37:
    buffer_wbl2 sc1
    s_waitcnt vmcnt(0)
    buffer_store_dword v2, v3, s[20:23], 0 offen sc1
L_fe_38:
    s_mov_b64 exec, s[74:75]
    s_branch L_p2_al_poll
L_helpB:
    s_cmp_eq_u32 s24, 5
    s_cbranch_scc1 L_helpB1
    s_cmp_eq_u32 s24, 6
    s_cbranch_scc1 L_helpB2
    s_sub_u32 s32, s24, 4
    v_and_b32 v1, 63, v0
    v_lshrrev_b32 v2, 3, v1
    v_and_b32 v3, 7, v1
    v_lshrrev_b32 v4, 2, v2
    v_lshlrev_b32 v4, 4, v4
    v_and_b32 v5, 1, v2
    v_lshlrev_b32 v5, 3, v5
    v_add_u32 v4, v4, v5
    v_bfe_u32 v5, v2, 1, 1
    v_add_u32 v4, v4, v5
    s_lshl_b32 s33, s25, 8
    s_lshl_b32 s34, s32, 6
    s_add_u32 s33, s33, s34
    v_add_u32 v4, s33, v4
    v_lshlrev_b32 v4, 11, v4
    v_lshrrev_b32 v5, 1, v2
    v_xor_b32 v5, v3, v5
    v_lshlrev_b32 v5, 4, v5
    v_add_u32 v4, v4, v5
    v_add_u32 v10, 0, v4
    v_xor_b32 v11, 64, v4
    v_add_u32 v11, 65536, v11
    v_add_u32 v12, 4096, v4
    v_xor_b32 v13, 64, v4
    v_add_u32 v13, 69632, v13
    v_add_u32 v14, 8192, v4
    v_xor_b32 v15, 64, v4
    v_add_u32 v15, 73728, v15
    v_add_u32 v16, 12288, v4
    v_xor_b32 v17, 64, v4
    v_add_u32 v17, 77824, v17
    s_lshl_b32 s34, s32, 4
    v_add_u32 v6, s34, v2
    s_movk_i32 s35, 6144
    v_mul_lo_u32 v6, v6, s35
    v_bfe_u32 v7, v2, 1, 1
    v_lshlrev_b32 v7, 1, v7
    v_xor_b32 v7, v3, v7
    v_lshlrev_b32 v7, 4, v7
    v_add_u32 v6, v6, v7
    s_lshl_b32 s34, s26, 7
    v_add_u32 v18, s34, v6
    v_xor_b32 v19, 64, v18
    v_add_u32 v19, 49152, v19
    v_lshrrev_b32 v6, 2, v1
    s_lshl_b32 s34, s32, 4
    v_add_u32 v6, s34, v6
    s_movk_i32 s35, 6144
    v_mul_lo_u32 v6, v6, s35
    v_and_b32 v7, 3, v1
    v_lshrrev_b32 v8, 5, v1
    v_lshlrev_b32 v8, 1, v8
    v_xor_b32 v7, v7, v8
    v_lshlrev_b32 v7, 4, v7
    v_add_u32 v6, v6, v7
    s_lshl_b32 s34, s26, 7
    s_lshl_b32 s35, s27, 6
    s_add_u32 s34, s34, s35
    v_add_u32 v20, s34, v6
    s_lshl_b32 s44, s32, 13
    s_lshl_b32 s45, s32, 11
    s_lshl_b32 s46, s32, 10
    s_mov_b32 s29, 0
    s_mul_i32 s33, s25, 0
    s_and_b32 s33, s33, 15
    s_lshl_b32 s40, s33, 7
    s_mul_i32 s41, s33, 393216
    s_add_u32 s42, s41, 2048
    s_add_u32 s43, s41, 4096
    s_waitcnt lgkmcnt(0)
    s_add_u32 s32, s29, s44
    s_mov_b32 m0, s32
    s_nop 0
    buffer_load_dwordx4 v10, s[4:7], s40 offen lds
    s_add_u32 m0, s32, 1024
    s_nop 0
    buffer_load_dwordx4 v11, s[4:7], s40 offen lds
    s_add_u32 m0, s32, 2048
    s_nop 0
    buffer_load_dwordx4 v12, s[4:7], s40 offen lds
    s_add_u32 m0, s32, 3072
    s_nop 0
    buffer_load_dwordx4 v13, s[4:7], s40 offen lds
    s_add_u32 m0, s32, 4096
    s_nop 0
    buffer_load_dwordx4 v14, s[4:7], s40 offen lds
    s_add_u32 m0, s32, 5120
    s_nop 0
    buffer_load_dwordx4 v15, s[4:7], s40 offen lds
    s_add_u32 m0, s32, 6144
    s_nop 0
    buffer_load_dwordx4 v16, s[4:7], s40 offen lds
    s_add_u32 m0, s32, 7168
    s_nop 0
    buffer_load_dwordx4 v17, s[4:7], s40 offen lds
    s_add_u32 s32, s29, s45
    s_add_u32 m0, s32, 32768
    s_nop 0
    buffer_load_dwordx4 v18, s[16:19], s42 offen lds
    s_add_u32 m0, s32, 33792
    s_nop 0
    buffer_load_dwordx4 v19, s[16:19], s42 offen lds
    s_add_u32 m0, s32, 40960
    s_nop 0
    buffer_load_dwordx4 v18, s[16:19], s43 offen lds
    s_add_u32 m0, s32, 41984
    s_nop 0
    buffer_load_dwordx4 v19, s[16:19], s43 offen lds
    s_add_u32 s32, s29, s46
    s_add_u32 m0, s32, 49152
    s_nop 0
    buffer_load_dwordx4 v20, s[16:19], s41 offen lds
    s_add_u32 s40, s40, 128
    s_add_u32 s41, s41, 393216
    s_add_u32 s42, s42, 393216
    s_add_u32 s43, s43, 393216
    s_cmp_eq_u32 s40, 2048
    s_cselect_b32 s40, 0, s40
    s_cselect_b32 s41, 0, s41
    s_cselect_b32 s42, 2048, s42
    s_cselect_b32 s43, 4096, s43
    s_add_u32 s29, s29, 53248
    s_cmp_eq_u32 s29, 159744
    s_cselect_b32 s29, 0, s29
    s_add_u32 s32, s29, s44
    s_mov_b32 m0, s32
    s_nop 0
    buffer_load_dwordx4 v10, s[4:7], s40 offen lds
    s_add_u32 m0, s32, 1024
    s_nop 0
    buffer_load_dwordx4 v11, s[4:7], s40 offen lds
    s_add_u32 m0, s32, 2048
    s_nop 0
    buffer_load_dwordx4 v12, s[4:7], s40 offen lds
    s_add_u32 m0, s32, 3072
    s_nop 0
    buffer_load_dwordx4 v13, s[4:7], s40 offen lds
    s_add_u32 m0, s32, 4096
    s_nop 0
    buffer_load_dwordx4 v14, s[4:7], s40 offen lds
    s_add_u32 m0, s32, 5120
    s_nop 0
    buffer_load_dwordx4 v15, s[4:7], s40 offen lds
    s_add_u32 m0, s32, 6144
    s_nop 0
    buffer_load_dwordx4 v16, s[4:7], s40 offen lds
    s_add_u32 m0, s32, 7168
    s_nop 0
    buffer_load_dwordx4 v17, s[4:7], s40 offen lds
    s_add_u32 s32, s29, s45
    s_add_u32 m0, s32, 32768
    s_nop 0
    buffer_load_dwordx4 v18, s[16:19], s42 offen lds
    s_add_u32 m0, s32, 33792
    s_nop 0
    buffer_load_dwordx4 v19, s[16:19], s42 offen lds
    s_add_u32 m0, s32, 40960
    s_nop 0
    buffer_load_dwordx4 v18, s[16:19], s43 offen lds
    s_add_u32 m0, s32, 41984
    s_nop 0
    buffer_load_dwordx4 v19, s[16:19], s43 offen lds
    s_add_u32 s32, s29, s46
    s_add_u32 m0, s32, 49152
    s_nop 0
    buffer_load_dwordx4 v20, s[16:19], s41 offen lds
    s_add_u32 s40, s40, 128
    s_add_u32 s41, s41, 393216
    s_add_u32 s42, s42, 393216
    s_add_u32 s43, s43, 393216
    s_cmp_eq_u32 s40, 2048
    s_cselect_b32 s40, 0, s40
    s_cselect_b32 s41, 0, s41
    s_cselect_b32 s42, 2048, s42
    s_cselect_b32 s43, 4096, s43
    s_add_u32 s29, s29, 53248
    s_cmp_eq_u32 s29, 159744
    s_cselect_b32 s29, 0, s29
    s_mov_b32 s96, s16
    s_mov_b32 s97, s17
    s_mov_b32 s98, 6291456
    s_mov_b32 s99, 0x20000
    s_mov_b32 s95, 786432
    s_cmp_eq_u32 s24, 4
    s_cselect_b32 s96, s4, s96
    s_cselect_b32 s97, s5, s97
    s_cselect_b32 s98, 4194304, s98
    s_cselect_b32 s95, 256, s95
    s_cmp_eq_u32 s24, 5
    s_cselect_b32 s96, s8, s96
    s_cselect_b32 s97, s9, s97
    s_cselect_b32 s98, 2097152, s98
    s_cselect_b32 s95, 256, s95
    s_cmp_eq_u32 s24, 6
    s_cselect_b32 s96, s12, s96
    s_cselect_b32 s97, s13, s97
    s_cselect_b32 s98, 2097152, s98
    s_cselect_b32 s95, 256, s95
    v_and_b32 v240, 63, v0
    s_add_u32 s33, s31, 0
    s_and_b32 s33, s33, 31
    s_lshl_b32 s32, s3, 5
    s_add_u32 s32, s32, s33
    s_lshl_b32 s32, s32, 3
    v_and_b32 v243, 7, v240
    v_add_u32 v243, s32, v243
    v_lshlrev_b32 v243, 11, v243
    v_bfe_u32 v244, v240, 3, 1
    v_lshlrev_b32 v244, 7, v244
    v_add_u32 v243, v243, v244
    s_lshl_b32 s32, s2, 2
    v_and_b32 v245, 3, v240
    v_add_u32 v245, s32, v245
    v_lshlrev_b32 v245, 11, v245
    v_bfe_u32 v244, v240, 2, 1
    v_lshlrev_b32 v244, 7, v244
    v_add_u32 v245, v245, v244
    v_min_u32 v246, 23, v240
    v_cmp_lt_u32 vcc, 11, v246
    v_subrev_u32 v244, 12, v246
    s_nop 0
    v_cndmask_b32 v246, v246, v244, vcc
    s_mul_i32 s32, s2, 12
    v_add_u32 v246, s32, v246
    v_lshlrev_b32 v246, 7, v246
    v_mov_b32 v244, 393216
    v_cndmask_b32 v244, 0, v244, vcc
    v_add_u32 v246, v246, v244
    s_cmp_eq_u32 s24, 4
    s_cselect_b64 vcc, -1, 0
    v_cndmask_b32 v245, v245, v243, vcc
    s_cmp_eq_u32 s24, 7
    s_cselect_b64 vcc, -1, 0
    v_cndmask_b32 v241, v245, v246, vcc
    s_lshr_b32 s94, s95, 1
    s_mul_i32 s94, s94, 3
    v_lshlrev_b32 v242, 7, v240
    v_min_u32 v247, 63, v240
    v_lshlrev_b32 v247, 7, v247
    s_lshl_b32 s47, s2, 13
    s_cmp_eq_u32 s24, 7
    s_cselect_b32 s58, 341, 341
    buffer_load_dword v243, v241, s[96:99], s94 offen
    s_add_u32 s94, s94, s95
    buffer_load_dword v243, v241, s[96:99], s94 offen
    s_add_u32 s94, s94, s95
    s_waitcnt vmcnt(15)
    s_barrier
    s_add_u32 s32, s29, s44
    s_mov_b32 m0, s32
    s_nop 0
    buffer_load_dwordx4 v10, s[4:7], s40 offen lds
    s_add_u32 m0, s32, 1024
    s_nop 0
    buffer_load_dwordx4 v11, s[4:7], s40 offen lds
    s_add_u32 m0, s32, 2048
    s_nop 0
    buffer_load_dwordx4 v12, s[4:7], s40 offen lds
    s_add_u32 m0, s32, 3072
    s_nop 0
    buffer_load_dwordx4 v13, s[4:7], s40 offen lds
    s_add_u32 m0, s32, 4096
    s_nop 0
    buffer_load_dwordx4 v14, s[4:7], s40 offen lds
    s_add_u32 m0, s32, 5120
    s_nop 0
    buffer_load_dwordx4 v15, s[4:7], s40 offen lds
    s_add_u32 m0, s32, 6144
    s_nop 0
    buffer_load_dwordx4 v16, s[4:7], s40 offen lds
    s_add_u32 m0, s32, 7168
    s_nop 0
    buffer_load_dwordx4 v17, s[4:7], s40 offen lds
    s_add_u32 s32, s29, s45
    s_add_u32 m0, s32, 32768
    s_nop 0
    buffer_load_dwordx4 v18, s[16:19], s42 offen lds
    s_add_u32 m0, s32, 33792
    s_nop 0
    buffer_load_dwordx4 v19, s[16:19], s42 offen lds
    s_add_u32 m0, s32, 40960
    s_nop 0
    buffer_load_dwordx4 v18, s[16:19], s43 offen lds
    s_add_u32 m0, s32, 41984
    s_nop 0
    buffer_load_dwordx4 v19, s[16:19], s43 offen lds
    s_add_u32 s32, s29, s46
    s_add_u32 m0, s32, 49152
    s_nop 0
    buffer_load_dwordx4 v20, s[16:19], s41 offen lds
    s_add_u32 s40, s40, 128
    s_add_u32 s41, s41, 393216
    s_add_u32 s42, s42, 393216
    s_add_u32 s43, s43, 393216
    s_cmp_eq_u32 s40, 2048
    s_cselect_b32 s40, 0, s40
    s_cselect_b32 s41, 0, s41
    s_cselect_b32 s42, 2048, s42
    s_cselect_b32 s43, 4096, s43
    s_add_u32 s29, s29, 53248
    s_cmp_eq_u32 s29, 159744
    s_cselect_b32 s29, 0, s29
    s_waitcnt vmcnt(15)
    s_barrier
    s_add_u32 s32, s29, s44
    s_mov_b32 m0, s32
    s_nop 0
    buffer_load_dwordx4 v10, s[4:7], s40 offen lds
    s_add_u32 m0, s32, 1024
    s_nop 0
    buffer_load_dwordx4 v11, s[4:7], s40 offen lds
    s_add_u32 m0, s32, 2048
    s_nop 0
    buffer_load_dwordx4 v12, s[4:7], s40 offen lds
    s_add_u32 m0, s32, 3072
    s_nop 0
    buffer_load_dwordx4 v13, s[4:7], s40 offen lds
    s_add_u32 m0, s32, 4096
    s_nop 0
    buffer_load_dwordx4 v14, s[4:7], s40 offen lds
    s_add_u32 m0, s32, 5120
    s_nop 0
    buffer_load_dwordx4 v15, s[4:7], s40 offen lds
    s_add_u32 m0, s32, 6144
    s_nop 0
    buffer_load_dwordx4 v16, s[4:7], s40 offen lds
    s_add_u32 m0, s32, 7168
    s_nop 0
    buffer_load_dwordx4 v17, s[4:7], s40 offen lds
    s_add_u32 s32, s29, s45
    s_add_u32 m0, s32, 32768
    s_nop 0
    buffer_load_dwordx4 v18, s[16:19], s42 offen lds
    s_add_u32 m0, s32, 33792
    s_nop 0
    buffer_load_dwordx4 v19, s[16:19], s42 offen lds
    s_add_u32 m0, s32, 40960
    s_nop 0
    buffer_load_dwordx4 v18, s[16:19], s43 offen lds
    s_add_u32 m0, s32, 41984
    s_nop 0
    buffer_load_dwordx4 v19, s[16:19], s43 offen lds
    s_add_u32 s32, s29, s46
    s_add_u32 m0, s32, 49152
    s_nop 0
    buffer_load_dwordx4 v20, s[16:19], s41 offen lds
    s_add_u32 s40, s40, 128
    s_add_u32 s41, s41, 393216
    s_add_u32 s42, s42, 393216
    s_add_u32 s43, s43, 393216
    s_cmp_eq_u32 s40, 2048
    s_cselect_b32 s40, 0, s40
    s_cselect_b32 s41, 0, s41
    s_cselect_b32 s42, 2048, s42
    s_cselect_b32 s43, 4096, s43
    s_add_u32 s29, s29, 53248
    s_cmp_eq_u32 s29, 159744
    s_cselect_b32 s29, 0, s29
    s_mov_b32 s28, 0
    s_lshr_b32 s36, s58, s28
    s_bitcmp1_b32 s36, 0
    s_cselect_b32 s36, s94, 0x80000000
    s_cselect_b32 s37, s95, 0
    buffer_load_dword v243, v241, s[96:99], s36 offen
    s_add_u32 s94, s94, s37
    s_lshr_b32 s36, 4096, s28
    s_bitcmp1_b32 s36, 0
    s_cselect_b32 s36, s47, 0x80000000
    s_cselect_b32 s37, 8192, 0
    buffer_load_dword v244, v247, s[88:91], s36 offen
    s_add_u32 s47, s47, s37
    s_waitcnt vmcnt(15)
    s_mov_b32 s28, 1
L_ploopBx:
    s_barrier
    s_add_u32 s32, s29, s44
    s_mov_b32 m0, s32
    s_nop 0
    buffer_load_dwordx4 v10, s[4:7], s40 offen lds
    s_add_u32 m0, s32, 1024
    s_nop 0
    buffer_load_dwordx4 v11, s[4:7], s40 offen lds
    s_add_u32 m0, s32, 2048
    s_nop 0
    buffer_load_dwordx4 v12, s[4:7], s40 offen lds
    s_add_u32 m0, s32, 3072
    s_nop 0
    buffer_load_dwordx4 v13, s[4:7], s40 offen lds
    s_add_u32 m0, s32, 4096
    s_nop 0
    buffer_load_dwordx4 v14, s[4:7], s40 offen lds
    s_add_u32 m0, s32, 5120
    s_nop 0
    buffer_load_dwordx4 v15, s[4:7], s40 offen lds
    s_add_u32 m0, s32, 6144
    s_nop 0
    buffer_load_dwordx4 v16, s[4:7], s40 offen lds
    s_add_u32 m0, s32, 7168
    s_nop 0
    buffer_load_dwordx4 v17, s[4:7], s40 offen lds
    s_add_u32 s32, s29, s45
    s_add_u32 m0, s32, 32768
    s_nop 0
    buffer_load_dwordx4 v18, s[16:19], s42 offen lds
    s_add_u32 m0, s32, 33792
    s_nop 0
    buffer_load_dwordx4 v19, s[16:19], s42 offen lds
    s_add_u32 m0, s32, 40960
    s_nop 0
    buffer_load_dwordx4 v18, s[16:19], s43 offen lds
    s_add_u32 m0, s32, 41984
    s_nop 0
    buffer_load_dwordx4 v19, s[16:19], s43 offen lds
    s_add_u32 s32, s29, s46
    s_add_u32 m0, s32, 49152
    s_nop 0
    buffer_load_dwordx4 v20, s[16:19], s41 offen lds
    s_add_u32 s40, s40, 128
    s_add_u32 s41, s41, 393216
    s_add_u32 s42, s42, 393216
    s_add_u32 s43, s43, 393216
    s_cmp_eq_u32 s40, 2048
    s_cselect_b32 s40, 0, s40
    s_cselect_b32 s41, 0, s41
    s_cselect_b32 s42, 2048, s42
    s_cselect_b32 s43, 4096, s43
    s_add_u32 s29, s29, 53248
    s_cmp_eq_u32 s29, 159744
    s_cselect_b32 s29, 0, s29
    s_lshr_b32 s36, s58, s28
    s_bitcmp1_b32 s36, 0
    s_cselect_b32 s36, s94, 0x80000000
    s_cselect_b32 s37, s95, 0
    buffer_load_dword v243, v241, s[96:99], s36 offen
    s_add_u32 s94, s94, s37
    s_lshr_b32 s36, 4096, s28
    s_bitcmp1_b32 s36, 0
    s_cselect_b32 s36, s47, 0x80000000
    s_cselect_b32 s37, 8192, 0
    buffer_load_dword v244, v247, s[88:91], s36 offen
    s_add_u32 s47, s47, s37
    s_waitcnt vmcnt(17)
    s_add_u32 s28, s28, 1
    s_cmp_lt_u32 s28, 13
    s_cbranch_scc1 L_ploopBx
    s_barrier
    s_waitcnt vmcnt(0)
    s_cmp_lg_u32 s24, 7
    s_cbranch_scc1 L_cp_39
    s_getpc_b64 s[32:33]
L_pc_40:
    s_sub_u32 s32, s32, L_pc_40-gated_mix__ssm_conv_s5__linear_attn_block__prompt_kernel
    s_subb_u32 s33, s33, 0
    s_lshl_b32 s34, s31, 4
    v_and_b32 v245, 15, v0
    v_add_u32 v245, s34, v245
    v_lshlrev_b32 v245, 7, v245
    v_min_u32 v245, L_end-gated_mix__ssm_conv_s5__linear_attn_block__prompt_kernel, v245
    global_load_dword v246, v245, s[32:33]
L_cp_39:
    s_barrier
    s_barrier
L_helpB_join:
    v_mov_b32 v2, 159768
    ds_read_b32 v4, v2
    s_waitcnt lgkmcnt(0)
    v_readfirstlane_b32 s68, v4
    s_sub_u32 s32, s24, 4
    s_lshr_b32 s32, s32, 1
    s_lshl_b32 s33, s26, 1
    s_add_u32 s32, s32, s33
    s_lshl_b32 s96, s32, 7
    s_add_u32 s96, s96, 265289728
    v_and_b32 v99, 7, v0
    v_lshlrev_b32 v99, 2, v99
    buffer_load_dword v98, v99, s[20:23], s96 offen sc1
    s_barrier
    s_sub_u32 s32, s24, 4
    v_and_b32 v10, 63, v0
    v_lshlrev_b32 v10, 4, v10
    s_lshl_b32 s33, s32, 11
    v_add_u32 v11, s33, v10
    s_lshl_b32 s33, s32, 10
    v_and_b32 v12, 48, v0
    v_lshlrev_b32 v12, 4, v12
    v_and_b32 v13, 3, v0
    v_lshlrev_b32 v13, 2, v13
    v_add_u32 v12, v12, v13
    v_add_u32 v12, s33, v12
    ds_read_b128 v[100:103], v11 offset:0
    ds_read_b128 v[104:107], v11 offset:1024
    ds_read_b32 v108, v12 offset:32768
    ds_read_b128 v[112:115], v11 offset:8192
    ds_read_b128 v[116:119], v11 offset:9216
    ds_read_b32 v120, v12 offset:36864
    ds_read_b128 v[124:127], v11 offset:16384
    ds_read_b128 v[128:131], v11 offset:17408
    ds_read_b32 v132, v12 offset:40960
    ds_read_b128 v[136:139], v11 offset:24576
    ds_read_b128 v[140:143], v11 offset:25600
    ds_read_b32 v144, v12 offset:45056
    s_waitcnt lgkmcnt(0)
    v_pk_add_f32 v[100:101], v[100:101], v[112:113]
    v_pk_add_f32 v[124:125], v[124:125], v[136:137]
    v_pk_add_f32 v[102:103], v[102:103], v[114:115]
    v_pk_add_f32 v[126:127], v[126:127], v[138:139]
    v_pk_add_f32 v[104:105], v[104:105], v[116:117]
    v_pk_add_f32 v[128:129], v[128:129], v[140:141]
    v_pk_add_f32 v[106:107], v[106:107], v[118:119]
    v_pk_add_f32 v[130:131], v[130:131], v[142:143]
    v_add_f32 v108, v108, v120
    v_add_f32 v132, v132, v144
    v_pk_add_f32 v[100:101], v[100:101], v[124:125]
    v_pk_add_f32 v[102:103], v[102:103], v[126:127]
    v_pk_add_f32 v[104:105], v[104:105], v[128:129]
    v_pk_add_f32 v[106:107], v[106:107], v[130:131]
    v_add_f32 v108, v108, v132
    s_mov_b32 s35, 0
L_kz_41:
    s_waitcnt vmcnt(0)
    v_cmp_eq_u32 vcc, s68, v98
    s_cmp_eq_u64 vcc, exec
    s_cbranch_scc1 L_kzok_42
    buffer_load_dword v98, v99, s[20:23], s96 offen sc1
    s_add_u32 s35, s35, 1
    s_cmp_lt_u32 s35, 131072
    s_cbranch_scc1 L_kz_41
L_kzok_42:
    s_lshr_b32 s33, s32, 1
    s_lshl_b32 s34, s26, 1
    s_add_u32 s33, s33, s34
    s_mul_i32 s33, s33, 4608
    s_add_u32 s33, s33, 264241152
    s_and_b32 s34, s32, 1
    s_mul_i32 s35, s34, 2304
    s_add_u32 s33, s33, s35
    v_lshrrev_b32 v10, 2, v10
    buffer_atomic_add_f32 v100, v10, s[20:23], s33 offen offset:0
    buffer_atomic_add_f32 v101, v10, s[20:23], s33 offen offset:256
    buffer_atomic_add_f32 v102, v10, s[20:23], s33 offen offset:512
    buffer_atomic_add_f32 v103, v10, s[20:23], s33 offen offset:768
    buffer_atomic_add_f32 v104, v10, s[20:23], s33 offen offset:1024
    buffer_atomic_add_f32 v105, v10, s[20:23], s33 offen offset:1280
    buffer_atomic_add_f32 v106, v10, s[20:23], s33 offen offset:1536
    buffer_atomic_add_f32 v107, v10, s[20:23], s33 offen offset:1792
    buffer_atomic_add_f32 v108, v10, s[20:23], s33 offen offset:2048
    s_lshl_b32 s97, s25, 1
    s_add_u32 s97, s97, s34
    s_add_u32 s97, s97, 8
    s_lshl_b32 s97, s97, 2
    s_add_u32 s97, s97, s96
    s_load_dwordx2 s[8:9], s[0:1], 40
    s_mov_b32 s10, 2097152
    s_mov_b32 s11, 0x20000
    s_load_dwordx2 s[12:13], s[0:1], 48
    s_mov_b32 s14, 2097152
    s_mov_b32 s15, 0x20000
    s_load_dwordx2 s[16:17], s[0:1], 88
    s_mov_b32 s18, 2097152
    s_mov_b32 s19, 0x20000
    s_load_dwordx2 s[60:61], s[0:1], 104
    s_mov_b32 s62, 8388608
    s_mov_b32 s63, 0x20000
    s_load_dwordx2 s[64:65], s[0:1], 64
    s_mov_b32 s66, 2048
    s_mov_b32 s67, 0x20000
    s_mov_b32 s73, s26
    s_mov_b32 s71, s25
    s_lshl_b32 s72, s26, 1
    s_add_u32 s72, s72, s27
    s_lshr_b32 s32, s31, 4
    s_lshl_b32 s25, s3, 1
    s_add_u32 s25, s25, s32
    s_and_b32 s26, s31, 15
    s_waitcnt lgkmcnt(0)
    v_and_b32 v1, 63, v0
    v_lshrrev_b32 v2, 3, v1
    v_and_b32 v3, 7, v1
    s_lshl_b32 s33, s26, 6
    v_add_u32 v4, s33, v2
    v_lshlrev_b32 v4, 11, v4
    v_lshrrev_b32 v5, 1, v2
    v_xor_b32 v5, v3, v5
    v_lshlrev_b32 v5, 4, v5
    v_add_u32 v6, v4, v5
    v_xor_b32 v7, 64, v6
    v_add_u32 v10, 0, v6
    v_add_u32 v11, 16384, v7
    v_add_u32 v12, 32768, v6
    v_add_u32 v13, 49152, v7
    v_add_u32 v14, 65536, v6
    v_add_u32 v15, 81920, v7
    v_add_u32 v16, 98304, v6
    v_add_u32 v17, 114688, v7
    v_lshlrev_b32 v4, 11, v2
    v_bfe_u32 v5, v2, 1, 1
    v_lshlrev_b32 v5, 2, v5
    v_xor_b32 v5, v3, v5
    v_lshlrev_b32 v5, 4, v5
    v_add_u32 v4, v4, v5
    s_lshl_b32 s33, s26, 7
    v_add_u32 v6, s33, v4
    v_add_u32 v20, 0, v6
    v_add_u32 v21, 16384, v6
    v_add_u32 v22, 32768, v6
    v_add_u32 v23, 49152, v6
    v_add_u32 v24, 65536, v6
    v_add_u32 v25, 81920, v6
    v_add_u32 v26, 98304, v6
    v_add_u32 v27, 114688, v6
    s_cmp_lg_u32 s24, 6
    s_cbranch_scc1 L_nb_43
    s_waitcnt vmcnt(0)
    v_mov_b32 v2, s68
    v_mov_b32 v3, s97
    s_mov_b64 s[74:75], exec
    s_mov_b64 exec, 1
    buffer_store_dword v2, v3, s[20:23], 0 offen sc1
    s_mov_b64 exec, s[74:75]
    s_mov_b32 s41, 0
    s_mov_b32 s43, 98304
    s_mov_b32 m0, s43
    s_nop 0
    buffer_load_dwordx4 v10, s[8:11], s41 offen lds
    s_add_u32 m0, s43, 1024
    s_nop 0
    buffer_load_dwordx4 v11, s[8:11], s41 offen lds
    s_add_u32 m0, s43, 2048
    s_nop 0
    buffer_load_dwordx4 v12, s[8:11], s41 offen lds
    s_add_u32 m0, s43, 3072
    s_nop 0
    buffer_load_dwordx4 v13, s[8:11], s41 offen lds
    s_add_u32 m0, s43, 4096
    s_nop 0
    buffer_load_dwordx4 v14, s[8:11], s41 offen lds
    s_add_u32 m0, s43, 5120
    s_nop 0
    buffer_load_dwordx4 v15, s[8:11], s41 offen lds
    s_add_u32 m0, s43, 6144
    s_nop 0
    buffer_load_dwordx4 v16, s[8:11], s41 offen lds
    s_add_u32 m0, s43, 7168
    s_nop 0
    buffer_load_dwordx4 v17, s[8:11], s41 offen lds
    s_add_u32 s41, s41, 128
    s_add_u32 s43, s43, 8192
    s_cmp_ge_u32 s43, 147456
    s_cselect_b32 s32, 49152, 0
    s_sub_u32 s43, s43, s32
    s_mov_b32 m0, s43
    s_nop 0
    buffer_load_dwordx4 v10, s[8:11], s41 offen lds
    s_add_u32 m0, s43, 1024
    s_nop 0
    buffer_load_dwordx4 v11, s[8:11], s41 offen lds
    s_add_u32 m0, s43, 2048
    s_nop 0
    buffer_load_dwordx4 v12, s[8:11], s41 offen lds
    s_add_u32 m0, s43, 3072
    s_nop 0
    buffer_load_dwordx4 v13, s[8:11], s41 offen lds
    s_add_u32 m0, s43, 4096
    s_nop 0
    buffer_load_dwordx4 v14, s[8:11], s41 offen lds
    s_add_u32 m0, s43, 5120
    s_nop 0
    buffer_load_dwordx4 v15, s[8:11], s41 offen lds
    s_add_u32 m0, s43, 6144
    s_nop 0
    buffer_load_dwordx4 v16, s[8:11], s41 offen lds
    s_add_u32 m0, s43, 7168
    s_nop 0
    buffer_load_dwordx4 v17, s[8:11], s41 offen lds
    s_add_u32 s41, s41, 128
    s_add_u32 s43, s43, 8192
    s_cmp_ge_u32 s43, 147456
    s_cselect_b32 s32, 49152, 0
    s_sub_u32 s43, s43, s32
    s_mov_b32 m0, s43
    s_nop 0
    buffer_load_dwordx4 v10, s[8:11], s41 offen lds
    s_add_u32 m0, s43, 1024
    s_nop 0
    buffer_load_dwordx4 v11, s[8:11], s41 offen lds
    s_add_u32 m0, s43, 2048
    s_nop 0
    buffer_load_dwordx4 v12, s[8:11], s41 offen lds
    s_add_u32 m0, s43, 3072
    s_nop 0
    buffer_load_dwordx4 v13, s[8:11], s41 offen lds
    s_add_u32 m0, s43, 4096
    s_nop 0
    buffer_load_dwordx4 v14, s[8:11], s41 offen lds
    s_add_u32 m0, s43, 5120
    s_nop 0
    buffer_load_dwordx4 v15, s[8:11], s41 offen lds
    s_add_u32 m0, s43, 6144
    s_nop 0
    buffer_load_dwordx4 v16, s[8:11], s41 offen lds
    s_add_u32 m0, s43, 7168
    s_nop 0
    buffer_load_dwordx4 v17, s[8:11], s41 offen lds
    s_add_u32 s41, s41, 128
    s_add_u32 s43, s43, 8192
    s_cmp_ge_u32 s43, 147456
    s_cselect_b32 s32, 49152, 0
    s_sub_u32 s43, s43, s32
    s_mov_b32 m0, s43
    s_nop 0
    buffer_load_dwordx4 v10, s[8:11], s41 offen lds
    s_add_u32 m0, s43, 1024
    s_nop 0
    buffer_load_dwordx4 v11, s[8:11], s41 offen lds
    s_add_u32 m0, s43, 2048
    s_nop 0
    buffer_load_dwordx4 v12, s[8:11], s41 offen lds
    s_add_u32 m0, s43, 3072
    s_nop 0
    buffer_load_dwordx4 v13, s[8:11], s41 offen lds
    s_add_u32 m0, s43, 4096
    s_nop 0
    buffer_load_dwordx4 v14, s[8:11], s41 offen lds
    s_add_u32 m0, s43, 5120
    s_nop 0
    buffer_load_dwordx4 v15, s[8:11], s41 offen lds
    s_add_u32 m0, s43, 6144
    s_nop 0
    buffer_load_dwordx4 v16, s[8:11], s41 offen lds
    s_add_u32 m0, s43, 7168
    s_nop 0
    buffer_load_dwordx4 v17, s[8:11], s41 offen lds
    s_add_u32 s41, s41, 128
    s_add_u32 s43, s43, 8192
    s_cmp_ge_u32 s43, 147456
    s_cselect_b32 s32, 49152, 0
    s_sub_u32 s43, s43, s32
    s_branch L_nb_43x
L_nb_43:
    s_waitcnt vmcnt(0)
    v_mov_b32 v2, s68
    v_mov_b32 v3, s97
    s_mov_b64 s[74:75], exec
    s_mov_b64 exec, 1
    buffer_store_dword v2, v3, s[20:23], 0 offen sc1
    s_mov_b64 exec, s[74:75]
L_nb_43x:
    s_barrier
    s_cmp_eq_u32 s24, 6
    s_cbranch_scc1 L_p2_bl
    s_cmp_eq_u32 s24, 7
    s_cbranch_scc1 L_p2_h3
    s_branch L_p2_al
L_helpB1:
    s_sub_u32 s32, s24, 4
    v_and_b32 v1, 63, v0
    v_lshrrev_b32 v2, 3, v1
    v_and_b32 v3, 7, v1
    v_lshrrev_b32 v4, 2, v2
    v_lshlrev_b32 v4, 4, v4
    v_and_b32 v5, 1, v2
    v_lshlrev_b32 v5, 3, v5
    v_add_u32 v4, v4, v5
    v_bfe_u32 v5, v2, 1, 1
    v_add_u32 v4, v4, v5
    s_lshl_b32 s33, s25, 8
    s_lshl_b32 s34, s32, 6
    s_add_u32 s33, s33, s34
    v_add_u32 v4, s33, v4
    v_lshlrev_b32 v4, 11, v4
    v_lshrrev_b32 v5, 1, v2
    v_xor_b32 v5, v3, v5
    v_lshlrev_b32 v5, 4, v5
    v_add_u32 v4, v4, v5
    v_add_u32 v10, 0, v4
    v_xor_b32 v11, 64, v4
    v_add_u32 v11, 65536, v11
    v_add_u32 v12, 4096, v4
    v_xor_b32 v13, 64, v4
    v_add_u32 v13, 69632, v13
    v_add_u32 v14, 8192, v4
    v_xor_b32 v15, 64, v4
    v_add_u32 v15, 73728, v15
    v_add_u32 v16, 12288, v4
    v_xor_b32 v17, 64, v4
    v_add_u32 v17, 77824, v17
    s_lshl_b32 s34, s32, 4
    v_add_u32 v6, s34, v2
    s_movk_i32 s35, 6144
    v_mul_lo_u32 v6, v6, s35
    v_bfe_u32 v7, v2, 1, 1
    v_lshlrev_b32 v7, 1, v7
    v_xor_b32 v7, v3, v7
    v_lshlrev_b32 v7, 4, v7
    v_add_u32 v6, v6, v7
    s_lshl_b32 s34, s26, 7
    v_add_u32 v18, s34, v6
    v_xor_b32 v19, 64, v18
    v_add_u32 v19, 49152, v19
    v_lshrrev_b32 v6, 2, v1
    s_lshl_b32 s34, s32, 4
    v_add_u32 v6, s34, v6
    s_movk_i32 s35, 6144
    v_mul_lo_u32 v6, v6, s35
    v_and_b32 v7, 3, v1
    v_lshrrev_b32 v8, 5, v1
    v_lshlrev_b32 v8, 1, v8
    v_xor_b32 v7, v7, v8
    v_lshlrev_b32 v7, 4, v7
    v_add_u32 v6, v6, v7
    s_lshl_b32 s34, s26, 7
    s_lshl_b32 s35, s27, 6
    s_add_u32 s34, s34, s35
    v_add_u32 v20, s34, v6
    s_lshl_b32 s44, s32, 13
    s_lshl_b32 s45, s32, 11
    s_lshl_b32 s46, s32, 10
    s_mov_b32 s29, 0
    s_mul_i32 s33, s25, 0
    s_and_b32 s33, s33, 15
    s_lshl_b32 s40, s33, 7
    s_mul_i32 s41, s33, 393216
    s_add_u32 s42, s41, 2048
    s_add_u32 s43, s41, 4096
    s_waitcnt lgkmcnt(0)
    s_mov_b32 s69, 266665984
    s_buffer_load_dword s68, s[20:23], s69
    s_add_u32 s32, s29, s44
    s_mov_b32 m0, s32
    s_nop 0
    buffer_load_dwordx4 v10, s[4:7], s40 offen lds
    s_add_u32 m0, s32, 1024
    s_nop 0
    buffer_load_dwordx4 v11, s[4:7], s40 offen lds
    s_add_u32 m0, s32, 2048
    s_nop 0
    buffer_load_dwordx4 v12, s[4:7], s40 offen lds
    s_add_u32 m0, s32, 3072
    s_nop 0
    buffer_load_dwordx4 v13, s[4:7], s40 offen lds
    s_add_u32 m0, s32, 4096
    s_nop 0
    buffer_load_dwordx4 v14, s[4:7], s40 offen lds
    s_add_u32 m0, s32, 5120
    s_nop 0
    buffer_load_dwordx4 v15, s[4:7], s40 offen lds
    s_add_u32 m0, s32, 6144
    s_nop 0
    buffer_load_dwordx4 v16, s[4:7], s40 offen lds
    s_add_u32 m0, s32, 7168
    s_nop 0
    buffer_load_dwordx4 v17, s[4:7], s40 offen lds
    s_add_u32 s32, s29, s45
    s_add_u32 m0, s32, 32768
    s_nop 0
    buffer_load_dwordx4 v18, s[16:19], s42 offen lds
    s_add_u32 m0, s32, 33792
    s_nop 0
    buffer_load_dwordx4 v19, s[16:19], s42 offen lds
    s_add_u32 m0, s32, 40960
    s_nop 0
    buffer_load_dwordx4 v18, s[16:19], s43 offen lds
    s_add_u32 m0, s32, 41984
    s_nop 0
    buffer_load_dwordx4 v19, s[16:19], s43 offen lds
    s_add_u32 s32, s29, s46
    s_add_u32 m0, s32, 49152
    s_nop 0
    buffer_load_dwordx4 v20, s[16:19], s41 offen lds
    s_add_u32 s40, s40, 128
    s_add_u32 s41, s41, 393216
    s_add_u32 s42, s42, 393216
    s_add_u32 s43, s43, 393216
    s_cmp_eq_u32 s40, 2048
    s_cselect_b32 s40, 0, s40
    s_cselect_b32 s41, 0, s41
    s_cselect_b32 s42, 2048, s42
    s_cselect_b32 s43, 4096, s43
    s_add_u32 s29, s29, 53248
    s_cmp_eq_u32 s29, 159744
    s_cselect_b32 s29, 0, s29
    s_add_u32 s32, s29, s44
    s_mov_b32 m0, s32
    s_nop 0
    buffer_load_dwordx4 v10, s[4:7], s40 offen lds
    s_add_u32 m0, s32, 1024
    s_nop 0
    buffer_load_dwordx4 v11, s[4:7], s40 offen lds
    s_add_u32 m0, s32, 2048
    s_nop 0
    buffer_load_dwordx4 v12, s[4:7], s40 offen lds
    s_add_u32 m0, s32, 3072
    s_nop 0
    buffer_load_dwordx4 v13, s[4:7], s40 offen lds
    s_add_u32 m0, s32, 4096
    s_nop 0
    buffer_load_dwordx4 v14, s[4:7], s40 offen lds
    s_add_u32 m0, s32, 5120
    s_nop 0
    buffer_load_dwordx4 v15, s[4:7], s40 offen lds
    s_add_u32 m0, s32, 6144
    s_nop 0
    buffer_load_dwordx4 v16, s[4:7], s40 offen lds
    s_add_u32 m0, s32, 7168
    s_nop 0
    buffer_load_dwordx4 v17, s[4:7], s40 offen lds
    s_add_u32 s32, s29, s45
    s_add_u32 m0, s32, 32768
    s_nop 0
    buffer_load_dwordx4 v18, s[16:19], s42 offen lds
    s_add_u32 m0, s32, 33792
    s_nop 0
    buffer_load_dwordx4 v19, s[16:19], s42 offen lds
    s_add_u32 m0, s32, 40960
    s_nop 0
    buffer_load_dwordx4 v18, s[16:19], s43 offen lds
    s_add_u32 m0, s32, 41984
    s_nop 0
    buffer_load_dwordx4 v19, s[16:19], s43 offen lds
    s_add_u32 s32, s29, s46
    s_add_u32 m0, s32, 49152
    s_nop 0
    buffer_load_dwordx4 v20, s[16:19], s41 offen lds
    s_add_u32 s40, s40, 128
    s_add_u32 s41, s41, 393216
    s_add_u32 s42, s42, 393216
    s_add_u32 s43, s43, 393216
    s_cmp_eq_u32 s40, 2048
    s_cselect_b32 s40, 0, s40
    s_cselect_b32 s41, 0, s41
    s_cselect_b32 s42, 2048, s42
    s_cselect_b32 s43, 4096, s43
    s_add_u32 s29, s29, 53248
    s_cmp_eq_u32 s29, 159744
    s_cselect_b32 s29, 0, s29
    s_mov_b32 s96, s16
    s_mov_b32 s97, s17
    s_mov_b32 s98, 6291456
    s_mov_b32 s99, 0x20000
    s_mov_b32 s95, 786432
    s_cmp_eq_u32 s24, 4
    s_cselect_b32 s96, s4, s96
    s_cselect_b32 s97, s5, s97
    s_cselect_b32 s98, 4194304, s98
    s_cselect_b32 s95, 256, s95
    s_cmp_eq_u32 s24, 5
    s_cselect_b32 s96, s8, s96
    s_cselect_b32 s97, s9, s97
    s_cselect_b32 s98, 2097152, s98
    s_cselect_b32 s95, 256, s95
    s_cmp_eq_u32 s24, 6
    s_cselect_b32 s96, s12, s96
    s_cselect_b32 s97, s13, s97
    s_cselect_b32 s98, 2097152, s98
    s_cselect_b32 s95, 256, s95
    v_and_b32 v240, 63, v0
    s_add_u32 s33, s31, 0
    s_and_b32 s33, s33, 31
    s_lshl_b32 s32, s3, 5
    s_add_u32 s32, s32, s33
    s_lshl_b32 s32, s32, 3
    v_and_b32 v243, 7, v240
    v_add_u32 v243, s32, v243
    v_lshlrev_b32 v243, 11, v243
    v_bfe_u32 v244, v240, 3, 1
    v_lshlrev_b32 v244, 7, v244
    v_add_u32 v243, v243, v244
    s_lshl_b32 s32, s2, 2
    v_and_b32 v245, 3, v240
    v_add_u32 v245, s32, v245
    v_lshlrev_b32 v245, 11, v245
    v_bfe_u32 v244, v240, 2, 1
    v_lshlrev_b32 v244, 7, v244
    v_add_u32 v245, v245, v244
    v_min_u32 v246, 23, v240
    v_cmp_lt_u32 vcc, 11, v246
    v_subrev_u32 v244, 12, v246
    s_nop 0
    v_cndmask_b32 v246, v246, v244, vcc
    s_mul_i32 s32, s2, 12
    v_add_u32 v246, s32, v246
    v_lshlrev_b32 v246, 7, v246
    v_mov_b32 v244, 393216
    v_cndmask_b32 v244, 0, v244, vcc
    v_add_u32 v246, v246, v244
    s_cmp_eq_u32 s24, 4
    s_cselect_b64 vcc, -1, 0
    v_cndmask_b32 v245, v245, v243, vcc
    s_cmp_eq_u32 s24, 7
    s_cselect_b64 vcc, -1, 0
    v_cndmask_b32 v241, v245, v246, vcc
    s_lshr_b32 s94, s95, 1
    s_mul_i32 s94, s94, 3
    v_lshlrev_b32 v242, 7, v240
    v_min_u32 v247, 63, v240
    v_lshlrev_b32 v247, 7, v247
    s_lshl_b32 s47, s2, 13
    s_cmp_eq_u32 s24, 7
    s_cselect_b32 s58, 341, 341
    buffer_load_dword v243, v241, s[96:99], s94 offen
    s_add_u32 s94, s94, s95
    buffer_load_dword v243, v241, s[96:99], s94 offen
    s_add_u32 s94, s94, s95
    s_waitcnt vmcnt(15)
    s_barrier
    s_add_u32 s32, s29, s44
    s_mov_b32 m0, s32
    s_nop 0
    buffer_load_dwordx4 v10, s[4:7], s40 offen lds
    s_add_u32 m0, s32, 1024
    s_nop 0
    buffer_load_dwordx4 v11, s[4:7], s40 offen lds
    s_add_u32 m0, s32, 2048
    s_nop 0
    buffer_load_dwordx4 v12, s[4:7], s40 offen lds
    s_add_u32 m0, s32, 3072
    s_nop 0
    buffer_load_dwordx4 v13, s[4:7], s40 offen lds
    s_add_u32 m0, s32, 4096
    s_nop 0
    buffer_load_dwordx4 v14, s[4:7], s40 offen lds
    s_add_u32 m0, s32, 5120
    s_nop 0
    buffer_load_dwordx4 v15, s[4:7], s40 offen lds
    s_add_u32 m0, s32, 6144
    s_nop 0
    buffer_load_dwordx4 v16, s[4:7], s40 offen lds
    s_add_u32 m0, s32, 7168
    s_nop 0
    buffer_load_dwordx4 v17, s[4:7], s40 offen lds
    s_add_u32 s32, s29, s45
    s_add_u32 m0, s32, 32768
    s_nop 0
    buffer_load_dwordx4 v18, s[16:19], s42 offen lds
    s_add_u32 m0, s32, 33792
    s_nop 0
    buffer_load_dwordx4 v19, s[16:19], s42 offen lds
    s_add_u32 m0, s32, 40960
    s_nop 0
    buffer_load_dwordx4 v18, s[16:19], s43 offen lds
    s_add_u32 m0, s32, 41984
    s_nop 0
    buffer_load_dwordx4 v19, s[16:19], s43 offen lds
    s_add_u32 s32, s29, s46
    s_add_u32 m0, s32, 49152
    s_nop 0
    buffer_load_dwordx4 v20, s[16:19], s41 offen lds
    s_add_u32 s40, s40, 128
    s_add_u32 s41, s41, 393216
    s_add_u32 s42, s42, 393216
    s_add_u32 s43, s43, 393216
    s_cmp_eq_u32 s40, 2048
    s_cselect_b32 s40, 0, s40
    s_cselect_b32 s41, 0, s41
    s_cselect_b32 s42, 2048, s42
    s_cselect_b32 s43, 4096, s43
    s_add_u32 s29, s29, 53248
    s_cmp_eq_u32 s29, 159744
    s_cselect_b32 s29, 0, s29
    s_waitcnt vmcnt(15)
    s_barrier
    s_add_u32 s32, s29, s44
    s_mov_b32 m0, s32
    s_nop 0
    buffer_load_dwordx4 v10, s[4:7], s40 offen lds
    s_add_u32 m0, s32, 1024
    s_nop 0
    buffer_load_dwordx4 v11, s[4:7], s40 offen lds
    s_add_u32 m0, s32, 2048
    s_nop 0
    buffer_load_dwordx4 v12, s[4:7], s40 offen lds
    s_add_u32 m0, s32, 3072
    s_nop 0
    buffer_load_dwordx4 v13, s[4:7], s40 offen lds
    s_add_u32 m0, s32, 4096
    s_nop 0
    buffer_load_dwordx4 v14, s[4:7], s40 offen lds
    s_add_u32 m0, s32, 5120
    s_nop 0
    buffer_load_dwordx4 v15, s[4:7], s40 offen lds
    s_add_u32 m0, s32, 6144
    s_nop 0
    buffer_load_dwordx4 v16, s[4:7], s40 offen lds
    s_add_u32 m0, s32, 7168
    s_nop 0
    buffer_load_dwordx4 v17, s[4:7], s40 offen lds
    s_add_u32 s32, s29, s45
    s_add_u32 m0, s32, 32768
    s_nop 0
    buffer_load_dwordx4 v18, s[16:19], s42 offen lds
    s_add_u32 m0, s32, 33792
    s_nop 0
    buffer_load_dwordx4 v19, s[16:19], s42 offen lds
    s_add_u32 m0, s32, 40960
    s_nop 0
    buffer_load_dwordx4 v18, s[16:19], s43 offen lds
    s_add_u32 m0, s32, 41984
    s_nop 0
    buffer_load_dwordx4 v19, s[16:19], s43 offen lds
    s_add_u32 s32, s29, s46
    s_add_u32 m0, s32, 49152
    s_nop 0
    buffer_load_dwordx4 v20, s[16:19], s41 offen lds
    s_add_u32 s40, s40, 128
    s_add_u32 s41, s41, 393216
    s_add_u32 s42, s42, 393216
    s_add_u32 s43, s43, 393216
    s_cmp_eq_u32 s40, 2048
    s_cselect_b32 s40, 0, s40
    s_cselect_b32 s41, 0, s41
    s_cselect_b32 s42, 2048, s42
    s_cselect_b32 s43, 4096, s43
    s_add_u32 s29, s29, 53248
    s_cmp_eq_u32 s29, 159744
    s_cselect_b32 s29, 0, s29
    s_mov_b32 s28, 0
    s_lshr_b32 s36, s58, s28
    s_bitcmp1_b32 s36, 0
    s_cselect_b32 s36, s94, 0x80000000
    s_cselect_b32 s37, s95, 0
    buffer_load_dword v243, v241, s[96:99], s36 offen
    s_add_u32 s94, s94, s37
    s_lshr_b32 s36, 4096, s28
    s_bitcmp1_b32 s36, 0
    s_cselect_b32 s36, s47, 0x80000000
    s_cselect_b32 s37, 8192, 0
    buffer_load_dword v244, v247, s[88:91], s36 offen
    s_add_u32 s47, s47, s37
    s_waitcnt vmcnt(15)
    s_waitcnt lgkmcnt(0)
    s_mul_i32 s68, s68, 0x9E3779B1
    s_add_u32 s68, s68, 0x7F4A7C15
    s_cmp_eq_u32 s68, 0
    s_cselect_b32 s68, 1, s68
    v_mov_b32 v86, s68
    v_mov_b32 v87, 0
    v_mov_b32 v89, 159768
    s_mov_b64 s[74:75], exec
    s_mov_b64 exec, 1
    ds_write_b64 v89, v[86:87]
    s_mov_b64 exec, s[74:75]
    s_waitcnt lgkmcnt(0)
    s_barrier
    s_add_u32 s32, s29, s44
    s_mov_b32 m0, s32
    s_nop 0
    buffer_load_dwordx4 v10, s[4:7], s40 offen lds
    s_add_u32 m0, s32, 1024
    s_nop 0
    buffer_load_dwordx4 v11, s[4:7], s40 offen lds
    s_add_u32 m0, s32, 2048
    s_nop 0
    buffer_load_dwordx4 v12, s[4:7], s40 offen lds
    s_add_u32 m0, s32, 3072
    s_nop 0
    buffer_load_dwordx4 v13, s[4:7], s40 offen lds
    s_add_u32 m0, s32, 4096
    s_nop 0
    buffer_load_dwordx4 v14, s[4:7], s40 offen lds
    s_add_u32 m0, s32, 5120
    s_nop 0
    buffer_load_dwordx4 v15, s[4:7], s40 offen lds
    s_add_u32 m0, s32, 6144
    s_nop 0
    buffer_load_dwordx4 v16, s[4:7], s40 offen lds
    s_add_u32 m0, s32, 7168
    s_nop 0
    buffer_load_dwordx4 v17, s[4:7], s40 offen lds
    s_add_u32 s32, s29, s45
    s_add_u32 m0, s32, 32768
    s_nop 0
    buffer_load_dwordx4 v18, s[16:19], s42 offen lds
    s_add_u32 m0, s32, 33792
    s_nop 0
    buffer_load_dwordx4 v19, s[16:19], s42 offen lds
    s_add_u32 m0, s32, 40960
    s_nop 0
    buffer_load_dwordx4 v18, s[16:19], s43 offen lds
    s_add_u32 m0, s32, 41984
    s_nop 0
    buffer_load_dwordx4 v19, s[16:19], s43 offen lds
    s_add_u32 s32, s29, s46
    s_add_u32 m0, s32, 49152
    s_nop 0
    buffer_load_dwordx4 v20, s[16:19], s41 offen lds
    s_add_u32 s40, s40, 128
    s_add_u32 s41, s41, 393216
    s_add_u32 s42, s42, 393216
    s_add_u32 s43, s43, 393216
    s_cmp_eq_u32 s40, 2048
    s_cselect_b32 s40, 0, s40
    s_cselect_b32 s41, 0, s41
    s_cselect_b32 s42, 2048, s42
    s_cselect_b32 s43, 4096, s43
    s_add_u32 s29, s29, 53248
    s_cmp_eq_u32 s29, 159744
    s_cselect_b32 s29, 0, s29
    s_mov_b32 s28, 1
    s_lshr_b32 s36, s58, s28
    s_bitcmp1_b32 s36, 0
    s_cselect_b32 s36, s94, 0x80000000
    s_cselect_b32 s37, s95, 0
    buffer_load_dword v243, v241, s[96:99], s36 offen
    s_add_u32 s94, s94, s37
    s_lshr_b32 s36, 4096, s28
    s_bitcmp1_b32 s36, 0
    s_cselect_b32 s36, s47, 0x80000000
    s_cselect_b32 s37, 8192, 0
    buffer_load_dword v244, v247, s[88:91], s36 offen
    s_add_u32 s47, s47, s37
    s_waitcnt vmcnt(17)
    s_getreg_b32 s93, hwreg(HW_REG_XCC_ID, 0, 4)
    s_lshl_b32 s32, s3, 5
    s_add_u32 s32, s32, s31
    s_lshl_b32 s32, s32, 3
    s_add_u32 s32, s32, 266600448
    v_mov_b32 v86, s93
    v_mov_b32 v87, s68
    v_mov_b32 v88, s32
    s_mov_b64 s[74:75], exec
    s_mov_b64 exec, 1
    buffer_store_dwordx2 v[86:87], v88, s[20:23], 0 offen sc1
    s_mov_b64 exec, s[74:75]
    s_mov_b32 s28, 2
L_ploopBy:
    s_barrier
    s_add_u32 s32, s29, s44
    s_mov_b32 m0, s32
    s_nop 0
    buffer_load_dwordx4 v10, s[4:7], s40 offen lds
    s_add_u32 m0, s32, 1024
    s_nop 0
    buffer_load_dwordx4 v11, s[4:7], s40 offen lds
    s_add_u32 m0, s32, 2048
    s_nop 0
    buffer_load_dwordx4 v12, s[4:7], s40 offen lds
    s_add_u32 m0, s32, 3072
    s_nop 0
    buffer_load_dwordx4 v13, s[4:7], s40 offen lds
    s_add_u32 m0, s32, 4096
    s_nop 0
    buffer_load_dwordx4 v14, s[4:7], s40 offen lds
    s_add_u32 m0, s32, 5120
    s_nop 0
    buffer_load_dwordx4 v15, s[4:7], s40 offen lds
    s_add_u32 m0, s32, 6144
    s_nop 0
    buffer_load_dwordx4 v16, s[4:7], s40 offen lds
    s_add_u32 m0, s32, 7168
    s_nop 0
    buffer_load_dwordx4 v17, s[4:7], s40 offen lds
    s_add_u32 s32, s29, s45
    s_add_u32 m0, s32, 32768
    s_nop 0
    buffer_load_dwordx4 v18, s[16:19], s42 offen lds
    s_add_u32 m0, s32, 33792
    s_nop 0
    buffer_load_dwordx4 v19, s[16:19], s42 offen lds
    s_add_u32 m0, s32, 40960
    s_nop 0
    buffer_load_dwordx4 v18, s[16:19], s43 offen lds
    s_add_u32 m0, s32, 41984
    s_nop 0
    buffer_load_dwordx4 v19, s[16:19], s43 offen lds
    s_add_u32 s32, s29, s46
    s_add_u32 m0, s32, 49152
    s_nop 0
    buffer_load_dwordx4 v20, s[16:19], s41 offen lds
    s_add_u32 s40, s40, 128
    s_add_u32 s41, s41, 393216
    s_add_u32 s42, s42, 393216
    s_add_u32 s43, s43, 393216
    s_cmp_eq_u32 s40, 2048
    s_cselect_b32 s40, 0, s40
    s_cselect_b32 s41, 0, s41
    s_cselect_b32 s42, 2048, s42
    s_cselect_b32 s43, 4096, s43
    s_add_u32 s29, s29, 53248
    s_cmp_eq_u32 s29, 159744
    s_cselect_b32 s29, 0, s29
    s_lshr_b32 s36, s58, s28
    s_bitcmp1_b32 s36, 0
    s_cselect_b32 s36, s94, 0x80000000
    s_cselect_b32 s37, s95, 0
    buffer_load_dword v243, v241, s[96:99], s36 offen
    s_add_u32 s94, s94, s37
    s_lshr_b32 s36, 4096, s28
    s_bitcmp1_b32 s36, 0
    s_cselect_b32 s36, s47, 0x80000000
    s_cselect_b32 s37, 8192, 0
    buffer_load_dword v244, v247, s[88:91], s36 offen
    s_add_u32 s47, s47, s37
    s_waitcnt vmcnt(17)
    s_add_u32 s28, s28, 1
    s_cmp_lt_u32 s28, 13
    s_cbranch_scc1 L_ploopBy
    s_barrier
    s_waitcnt vmcnt(0)
    s_cmp_lg_u32 s24, 7
    s_cbranch_scc1 L_cp_44
    s_getpc_b64 s[32:33]
L_pc_45:
    s_sub_u32 s32, s32, L_pc_45-gated_mix__ssm_conv_s5__linear_attn_block__prompt_kernel
    s_subb_u32 s33, s33, 0
    s_lshl_b32 s34, s31, 4
    v_and_b32 v245, 15, v0
    v_add_u32 v245, s34, v245
    v_lshlrev_b32 v245, 7, v245
    v_min_u32 v245, L_end-gated_mix__ssm_conv_s5__linear_attn_block__prompt_kernel, v245
    global_load_dword v246, v245, s[32:33]
L_cp_44:
    s_barrier
    s_barrier
    s_branch L_helpB_join
L_helpB2:
    s_sub_u32 s32, s24, 4
    v_and_b32 v1, 63, v0
    v_lshrrev_b32 v2, 3, v1
    v_and_b32 v3, 7, v1
    v_lshrrev_b32 v4, 2, v2
    v_lshlrev_b32 v4, 4, v4
    v_and_b32 v5, 1, v2
    v_lshlrev_b32 v5, 3, v5
    v_add_u32 v4, v4, v5
    v_bfe_u32 v5, v2, 1, 1
    v_add_u32 v4, v4, v5
    s_lshl_b32 s33, s25, 8
    s_lshl_b32 s34, s32, 6
    s_add_u32 s33, s33, s34
    v_add_u32 v4, s33, v4
    v_lshlrev_b32 v4, 11, v4
    v_lshrrev_b32 v5, 1, v2
    v_xor_b32 v5, v3, v5
    v_lshlrev_b32 v5, 4, v5
    v_add_u32 v4, v4, v5
    v_add_u32 v10, 0, v4
    v_xor_b32 v11, 64, v4
    v_add_u32 v11, 65536, v11
    v_add_u32 v12, 4096, v4
    v_xor_b32 v13, 64, v4
    v_add_u32 v13, 69632, v13
    v_add_u32 v14, 8192, v4
    v_xor_b32 v15, 64, v4
    v_add_u32 v15, 73728, v15
    v_add_u32 v16, 12288, v4
    v_xor_b32 v17, 64, v4
    v_add_u32 v17, 77824, v17
    s_lshl_b32 s34, s32, 4
    v_add_u32 v6, s34, v2
    s_movk_i32 s35, 6144
    v_mul_lo_u32 v6, v6, s35
    v_bfe_u32 v7, v2, 1, 1
    v_lshlrev_b32 v7, 1, v7
    v_xor_b32 v7, v3, v7
    v_lshlrev_b32 v7, 4, v7
    v_add_u32 v6, v6, v7
    s_lshl_b32 s34, s26, 7
    v_add_u32 v18, s34, v6
    v_xor_b32 v19, 64, v18
    v_add_u32 v19, 49152, v19
    v_lshrrev_b32 v6, 2, v1
    s_lshl_b32 s34, s32, 4
    v_add_u32 v6, s34, v6
    s_movk_i32 s35, 6144
    v_mul_lo_u32 v6, v6, s35
    v_and_b32 v7, 3, v1
    v_lshrrev_b32 v8, 5, v1
    v_lshlrev_b32 v8, 1, v8
    v_xor_b32 v7, v7, v8
    v_lshlrev_b32 v7, 4, v7
    v_add_u32 v6, v6, v7
    s_lshl_b32 s34, s26, 7
    s_lshl_b32 s35, s27, 6
    s_add_u32 s34, s34, s35
    v_add_u32 v20, s34, v6
    s_lshl_b32 s44, s32, 13
    s_lshl_b32 s45, s32, 11
    s_lshl_b32 s46, s32, 10
    s_mov_b32 s29, 0
    s_mul_i32 s33, s25, 0
    s_and_b32 s33, s33, 15
    s_lshl_b32 s40, s33, 7
    s_mul_i32 s41, s33, 393216
    s_add_u32 s42, s41, 2048
    s_add_u32 s43, s41, 4096
    s_waitcnt lgkmcnt(0)
    s_add_u32 s32, s29, s44
    s_mov_b32 m0, s32
    s_nop 0
    buffer_load_dwordx4 v10, s[4:7], s40 offen lds
    s_add_u32 m0, s32, 1024
    s_nop 0
    buffer_load_dwordx4 v11, s[4:7], s40 offen lds
    s_add_u32 m0, s32, 2048
    s_nop 0
    buffer_load_dwordx4 v12, s[4:7], s40 offen lds
    s_add_u32 m0, s32, 3072
    s_nop 0
    buffer_load_dwordx4 v13, s[4:7], s40 offen lds
    s_add_u32 m0, s32, 4096
    s_nop 0
    buffer_load_dwordx4 v14, s[4:7], s40 offen lds
    s_add_u32 m0, s32, 5120
    s_nop 0
    buffer_load_dwordx4 v15, s[4:7], s40 offen lds
    s_add_u32 m0, s32, 6144
    s_nop 0
    buffer_load_dwordx4 v16, s[4:7], s40 offen lds
    s_add_u32 m0, s32, 7168
    s_nop 0
    buffer_load_dwordx4 v17, s[4:7], s40 offen lds
    s_add_u32 s32, s29, s45
    s_add_u32 m0, s32, 32768
    s_nop 0
    buffer_load_dwordx4 v18, s[16:19], s42 offen lds
    s_add_u32 m0, s32, 33792
    s_nop 0
    buffer_load_dwordx4 v19, s[16:19], s42 offen lds
    s_add_u32 m0, s32, 40960
    s_nop 0
    buffer_load_dwordx4 v18, s[16:19], s43 offen lds
    s_add_u32 m0, s32, 41984
    s_nop 0
    buffer_load_dwordx4 v19, s[16:19], s43 offen lds
    s_add_u32 s32, s29, s46
    s_add_u32 m0, s32, 49152
    s_nop 0
    buffer_load_dwordx4 v20, s[16:19], s41 offen lds
    s_add_u32 s40, s40, 128
    s_add_u32 s41, s41, 393216
    s_add_u32 s42, s42, 393216
    s_add_u32 s43, s43, 393216
    s_cmp_eq_u32 s40, 2048
    s_cselect_b32 s40, 0, s40
    s_cselect_b32 s41, 0, s41
    s_cselect_b32 s42, 2048, s42
    s_cselect_b32 s43, 4096, s43
    s_add_u32 s29, s29, 53248
    s_cmp_eq_u32 s29, 159744
    s_cselect_b32 s29, 0, s29
    s_add_u32 s32, s29, s44
    s_mov_b32 m0, s32
    s_nop 0
    buffer_load_dwordx4 v10, s[4:7], s40 offen lds
    s_add_u32 m0, s32, 1024
    s_nop 0
    buffer_load_dwordx4 v11, s[4:7], s40 offen lds
    s_add_u32 m0, s32, 2048
    s_nop 0
    buffer_load_dwordx4 v12, s[4:7], s40 offen lds
    s_add_u32 m0, s32, 3072
    s_nop 0
    buffer_load_dwordx4 v13, s[4:7], s40 offen lds
    s_add_u32 m0, s32, 4096
    s_nop 0
    buffer_load_dwordx4 v14, s[4:7], s40 offen lds
    s_add_u32 m0, s32, 5120
    s_nop 0
    buffer_load_dwordx4 v15, s[4:7], s40 offen lds
    s_add_u32 m0, s32, 6144
    s_nop 0
    buffer_load_dwordx4 v16, s[4:7], s40 offen lds
    s_add_u32 m0, s32, 7168
    s_nop 0
    buffer_load_dwordx4 v17, s[4:7], s40 offen lds
    s_add_u32 s32, s29, s45
    s_add_u32 m0, s32, 32768
    s_nop 0
    buffer_load_dwordx4 v18, s[16:19], s42 offen lds
    s_add_u32 m0, s32, 33792
    s_nop 0
    buffer_load_dwordx4 v19, s[16:19], s42 offen lds
    s_add_u32 m0, s32, 40960
    s_nop 0
    buffer_load_dwordx4 v18, s[16:19], s43 offen lds
    s_add_u32 m0, s32, 41984
    s_nop 0
    buffer_load_dwordx4 v19, s[16:19], s43 offen lds
    s_add_u32 s32, s29, s46
    s_add_u32 m0, s32, 49152
    s_nop 0
    buffer_load_dwordx4 v20, s[16:19], s41 offen lds
    s_add_u32 s40, s40, 128
    s_add_u32 s41, s41, 393216
    s_add_u32 s42, s42, 393216
    s_add_u32 s43, s43, 393216
    s_cmp_eq_u32 s40, 2048
    s_cselect_b32 s40, 0, s40
    s_cselect_b32 s41, 0, s41
    s_cselect_b32 s42, 2048, s42
    s_cselect_b32 s43, 4096, s43
    s_add_u32 s29, s29, 53248
    s_cmp_eq_u32 s29, 159744
    s_cselect_b32 s29, 0, s29
    s_mov_b32 s96, s16
    s_mov_b32 s97, s17
    s_mov_b32 s98, 6291456
    s_mov_b32 s99, 0x20000
    s_mov_b32 s95, 786432
    s_cmp_eq_u32 s24, 4
    s_cselect_b32 s96, s4, s96
    s_cselect_b32 s97, s5, s97
    s_cselect_b32 s98, 4194304, s98
    s_cselect_b32 s95, 256, s95
    s_cmp_eq_u32 s24, 5
    s_cselect_b32 s96, s8, s96
    s_cselect_b32 s97, s9, s97
    s_cselect_b32 s98, 2097152, s98
    s_cselect_b32 s95, 256, s95
    s_cmp_eq_u32 s24, 6
    s_cselect_b32 s96, s12, s96
    s_cselect_b32 s97, s13, s97
    s_cselect_b32 s98, 2097152, s98
    s_cselect_b32 s95, 256, s95
    v_and_b32 v240, 63, v0
    s_add_u32 s33, s31, 0
    s_and_b32 s33, s33, 31
    s_lshl_b32 s32, s3, 5
    s_add_u32 s32, s32, s33
    s_lshl_b32 s32, s32, 3
    v_and_b32 v243, 7, v240
    v_add_u32 v243, s32, v243
    v_lshlrev_b32 v243, 11, v243
    v_bfe_u32 v244, v240, 3, 1
    v_lshlrev_b32 v244, 7, v244
    v_add_u32 v243, v243, v244
    s_lshl_b32 s32, s2, 2
    v_and_b32 v245, 3, v240
    v_add_u32 v245, s32, v245
    v_lshlrev_b32 v245, 11, v245
    v_bfe_u32 v244, v240, 2, 1
    v_lshlrev_b32 v244, 7, v244
    v_add_u32 v245, v245, v244
    v_min_u32 v246, 23, v240
    v_cmp_lt_u32 vcc, 11, v246
    v_subrev_u32 v244, 12, v246
    s_nop 0
    v_cndmask_b32 v246, v246, v244, vcc
    s_mul_i32 s32, s2, 12
    v_add_u32 v246, s32, v246
    v_lshlrev_b32 v246, 7, v246
    v_mov_b32 v244, 393216
    v_cndmask_b32 v244, 0, v244, vcc
    v_add_u32 v246, v246, v244
    s_cmp_eq_u32 s24, 4
    s_cselect_b64 vcc, -1, 0
    v_cndmask_b32 v245, v245, v243, vcc
    s_cmp_eq_u32 s24, 7
    s_cselect_b64 vcc, -1, 0
    v_cndmask_b32 v241, v245, v246, vcc
    s_lshr_b32 s94, s95, 1
    s_mul_i32 s94, s94, 3
    v_lshlrev_b32 v242, 7, v240
    v_min_u32 v247, 63, v240
    v_lshlrev_b32 v247, 7, v247
    s_lshl_b32 s47, s2, 13
    s_cmp_eq_u32 s24, 7
    s_cselect_b32 s58, 341, 341
    buffer_load_dword v243, v241, s[96:99], s94 offen
    s_add_u32 s94, s94, s95
    buffer_load_dword v243, v241, s[96:99], s94 offen
    s_add_u32 s94, s94, s95
    s_waitcnt vmcnt(15)
    s_barrier
    s_add_u32 s32, s29, s44
    s_mov_b32 m0, s32
    s_nop 0
    buffer_load_dwordx4 v10, s[4:7], s40 offen lds
    s_add_u32 m0, s32, 1024
    s_nop 0
    buffer_load_dwordx4 v11, s[4:7], s40 offen lds
    s_add_u32 m0, s32, 2048
    s_nop 0
    buffer_load_dwordx4 v12, s[4:7], s40 offen lds
    s_add_u32 m0, s32, 3072
    s_nop 0
    buffer_load_dwordx4 v13, s[4:7], s40 offen lds
    s_add_u32 m0, s32, 4096
    s_nop 0
    buffer_load_dwordx4 v14, s[4:7], s40 offen lds
    s_add_u32 m0, s32, 5120
    s_nop 0
    buffer_load_dwordx4 v15, s[4:7], s40 offen lds
    s_add_u32 m0, s32, 6144
    s_nop 0
    buffer_load_dwordx4 v16, s[4:7], s40 offen lds
    s_add_u32 m0, s32, 7168
    s_nop 0
    buffer_load_dwordx4 v17, s[4:7], s40 offen lds
    s_add_u32 s32, s29, s45
    s_add_u32 m0, s32, 32768
    s_nop 0
    buffer_load_dwordx4 v18, s[16:19], s42 offen lds
    s_add_u32 m0, s32, 33792
    s_nop 0
    buffer_load_dwordx4 v19, s[16:19], s42 offen lds
    s_add_u32 m0, s32, 40960
    s_nop 0
    buffer_load_dwordx4 v18, s[16:19], s43 offen lds
    s_add_u32 m0, s32, 41984
    s_nop 0
    buffer_load_dwordx4 v19, s[16:19], s43 offen lds
    s_add_u32 s32, s29, s46
    s_add_u32 m0, s32, 49152
    s_nop 0
    buffer_load_dwordx4 v20, s[16:19], s41 offen lds
    s_add_u32 s40, s40, 128
    s_add_u32 s41, s41, 393216
    s_add_u32 s42, s42, 393216
    s_add_u32 s43, s43, 393216
    s_cmp_eq_u32 s40, 2048
    s_cselect_b32 s40, 0, s40
    s_cselect_b32 s41, 0, s41
    s_cselect_b32 s42, 2048, s42
    s_cselect_b32 s43, 4096, s43
    s_add_u32 s29, s29, 53248
    s_cmp_eq_u32 s29, 159744
    s_cselect_b32 s29, 0, s29
    s_waitcnt vmcnt(15)
    s_barrier
    s_add_u32 s32, s29, s44
    s_mov_b32 m0, s32
    s_nop 0
    buffer_load_dwordx4 v10, s[4:7], s40 offen lds
    s_add_u32 m0, s32, 1024
    s_nop 0
    buffer_load_dwordx4 v11, s[4:7], s40 offen lds
    s_add_u32 m0, s32, 2048
    s_nop 0
    buffer_load_dwordx4 v12, s[4:7], s40 offen lds
    s_add_u32 m0, s32, 3072
    s_nop 0
    buffer_load_dwordx4 v13, s[4:7], s40 offen lds
    s_add_u32 m0, s32, 4096
    s_nop 0
    buffer_load_dwordx4 v14, s[4:7], s40 offen lds
    s_add_u32 m0, s32, 5120
    s_nop 0
    buffer_load_dwordx4 v15, s[4:7], s40 offen lds
    s_add_u32 m0, s32, 6144
    s_nop 0
    buffer_load_dwordx4 v16, s[4:7], s40 offen lds
    s_add_u32 m0, s32, 7168
    s_nop 0
    buffer_load_dwordx4 v17, s[4:7], s40 offen lds
    s_add_u32 s32, s29, s45
    s_add_u32 m0, s32, 32768
    s_nop 0
    buffer_load_dwordx4 v18, s[16:19], s42 offen lds
    s_add_u32 m0, s32, 33792
    s_nop 0
    buffer_load_dwordx4 v19, s[16:19], s42 offen lds
    s_add_u32 m0, s32, 40960
    s_nop 0
    buffer_load_dwordx4 v18, s[16:19], s43 offen lds
    s_add_u32 m0, s32, 41984
    s_nop 0
    buffer_load_dwordx4 v19, s[16:19], s43 offen lds
    s_add_u32 s32, s29, s46
    s_add_u32 m0, s32, 49152
    s_nop 0
    buffer_load_dwordx4 v20, s[16:19], s41 offen lds
    s_add_u32 s40, s40, 128
    s_add_u32 s41, s41, 393216
    s_add_u32 s42, s42, 393216
    s_add_u32 s43, s43, 393216
    s_cmp_eq_u32 s40, 2048
    s_cselect_b32 s40, 0, s40
    s_cselect_b32 s41, 0, s41
    s_cselect_b32 s42, 2048, s42
    s_cselect_b32 s43, 4096, s43
    s_add_u32 s29, s29, 53248
    s_cmp_eq_u32 s29, 159744
    s_cselect_b32 s29, 0, s29
    s_mov_b32 s28, 0
    s_lshr_b32 s36, s58, s28
    s_bitcmp1_b32 s36, 0
    s_cselect_b32 s36, s94, 0x80000000
    s_cselect_b32 s37, s95, 0
    buffer_load_dword v243, v241, s[96:99], s36 offen
    s_add_u32 s94, s94, s37
    s_lshr_b32 s36, 4096, s28
    s_bitcmp1_b32 s36, 0
    s_cselect_b32 s36, s47, 0x80000000
    s_cselect_b32 s37, 8192, 0
    buffer_load_dword v244, v247, s[88:91], s36 offen
    s_add_u32 s47, s47, s37
    s_waitcnt vmcnt(15)
    s_barrier
    s_add_u32 s32, s29, s44
    s_mov_b32 m0, s32
    s_nop 0
    buffer_load_dwordx4 v10, s[4:7], s40 offen lds
    s_add_u32 m0, s32, 1024
    s_nop 0
    buffer_load_dwordx4 v11, s[4:7], s40 offen lds
    s_add_u32 m0, s32, 2048
    s_nop 0
    buffer_load_dwordx4 v12, s[4:7], s40 offen lds
    s_add_u32 m0, s32, 3072
    s_nop 0
    buffer_load_dwordx4 v13, s[4:7], s40 offen lds
    s_add_u32 m0, s32, 4096
    s_nop 0
    buffer_load_dwordx4 v14, s[4:7], s40 offen lds
    s_add_u32 m0, s32, 5120
    s_nop 0
    buffer_load_dwordx4 v15, s[4:7], s40 offen lds
    s_add_u32 m0, s32, 6144
    s_nop 0
    buffer_load_dwordx4 v16, s[4:7], s40 offen lds
    s_add_u32 m0, s32, 7168
    s_nop 0
    buffer_load_dwordx4 v17, s[4:7], s40 offen lds
    s_add_u32 s32, s29, s45
    s_add_u32 m0, s32, 32768
    s_nop 0
    buffer_load_dwordx4 v18, s[16:19], s42 offen lds
    s_add_u32 m0, s32, 33792
    s_nop 0
    buffer_load_dwordx4 v19, s[16:19], s42 offen lds
    s_add_u32 m0, s32, 40960
    s_nop 0
    buffer_load_dwordx4 v18, s[16:19], s43 offen lds
    s_add_u32 m0, s32, 41984
    s_nop 0
    buffer_load_dwordx4 v19, s[16:19], s43 offen lds
    s_add_u32 s32, s29, s46
    s_add_u32 m0, s32, 49152
    s_nop 0
    buffer_load_dwordx4 v20, s[16:19], s41 offen lds
    s_add_u32 s40, s40, 128
    s_add_u32 s41, s41, 393216
    s_add_u32 s42, s42, 393216
    s_add_u32 s43, s43, 393216
    s_cmp_eq_u32 s40, 2048
    s_cselect_b32 s40, 0, s40
    s_cselect_b32 s41, 0, s41
    s_cselect_b32 s42, 2048, s42
    s_cselect_b32 s43, 4096, s43
    s_add_u32 s29, s29, 53248
    s_cmp_eq_u32 s29, 159744
    s_cselect_b32 s29, 0, s29
    s_mov_b32 s28, 1
    s_lshr_b32 s36, s58, s28
    s_bitcmp1_b32 s36, 0
    s_cselect_b32 s36, s94, 0x80000000
    s_cselect_b32 s37, s95, 0
    buffer_load_dword v243, v241, s[96:99], s36 offen
    s_add_u32 s94, s94, s37
    s_lshr_b32 s36, 4096, s28
    s_bitcmp1_b32 s36, 0
    s_cselect_b32 s36, s47, 0x80000000
    s_cselect_b32 s37, 8192, 0
    buffer_load_dword v244, v247, s[88:91], s36 offen
    s_add_u32 s47, s47, s37
    s_waitcnt vmcnt(17)
    v_mov_b32 v60, 159768
    ds_read_b32 v62, v60
    s_waitcnt lgkmcnt(0)
    v_readfirstlane_b32 s68, v62
    v_mov_b32 v64, 0
    v_mov_b32 v65, 0
    v_mov_b32 v66, 0
    v_mov_b32 v67, 0
    v_and_b32 v68, 63, v0
    v_lshlrev_b32 v68, 4, v68
    s_lshl_b32 s32, s26, 1
    s_mul_i32 s32, s32, 4608
    s_mul_i32 s33, s25, 576
    s_add_u32 s32, s32, s33
    s_add_u32 s32, s32, 264241152
    s_add_u32 s33, s32, 4608
    s_mov_b64 s[74:75], exec
    s_mov_b32 exec_lo, -1
    s_mov_b32 exec_hi, 15
    buffer_store_dwordx4 v[64:67], v68, s[20:23], s32 offen sc1
    buffer_store_dwordx4 v[64:67], v68, s[20:23], s33 offen sc1
    s_mov_b64 exec, s[74:75]
    s_barrier
    s_add_u32 s32, s29, s44
    s_mov_b32 m0, s32
    s_nop 0
    buffer_load_dwordx4 v10, s[4:7], s40 offen lds
    s_add_u32 m0, s32, 1024
    s_nop 0
    buffer_load_dwordx4 v11, s[4:7], s40 offen lds
    s_add_u32 m0, s32, 2048
    s_nop 0
    buffer_load_dwordx4 v12, s[4:7], s40 offen lds
    s_add_u32 m0, s32, 3072
    s_nop 0
    buffer_load_dwordx4 v13, s[4:7], s40 offen lds
    s_add_u32 m0, s32, 4096
    s_nop 0
    buffer_load_dwordx4 v14, s[4:7], s40 offen lds
    s_add_u32 m0, s32, 5120
    s_nop 0
    buffer_load_dwordx4 v15, s[4:7], s40 offen lds
    s_add_u32 m0, s32, 6144
    s_nop 0
    buffer_load_dwordx4 v16, s[4:7], s40 offen lds
    s_add_u32 m0, s32, 7168
    s_nop 0
    buffer_load_dwordx4 v17, s[4:7], s40 offen lds
    s_add_u32 s32, s29, s45
    s_add_u32 m0, s32, 32768
    s_nop 0
    buffer_load_dwordx4 v18, s[16:19], s42 offen lds
    s_add_u32 m0, s32, 33792
    s_nop 0
    buffer_load_dwordx4 v19, s[16:19], s42 offen lds
    s_add_u32 m0, s32, 40960
    s_nop 0
    buffer_load_dwordx4 v18, s[16:19], s43 offen lds
    s_add_u32 m0, s32, 41984
    s_nop 0
    buffer_load_dwordx4 v19, s[16:19], s43 offen lds
    s_add_u32 s32, s29, s46
    s_add_u32 m0, s32, 49152
    s_nop 0
    buffer_load_dwordx4 v20, s[16:19], s41 offen lds
    s_add_u32 s40, s40, 128
    s_add_u32 s41, s41, 393216
    s_add_u32 s42, s42, 393216
    s_add_u32 s43, s43, 393216
    s_cmp_eq_u32 s40, 2048
    s_cselect_b32 s40, 0, s40
    s_cselect_b32 s41, 0, s41
    s_cselect_b32 s42, 2048, s42
    s_cselect_b32 s43, 4096, s43
    s_add_u32 s29, s29, 53248
    s_cmp_eq_u32 s29, 159744
    s_cselect_b32 s29, 0, s29
    s_mov_b32 s28, 2
    s_lshr_b32 s36, s58, s28
    s_bitcmp1_b32 s36, 0
    s_cselect_b32 s36, s94, 0x80000000
    s_cselect_b32 s37, s95, 0
    buffer_load_dword v243, v241, s[96:99], s36 offen
    s_add_u32 s94, s94, s37
    s_lshr_b32 s36, 4096, s28
    s_bitcmp1_b32 s36, 0
    s_cselect_b32 s36, s47, 0x80000000
    s_cselect_b32 s37, 8192, 0
    buffer_load_dword v244, v247, s[88:91], s36 offen
    s_add_u32 s47, s47, s37
    s_waitcnt vmcnt(17)
    s_waitcnt vmcnt(15)
    s_lshl_b32 s32, s26, 8
    s_lshl_b32 s33, s25, 2
    s_add_u32 s32, s32, s33
    s_add_u32 s32, s32, 265289728
    v_mov_b32 v64, s68
    v_mov_b32 v65, s32
    s_mov_b64 s[74:75], exec
    s_mov_b64 exec, 1
    buffer_store_dword v64, v65, s[20:23], 0 offen sc1
    buffer_store_dword v64, v65, s[20:23], 0 offen offset:128 sc1
    s_mov_b64 exec, s[74:75]
    s_mov_b32 s28, 3
L_ploopBz:
    s_barrier
    s_add_u32 s32, s29, s44
    s_mov_b32 m0, s32
    s_nop 0
    buffer_load_dwordx4 v10, s[4:7], s40 offen lds
    s_add_u32 m0, s32, 1024
    s_nop 0
    buffer_load_dwordx4 v11, s[4:7], s40 offen lds
    s_add_u32 m0, s32, 2048
    s_nop 0
    buffer_load_dwordx4 v12, s[4:7], s40 offen lds
    s_add_u32 m0, s32, 3072
    s_nop 0
    buffer_load_dwordx4 v13, s[4:7], s40 offen lds
    s_add_u32 m0, s32, 4096
    s_nop 0
    buffer_load_dwordx4 v14, s[4:7], s40 offen lds
    s_add_u32 m0, s32, 5120
    s_nop 0
    buffer_load_dwordx4 v15, s[4:7], s40 offen lds
    s_add_u32 m0, s32, 6144
    s_nop 0
    buffer_load_dwordx4 v16, s[4:7], s40 offen lds
    s_add_u32 m0, s32, 7168
    s_nop 0
    buffer_load_dwordx4 v17, s[4:7], s40 offen lds
    s_add_u32 s32, s29, s45
    s_add_u32 m0, s32, 32768
    s_nop 0
    buffer_load_dwordx4 v18, s[16:19], s42 offen lds
    s_add_u32 m0, s32, 33792
    s_nop 0
    buffer_load_dwordx4 v19, s[16:19], s42 offen lds
    s_add_u32 m0, s32, 40960
    s_nop 0
    buffer_load_dwordx4 v18, s[16:19], s43 offen lds
    s_add_u32 m0, s32, 41984
    s_nop 0
    buffer_load_dwordx4 v19, s[16:19], s43 offen lds
    s_add_u32 s32, s29, s46
    s_add_u32 m0, s32, 49152
    s_nop 0
    buffer_load_dwordx4 v20, s[16:19], s41 offen lds
    s_add_u32 s40, s40, 128
    s_add_u32 s41, s41, 393216
    s_add_u32 s42, s42, 393216
    s_add_u32 s43, s43, 393216
    s_cmp_eq_u32 s40, 2048
    s_cselect_b32 s40, 0, s40
    s_cselect_b32 s41, 0, s41
    s_cselect_b32 s42, 2048, s42
    s_cselect_b32 s43, 4096, s43
    s_add_u32 s29, s29, 53248
    s_cmp_eq_u32 s29, 159744
    s_cselect_b32 s29, 0, s29
    s_lshr_b32 s36, s58, s28
    s_bitcmp1_b32 s36, 0
    s_cselect_b32 s36, s94, 0x80000000
    s_cselect_b32 s37, s95, 0
    buffer_load_dword v243, v241, s[96:99], s36 offen
    s_add_u32 s94, s94, s37
    s_lshr_b32 s36, 4096, s28
    s_bitcmp1_b32 s36, 0
    s_cselect_b32 s36, s47, 0x80000000
    s_cselect_b32 s37, 8192, 0
    buffer_load_dword v244, v247, s[88:91], s36 offen
    s_add_u32 s47, s47, s37
    s_waitcnt vmcnt(17)
    s_add_u32 s28, s28, 1
    s_cmp_lt_u32 s28, 13
    s_cbranch_scc1 L_ploopBz
    s_barrier
    s_waitcnt vmcnt(0)
    s_cmp_lg_u32 s24, 7
    s_cbranch_scc1 L_cp_46
    s_getpc_b64 s[32:33]
L_pc_47:
    s_sub_u32 s32, s32, L_pc_47-gated_mix__ssm_conv_s5__linear_attn_block__prompt_kernel
    s_subb_u32 s33, s33, 0
    s_lshl_b32 s34, s31, 4
    v_and_b32 v245, 15, v0
    v_add_u32 v245, s34, v245
    v_lshlrev_b32 v245, 7, v245
    v_min_u32 v245, L_end-gated_mix__ssm_conv_s5__linear_attn_block__prompt_kernel, v245
    global_load_dword v246, v245, s[32:33]
L_cp_46:
    s_barrier
    s_barrier
    s_branch L_helpB_join
L_p2_al:
    s_sub_u32 s32, s24, 4
    v_and_b32 v1, 63, v0
    v_lshrrev_b32 v2, 3, v1
    v_and_b32 v3, 7, v1
    s_lshl_b32 s33, s25, 4
    s_lshl_b32 s34, s32, 3
    s_add_u32 s33, s33, s34
    s_lshl_b32 s33, s33, 10
    v_lshlrev_b32 v4, 4, v1
    v_xor_b32 v5, 0, v4
    v_add_u32 v5, s33, v5
    v_add_u32 v10, 0, v5
    v_xor_b32 v5, 64, v4
    v_add_u32 v5, s33, v5
    v_add_u32 v11, 1024, v5
    v_xor_b32 v5, 128, v4
    v_add_u32 v5, s33, v5
    v_add_u32 v12, 2048, v5
    v_xor_b32 v5, 192, v4
    v_add_u32 v5, s33, v5
    v_add_u32 v13, 3072, v5
    v_xor_b32 v5, 0, v4
    v_add_u32 v5, s33, v5
    v_add_u32 v14, 4096, v5
    v_xor_b32 v5, 64, v4
    v_add_u32 v5, s33, v5
    v_add_u32 v15, 5120, v5
    v_xor_b32 v5, 128, v4
    v_add_u32 v5, s33, v5
    v_add_u32 v16, 6144, v5
    v_xor_b32 v5, 192, v4
    v_add_u32 v5, s33, v5
    v_add_u32 v17, 7168, v5
    s_lshl_b32 s33, s25, 7
    s_lshl_b32 s34, s32, 6
    s_add_u32 s33, s33, s34
    v_add_u32 v4, s33, v2
    v_lshlrev_b32 v4, 11, v4
    v_lshrrev_b32 v5, 1, v2
    v_xor_b32 v5, v3, v5
    v_lshlrev_b32 v5, 4, v5
    v_add_u32 v6, v4, v5
    v_xor_b32 v7, 64, v6
    v_add_u32 v20, 0, v6
    v_add_u32 v21, 16384, v7
    v_add_u32 v22, 32768, v6
    v_add_u32 v23, 49152, v7
    v_add_u32 v24, 65536, v6
    v_add_u32 v25, 81920, v7
    v_add_u32 v26, 98304, v6
    v_add_u32 v27, 114688, v7
    s_lshl_b32 s44, s32, 13
    s_mov_b32 s42, 0
L_p2_al_poll:
    s_lshl_b32 s32, s3, 7
    s_add_u32 s32, s32, 266608640
    v_and_b32 v2, 15, v0
    v_lshlrev_b32 v2, 2, v2
    s_mov_b32 s33, 0
L_fp_48:
    buffer_load_dword v3, v2, s[20:23], s32 offen sc1
    s_waitcnt vmcnt(0)
    v_cmp_eq_u32 vcc, s68, v3
    s_cmp_eq_u64 vcc, exec
    s_cbranch_scc1 L_fo_49
    s_add_u32 s33, s33, 1
    s_cmp_lt_u32 s33, 131072
    s_cbranch_scc1 L_fp_48
L_fo_49:
    s_mov_b32 s47, 0
    s_mov_b32 s43, 251658240
    s_mov_b32 s40, 251658240
    s_add_u32 s32, s42, s44
    s_mov_b32 m0, s32
    s_nop 0
    buffer_load_dwordx4 v10, s[20:23], s40 offen sc1 lds
    s_add_u32 m0, s32, 1024
    s_nop 0
    buffer_load_dwordx4 v11, s[20:23], s40 offen sc1 lds
    s_add_u32 m0, s32, 2048
    s_nop 0
    buffer_load_dwordx4 v12, s[20:23], s40 offen sc1 lds
    s_add_u32 m0, s32, 3072
    s_nop 0
    buffer_load_dwordx4 v13, s[20:23], s40 offen sc1 lds
    s_add_u32 m0, s32, 4096
    s_nop 0
    buffer_load_dwordx4 v14, s[20:23], s40 offen sc1 lds
    s_add_u32 m0, s32, 5120
    s_nop 0
    buffer_load_dwordx4 v15, s[20:23], s40 offen sc1 lds
    s_add_u32 m0, s32, 6144
    s_nop 0
    buffer_load_dwordx4 v16, s[20:23], s40 offen sc1 lds
    s_add_u32 m0, s32, 7168
    s_nop 0
    buffer_load_dwordx4 v17, s[20:23], s40 offen sc1 lds
    s_add_u32 s47, s47, 1
    s_and_b32 s47, s47, 15
    s_mul_i32 s40, s47, 262144
    s_add_u32 s40, s40, s43
    s_add_u32 s42, s42, 16384
    s_cmp_eq_u32 s42, 98304
    s_cselect_b32 s42, 0, s42
    s_add_u32 s32, s42, s44
    s_mov_b32 m0, s32
    s_nop 0
    buffer_load_dwordx4 v10, s[20:23], s40 offen sc1 lds
    s_add_u32 m0, s32, 1024
    s_nop 0
    buffer_load_dwordx4 v11, s[20:23], s40 offen sc1 lds
    s_add_u32 m0, s32, 2048
    s_nop 0
    buffer_load_dwordx4 v12, s[20:23], s40 offen sc1 lds
    s_add_u32 m0, s32, 3072
    s_nop 0
    buffer_load_dwordx4 v13, s[20:23], s40 offen sc1 lds
    s_add_u32 m0, s32, 4096
    s_nop 0
    buffer_load_dwordx4 v14, s[20:23], s40 offen sc1 lds
    s_add_u32 m0, s32, 5120
    s_nop 0
    buffer_load_dwordx4 v15, s[20:23], s40 offen sc1 lds
    s_add_u32 m0, s32, 6144
    s_nop 0
    buffer_load_dwordx4 v16, s[20:23], s40 offen sc1 lds
    s_add_u32 m0, s32, 7168
    s_nop 0
    buffer_load_dwordx4 v17, s[20:23], s40 offen sc1 lds
    s_add_u32 s47, s47, 1
    s_and_b32 s47, s47, 15
    s_mul_i32 s40, s47, 262144
    s_add_u32 s40, s40, s43
    s_add_u32 s42, s42, 16384
    s_cmp_eq_u32 s42, 98304
    s_cselect_b32 s42, 0, s42
    s_waitcnt vmcnt(0)
    s_barrier
    s_add_u32 s32, s42, s44
    s_mov_b32 m0, s32
    s_nop 0
    buffer_load_dwordx4 v10, s[20:23], s40 offen sc1 lds
    s_add_u32 m0, s32, 1024
    s_nop 0
    buffer_load_dwordx4 v11, s[20:23], s40 offen sc1 lds
    s_add_u32 m0, s32, 2048
    s_nop 0
    buffer_load_dwordx4 v12, s[20:23], s40 offen sc1 lds
    s_add_u32 m0, s32, 3072
    s_nop 0
    buffer_load_dwordx4 v13, s[20:23], s40 offen sc1 lds
    s_add_u32 m0, s32, 4096
    s_nop 0
    buffer_load_dwordx4 v14, s[20:23], s40 offen sc1 lds
    s_add_u32 m0, s32, 5120
    s_nop 0
    buffer_load_dwordx4 v15, s[20:23], s40 offen sc1 lds
    s_add_u32 m0, s32, 6144
    s_nop 0
    buffer_load_dwordx4 v16, s[20:23], s40 offen sc1 lds
    s_add_u32 m0, s32, 7168
    s_nop 0
    buffer_load_dwordx4 v17, s[20:23], s40 offen sc1 lds
    s_add_u32 s47, s47, 1
    s_and_b32 s47, s47, 15
    s_mul_i32 s40, s47, 262144
    s_add_u32 s40, s40, s43
    s_add_u32 s42, s42, 16384
    s_cmp_eq_u32 s42, 98304
    s_cselect_b32 s42, 0, s42
    s_add_u32 s32, s42, s44
    s_mov_b32 m0, s32
    s_nop 0
    buffer_load_dwordx4 v10, s[20:23], s40 offen sc1 lds
    s_add_u32 m0, s32, 1024
    s_nop 0
    buffer_load_dwordx4 v11, s[20:23], s40 offen sc1 lds
    s_add_u32 m0, s32, 2048
    s_nop 0
    buffer_load_dwordx4 v12, s[20:23], s40 offen sc1 lds
    s_add_u32 m0, s32, 3072
    s_nop 0
    buffer_load_dwordx4 v13, s[20:23], s40 offen sc1 lds
    s_add_u32 m0, s32, 4096
    s_nop 0
    buffer_load_dwordx4 v14, s[20:23], s40 offen sc1 lds
    s_add_u32 m0, s32, 5120
    s_nop 0
    buffer_load_dwordx4 v15, s[20:23], s40 offen sc1 lds
    s_add_u32 m0, s32, 6144
    s_nop 0
    buffer_load_dwordx4 v16, s[20:23], s40 offen sc1 lds
    s_add_u32 m0, s32, 7168
    s_nop 0
    buffer_load_dwordx4 v17, s[20:23], s40 offen sc1 lds
    s_add_u32 s47, s47, 1
    s_and_b32 s47, s47, 15
    s_mul_i32 s40, s47, 262144
    s_add_u32 s40, s40, s43
    s_add_u32 s42, s42, 16384
    s_cmp_eq_u32 s42, 98304
    s_cselect_b32 s42, 0, s42
    s_add_u32 s32, s42, s44
    s_mov_b32 m0, s32
    s_nop 0
    buffer_load_dwordx4 v10, s[20:23], s40 offen sc1 lds
    s_add_u32 m0, s32, 1024
    s_nop 0
    buffer_load_dwordx4 v11, s[20:23], s40 offen sc1 lds
    s_add_u32 m0, s32, 2048
    s_nop 0
    buffer_load_dwordx4 v12, s[20:23], s40 offen sc1 lds
    s_add_u32 m0, s32, 3072
    s_nop 0
    buffer_load_dwordx4 v13, s[20:23], s40 offen sc1 lds
    s_add_u32 m0, s32, 4096
    s_nop 0
    buffer_load_dwordx4 v14, s[20:23], s40 offen sc1 lds
    s_add_u32 m0, s32, 5120
    s_nop 0
    buffer_load_dwordx4 v15, s[20:23], s40 offen sc1 lds
    s_add_u32 m0, s32, 6144
    s_nop 0
    buffer_load_dwordx4 v16, s[20:23], s40 offen sc1 lds
    s_add_u32 m0, s32, 7168
    s_nop 0
    buffer_load_dwordx4 v17, s[20:23], s40 offen sc1 lds
    s_add_u32 s47, s47, 1
    s_and_b32 s47, s47, 15
    s_mul_i32 s40, s47, 262144
    s_add_u32 s40, s40, s43
    s_add_u32 s42, s42, 16384
    s_cmp_eq_u32 s42, 98304
    s_cselect_b32 s42, 0, s42
    s_add_u32 s32, s42, s44
    s_mov_b32 m0, s32
    s_nop 0
    buffer_load_dwordx4 v10, s[20:23], s40 offen sc1 lds
    s_add_u32 m0, s32, 1024
    s_nop 0
    buffer_load_dwordx4 v11, s[20:23], s40 offen sc1 lds
    s_add_u32 m0, s32, 2048
    s_nop 0
    buffer_load_dwordx4 v12, s[20:23], s40 offen sc1 lds
    s_add_u32 m0, s32, 3072
    s_nop 0
    buffer_load_dwordx4 v13, s[20:23], s40 offen sc1 lds
    s_add_u32 m0, s32, 4096
    s_nop 0
    buffer_load_dwordx4 v14, s[20:23], s40 offen sc1 lds
    s_add_u32 m0, s32, 5120
    s_nop 0
    buffer_load_dwordx4 v15, s[20:23], s40 offen sc1 lds
    s_add_u32 m0, s32, 6144
    s_nop 0
    buffer_load_dwordx4 v16, s[20:23], s40 offen sc1 lds
    s_add_u32 m0, s32, 7168
    s_nop 0
    buffer_load_dwordx4 v17, s[20:23], s40 offen sc1 lds
    s_add_u32 s47, s47, 1
    s_and_b32 s47, s47, 15
    s_mul_i32 s40, s47, 262144
    s_add_u32 s40, s40, s43
    s_add_u32 s42, s42, 16384
    s_cmp_eq_u32 s42, 98304
    s_cselect_b32 s42, 0, s42
    s_waitcnt vmcnt(16)
    s_mov_b32 s28, 0
L_al_hc:
    s_barrier
    s_add_u32 s32, s42, s44
    s_mov_b32 m0, s32
    s_nop 0
    buffer_load_dwordx4 v10, s[20:23], s40 offen sc1 lds
    s_add_u32 m0, s32, 1024
    s_nop 0
    buffer_load_dwordx4 v11, s[20:23], s40 offen sc1 lds
    s_add_u32 m0, s32, 2048
    s_nop 0
    buffer_load_dwordx4 v12, s[20:23], s40 offen sc1 lds
    s_add_u32 m0, s32, 3072
    s_nop 0
    buffer_load_dwordx4 v13, s[20:23], s40 offen sc1 lds
    s_add_u32 m0, s32, 4096
    s_nop 0
    buffer_load_dwordx4 v14, s[20:23], s40 offen sc1 lds
    s_add_u32 m0, s32, 5120
    s_nop 0
    buffer_load_dwordx4 v15, s[20:23], s40 offen sc1 lds
    s_add_u32 m0, s32, 6144
    s_nop 0
    buffer_load_dwordx4 v16, s[20:23], s40 offen sc1 lds
    s_add_u32 m0, s32, 7168
    s_nop 0
    buffer_load_dwordx4 v17, s[20:23], s40 offen sc1 lds
    s_add_u32 s47, s47, 1
    s_and_b32 s47, s47, 15
    s_mul_i32 s40, s47, 262144
    s_add_u32 s40, s40, s43
    s_add_u32 s42, s42, 16384
    s_cmp_eq_u32 s42, 98304
    s_cselect_b32 s42, 0, s42
    s_add_u32 s32, s42, s44
    s_mov_b32 m0, s32
    s_nop 0
    buffer_load_dwordx4 v10, s[20:23], s40 offen sc1 lds
    s_add_u32 m0, s32, 1024
    s_nop 0
    buffer_load_dwordx4 v11, s[20:23], s40 offen sc1 lds
    s_add_u32 m0, s32, 2048
    s_nop 0
    buffer_load_dwordx4 v12, s[20:23], s40 offen sc1 lds
    s_add_u32 m0, s32, 3072
    s_nop 0
    buffer_load_dwordx4 v13, s[20:23], s40 offen sc1 lds
    s_add_u32 m0, s32, 4096
    s_nop 0
    buffer_load_dwordx4 v14, s[20:23], s40 offen sc1 lds
    s_add_u32 m0, s32, 5120
    s_nop 0
    buffer_load_dwordx4 v15, s[20:23], s40 offen sc1 lds
    s_add_u32 m0, s32, 6144
    s_nop 0
    buffer_load_dwordx4 v16, s[20:23], s40 offen sc1 lds
    s_add_u32 m0, s32, 7168
    s_nop 0
    buffer_load_dwordx4 v17, s[20:23], s40 offen sc1 lds
    s_add_u32 s47, s47, 1
    s_and_b32 s47, s47, 15
    s_mul_i32 s40, s47, 262144
    s_add_u32 s40, s40, s43
    s_add_u32 s42, s42, 16384
    s_cmp_eq_u32 s42, 98304
    s_cselect_b32 s42, 0, s42
    s_waitcnt vmcnt(16)
    s_add_u32 s28, s28, 1
    s_cmp_lt_u32 s28, 5
    s_cbranch_scc1 L_al_hc
    s_mov_b32 s47, 0
    s_mov_b32 s43, 255852544
    s_mov_b32 s40, 255852544
    s_mov_b32 s28, 0
L_al_ic:
    s_barrier
    s_add_u32 s32, s42, s44
    s_mov_b32 m0, s32
    s_nop 0
    buffer_load_dwordx4 v10, s[20:23], s40 offen sc1 lds
    s_add_u32 m0, s32, 1024
    s_nop 0
    buffer_load_dwordx4 v11, s[20:23], s40 offen sc1 lds
    s_add_u32 m0, s32, 2048
    s_nop 0
    buffer_load_dwordx4 v12, s[20:23], s40 offen sc1 lds
    s_add_u32 m0, s32, 3072
    s_nop 0
    buffer_load_dwordx4 v13, s[20:23], s40 offen sc1 lds
    s_add_u32 m0, s32, 4096
    s_nop 0
    buffer_load_dwordx4 v14, s[20:23], s40 offen sc1 lds
    s_add_u32 m0, s32, 5120
    s_nop 0
    buffer_load_dwordx4 v15, s[20:23], s40 offen sc1 lds
    s_add_u32 m0, s32, 6144
    s_nop 0
    buffer_load_dwordx4 v16, s[20:23], s40 offen sc1 lds
    s_add_u32 m0, s32, 7168
    s_nop 0
    buffer_load_dwordx4 v17, s[20:23], s40 offen sc1 lds
    s_add_u32 s47, s47, 1
    s_and_b32 s47, s47, 15
    s_mul_i32 s40, s47, 262144
    s_add_u32 s40, s40, s43
    s_add_u32 s42, s42, 16384
    s_cmp_eq_u32 s42, 98304
    s_cselect_b32 s42, 0, s42
    s_add_u32 s32, s42, s44
    s_mov_b32 m0, s32
    s_nop 0
    buffer_load_dwordx4 v10, s[20:23], s40 offen sc1 lds
    s_add_u32 m0, s32, 1024
    s_nop 0
    buffer_load_dwordx4 v11, s[20:23], s40 offen sc1 lds
    s_add_u32 m0, s32, 2048
    s_nop 0
    buffer_load_dwordx4 v12, s[20:23], s40 offen sc1 lds
    s_add_u32 m0, s32, 3072
    s_nop 0
    buffer_load_dwordx4 v13, s[20:23], s40 offen sc1 lds
    s_add_u32 m0, s32, 4096
    s_nop 0
    buffer_load_dwordx4 v14, s[20:23], s40 offen sc1 lds
    s_add_u32 m0, s32, 5120
    s_nop 0
    buffer_load_dwordx4 v15, s[20:23], s40 offen sc1 lds
    s_add_u32 m0, s32, 6144
    s_nop 0
    buffer_load_dwordx4 v16, s[20:23], s40 offen sc1 lds
    s_add_u32 m0, s32, 7168
    s_nop 0
    buffer_load_dwordx4 v17, s[20:23], s40 offen sc1 lds
    s_add_u32 s47, s47, 1
    s_and_b32 s47, s47, 15
    s_mul_i32 s40, s47, 262144
    s_add_u32 s40, s40, s43
    s_add_u32 s42, s42, 16384
    s_cmp_eq_u32 s42, 98304
    s_cselect_b32 s42, 0, s42
    s_waitcnt vmcnt(16)
    s_add_u32 s28, s28, 1
    s_cmp_lt_u32 s28, 8
    s_cbranch_scc1 L_al_ic
    s_lshl_b32 s46, s26, 7
    s_mov_b32 s47, 0
    s_mov_b32 s43, 260046848
    s_mov_b32 s40, 260046848
    s_barrier
    s_add_u32 s32, s42, s44
    s_mov_b32 m0, s32
    s_nop 0
    buffer_load_dwordx4 v20, s[4:7], s46 offen lds
    s_add_u32 m0, s32, 1024
    s_nop 0
    buffer_load_dwordx4 v21, s[4:7], s46 offen lds
    s_add_u32 m0, s32, 2048
    s_nop 0
    buffer_load_dwordx4 v22, s[4:7], s46 offen lds
    s_add_u32 m0, s32, 3072
    s_nop 0
    buffer_load_dwordx4 v23, s[4:7], s46 offen lds
    s_add_u32 m0, s32, 4096
    s_nop 0
    buffer_load_dwordx4 v24, s[4:7], s46 offen lds
    s_add_u32 m0, s32, 5120
    s_nop 0
    buffer_load_dwordx4 v25, s[4:7], s46 offen lds
    s_add_u32 m0, s32, 6144
    s_nop 0
    buffer_load_dwordx4 v26, s[4:7], s46 offen lds
    s_add_u32 m0, s32, 7168
    s_nop 0
    buffer_load_dwordx4 v27, s[4:7], s46 offen lds
    s_add_u32 s42, s42, 16384
    s_cmp_eq_u32 s42, 98304
    s_cselect_b32 s42, 0, s42
    s_waitcnt vmcnt(8)
    s_barrier
    s_add_u32 s32, s42, s44
    s_mov_b32 m0, s32
    s_nop 0
    buffer_load_dwordx4 v20, s[20:23], s40 offen sc1 lds
    s_add_u32 m0, s32, 1024
    s_nop 0
    buffer_load_dwordx4 v21, s[20:23], s40 offen sc1 lds
    s_add_u32 m0, s32, 2048
    s_nop 0
    buffer_load_dwordx4 v22, s[20:23], s40 offen sc1 lds
    s_add_u32 m0, s32, 3072
    s_nop 0
    buffer_load_dwordx4 v23, s[20:23], s40 offen sc1 lds
    s_add_u32 m0, s32, 4096
    s_nop 0
    buffer_load_dwordx4 v24, s[20:23], s40 offen sc1 lds
    s_add_u32 m0, s32, 5120
    s_nop 0
    buffer_load_dwordx4 v25, s[20:23], s40 offen sc1 lds
    s_add_u32 m0, s32, 6144
    s_nop 0
    buffer_load_dwordx4 v26, s[20:23], s40 offen sc1 lds
    s_add_u32 m0, s32, 7168
    s_nop 0
    buffer_load_dwordx4 v27, s[20:23], s40 offen sc1 lds
    s_add_u32 s47, s47, 1
    s_and_b32 s47, s47, 15
    s_mul_i32 s40, s47, 128
    s_add_u32 s40, s40, s43
    s_add_u32 s42, s42, 16384
    s_cmp_eq_u32 s42, 98304
    s_cselect_b32 s42, 0, s42
    s_add_u32 s32, s42, s44
    s_mov_b32 m0, s32
    s_nop 0
    buffer_load_dwordx4 v20, s[20:23], s40 offen sc1 lds
    s_add_u32 m0, s32, 1024
    s_nop 0
    buffer_load_dwordx4 v21, s[20:23], s40 offen sc1 lds
    s_add_u32 m0, s32, 2048
    s_nop 0
    buffer_load_dwordx4 v22, s[20:23], s40 offen sc1 lds
    s_add_u32 m0, s32, 3072
    s_nop 0
    buffer_load_dwordx4 v23, s[20:23], s40 offen sc1 lds
    s_add_u32 m0, s32, 4096
    s_nop 0
    buffer_load_dwordx4 v24, s[20:23], s40 offen sc1 lds
    s_add_u32 m0, s32, 5120
    s_nop 0
    buffer_load_dwordx4 v25, s[20:23], s40 offen sc1 lds
    s_add_u32 m0, s32, 6144
    s_nop 0
    buffer_load_dwordx4 v26, s[20:23], s40 offen sc1 lds
    s_add_u32 m0, s32, 7168
    s_nop 0
    buffer_load_dwordx4 v27, s[20:23], s40 offen sc1 lds
    s_add_u32 s47, s47, 1
    s_and_b32 s47, s47, 15
    s_mul_i32 s40, s47, 128
    s_add_u32 s40, s40, s43
    s_add_u32 s42, s42, 16384
    s_cmp_eq_u32 s42, 98304
    s_cselect_b32 s42, 0, s42
    s_add_u32 s32, s42, s44
    s_mov_b32 m0, s32
    s_nop 0
    buffer_load_dwordx4 v20, s[20:23], s40 offen sc1 lds
    s_add_u32 m0, s32, 1024
    s_nop 0
    buffer_load_dwordx4 v21, s[20:23], s40 offen sc1 lds
    s_add_u32 m0, s32, 2048
    s_nop 0
    buffer_load_dwordx4 v22, s[20:23], s40 offen sc1 lds
    s_add_u32 m0, s32, 3072
    s_nop 0
    buffer_load_dwordx4 v23, s[20:23], s40 offen sc1 lds
    s_add_u32 m0, s32, 4096
    s_nop 0
    buffer_load_dwordx4 v24, s[20:23], s40 offen sc1 lds
    s_add_u32 m0, s32, 5120
    s_nop 0
    buffer_load_dwordx4 v25, s[20:23], s40 offen sc1 lds
    s_add_u32 m0, s32, 6144
    s_nop 0
    buffer_load_dwordx4 v26, s[20:23], s40 offen sc1 lds
    s_add_u32 m0, s32, 7168
    s_nop 0
    buffer_load_dwordx4 v27, s[20:23], s40 offen sc1 lds
    s_add_u32 s47, s47, 1
    s_and_b32 s47, s47, 15
    s_mul_i32 s40, s47, 128
    s_add_u32 s40, s40, s43
    s_add_u32 s42, s42, 16384
    s_cmp_eq_u32 s42, 98304
    s_cselect_b32 s42, 0, s42
    s_waitcnt vmcnt(16)
    s_mov_b32 s28, 0
L_al_oc:
    s_barrier
    s_add_u32 s32, s42, s44
    s_mov_b32 m0, s32
    s_nop 0
    buffer_load_dwordx4 v20, s[20:23], s40 offen sc1 lds
    s_add_u32 m0, s32, 1024
    s_nop 0
    buffer_load_dwordx4 v21, s[20:23], s40 offen sc1 lds
    s_add_u32 m0, s32, 2048
    s_nop 0
    buffer_load_dwordx4 v22, s[20:23], s40 offen sc1 lds
    s_add_u32 m0, s32, 3072
    s_nop 0
    buffer_load_dwordx4 v23, s[20:23], s40 offen sc1 lds
    s_add_u32 m0, s32, 4096
    s_nop 0
    buffer_load_dwordx4 v24, s[20:23], s40 offen sc1 lds
    s_add_u32 m0, s32, 5120
    s_nop 0
    buffer_load_dwordx4 v25, s[20:23], s40 offen sc1 lds
    s_add_u32 m0, s32, 6144
    s_nop 0
    buffer_load_dwordx4 v26, s[20:23], s40 offen sc1 lds
    s_add_u32 m0, s32, 7168
    s_nop 0
    buffer_load_dwordx4 v27, s[20:23], s40 offen sc1 lds
    s_add_u32 s47, s47, 1
    s_and_b32 s47, s47, 15
    s_mul_i32 s40, s47, 128
    s_add_u32 s40, s40, s43
    s_add_u32 s42, s42, 16384
    s_cmp_eq_u32 s42, 98304
    s_cselect_b32 s42, 0, s42
    s_add_u32 s32, s42, s44
    s_mov_b32 m0, s32
    s_nop 0
    buffer_load_dwordx4 v20, s[20:23], s40 offen sc1 lds
    s_add_u32 m0, s32, 1024
    s_nop 0
    buffer_load_dwordx4 v21, s[20:23], s40 offen sc1 lds
    s_add_u32 m0, s32, 2048
    s_nop 0
    buffer_load_dwordx4 v22, s[20:23], s40 offen sc1 lds
    s_add_u32 m0, s32, 3072
    s_nop 0
    buffer_load_dwordx4 v23, s[20:23], s40 offen sc1 lds
    s_add_u32 m0, s32, 4096
    s_nop 0
    buffer_load_dwordx4 v24, s[20:23], s40 offen sc1 lds
    s_add_u32 m0, s32, 5120
    s_nop 0
    buffer_load_dwordx4 v25, s[20:23], s40 offen sc1 lds
    s_add_u32 m0, s32, 6144
    s_nop 0
    buffer_load_dwordx4 v26, s[20:23], s40 offen sc1 lds
    s_add_u32 m0, s32, 7168
    s_nop 0
    buffer_load_dwordx4 v27, s[20:23], s40 offen sc1 lds
    s_add_u32 s47, s47, 1
    s_and_b32 s47, s47, 15
    s_mul_i32 s40, s47, 128
    s_add_u32 s40, s40, s43
    s_add_u32 s42, s42, 16384
    s_cmp_eq_u32 s42, 98304
    s_cselect_b32 s42, 0, s42
    s_waitcnt vmcnt(16)
    s_add_u32 s28, s28, 1
    s_cmp_lt_u32 s28, 6
    s_cbranch_scc1 L_al_oc
    s_barrier
    s_add_u32 s32, s42, s44
    s_mov_b32 m0, s32
    s_nop 0
    buffer_load_dwordx4 v20, s[20:23], s40 offen sc1 lds
    s_add_u32 m0, s32, 1024
    s_nop 0
    buffer_load_dwordx4 v21, s[20:23], s40 offen sc1 lds
    s_add_u32 m0, s32, 2048
    s_nop 0
    buffer_load_dwordx4 v22, s[20:23], s40 offen sc1 lds
    s_add_u32 m0, s32, 3072
    s_nop 0
    buffer_load_dwordx4 v23, s[20:23], s40 offen sc1 lds
    s_add_u32 m0, s32, 4096
    s_nop 0
    buffer_load_dwordx4 v24, s[20:23], s40 offen sc1 lds
    s_add_u32 m0, s32, 5120
    s_nop 0
    buffer_load_dwordx4 v25, s[20:23], s40 offen sc1 lds
    s_add_u32 m0, s32, 6144
    s_nop 0
    buffer_load_dwordx4 v26, s[20:23], s40 offen sc1 lds
    s_add_u32 m0, s32, 7168
    s_nop 0
    buffer_load_dwordx4 v27, s[20:23], s40 offen sc1 lds
    s_add_u32 s47, s47, 1
    s_and_b32 s47, s47, 15
    s_mul_i32 s40, s47, 128
    s_add_u32 s40, s40, s43
    s_add_u32 s42, s42, 16384
    s_cmp_eq_u32 s42, 98304
    s_cselect_b32 s42, 0, s42
    s_waitcnt vmcnt(8)
    s_barrier
    s_waitcnt vmcnt(0)
    s_barrier
    s_barrier
    s_endpgm
L_p2_bl:
    s_waitcnt vmcnt(16)
    s_barrier
    s_mov_b32 s41, 512
    s_mov_b32 s43, 131072
    s_mov_b32 m0, s43
    s_nop 0
    buffer_load_dwordx4 v10, s[8:11], s41 offen lds
    s_add_u32 m0, s43, 1024
    s_nop 0
    buffer_load_dwordx4 v11, s[8:11], s41 offen lds
    s_add_u32 m0, s43, 2048
    s_nop 0
    buffer_load_dwordx4 v12, s[8:11], s41 offen lds
    s_add_u32 m0, s43, 3072
    s_nop 0
    buffer_load_dwordx4 v13, s[8:11], s41 offen lds
    s_add_u32 m0, s43, 4096
    s_nop 0
    buffer_load_dwordx4 v14, s[8:11], s41 offen lds
    s_add_u32 m0, s43, 5120
    s_nop 0
    buffer_load_dwordx4 v15, s[8:11], s41 offen lds
    s_add_u32 m0, s43, 6144
    s_nop 0
    buffer_load_dwordx4 v16, s[8:11], s41 offen lds
    s_add_u32 m0, s43, 7168
    s_nop 0
    buffer_load_dwordx4 v17, s[8:11], s41 offen lds
    s_add_u32 s41, s41, 128
    s_add_u32 s43, s43, 8192
    s_cmp_ge_u32 s43, 147456
    s_cselect_b32 s32, 49152, 0
    s_sub_u32 s43, s43, s32
    s_mov_b32 s41, 640
    s_mov_b32 s43, 139264
    s_mov_b32 m0, s43
    s_nop 0
    buffer_load_dwordx4 v10, s[8:11], s41 offen lds
    s_add_u32 m0, s43, 1024
    s_nop 0
    buffer_load_dwordx4 v11, s[8:11], s41 offen lds
    s_add_u32 m0, s43, 2048
    s_nop 0
    buffer_load_dwordx4 v12, s[8:11], s41 offen lds
    s_add_u32 m0, s43, 3072
    s_nop 0
    buffer_load_dwordx4 v13, s[8:11], s41 offen lds
    s_add_u32 m0, s43, 4096
    s_nop 0
    buffer_load_dwordx4 v14, s[8:11], s41 offen lds
    s_add_u32 m0, s43, 5120
    s_nop 0
    buffer_load_dwordx4 v15, s[8:11], s41 offen lds
    s_add_u32 m0, s43, 6144
    s_nop 0
    buffer_load_dwordx4 v16, s[8:11], s41 offen lds
    s_add_u32 m0, s43, 7168
    s_nop 0
    buffer_load_dwordx4 v17, s[8:11], s41 offen lds
    s_add_u32 s41, s41, 128
    s_add_u32 s43, s43, 8192
    s_cmp_ge_u32 s43, 147456
    s_cselect_b32 s32, 49152, 0
    s_sub_u32 s43, s43, s32
    s_waitcnt vmcnt(16)
    s_mov_b32 s41, 768
    s_mov_b32 s43, 98304
    s_mov_b32 s28, 0
L_bl_c_1:
    s_barrier
    s_mov_b32 m0, s43
    s_nop 0
    buffer_load_dwordx4 v10, s[8:11], s41 offen lds
    s_add_u32 m0, s43, 1024
    s_nop 0
    buffer_load_dwordx4 v11, s[8:11], s41 offen lds
    s_add_u32 m0, s43, 2048
    s_nop 0
    buffer_load_dwordx4 v12, s[8:11], s41 offen lds
    s_add_u32 m0, s43, 3072
    s_nop 0
    buffer_load_dwordx4 v13, s[8:11], s41 offen lds
    s_add_u32 m0, s43, 4096
    s_nop 0
    buffer_load_dwordx4 v14, s[8:11], s41 offen lds
    s_add_u32 m0, s43, 5120
    s_nop 0
    buffer_load_dwordx4 v15, s[8:11], s41 offen lds
    s_add_u32 m0, s43, 6144
    s_nop 0
    buffer_load_dwordx4 v16, s[8:11], s41 offen lds
    s_add_u32 m0, s43, 7168
    s_nop 0
    buffer_load_dwordx4 v17, s[8:11], s41 offen lds
    s_add_u32 s41, s41, 128
    s_add_u32 s43, s43, 8192
    s_cmp_ge_u32 s43, 147456
    s_cselect_b32 s32, 49152, 0
    s_sub_u32 s43, s43, s32
    s_mov_b32 m0, s43
    s_nop 0
    buffer_load_dwordx4 v10, s[8:11], s41 offen lds
    s_add_u32 m0, s43, 1024
    s_nop 0
    buffer_load_dwordx4 v11, s[8:11], s41 offen lds
    s_add_u32 m0, s43, 2048
    s_nop 0
    buffer_load_dwordx4 v12, s[8:11], s41 offen lds
    s_add_u32 m0, s43, 3072
    s_nop 0
    buffer_load_dwordx4 v13, s[8:11], s41 offen lds
    s_add_u32 m0, s43, 4096
    s_nop 0
    buffer_load_dwordx4 v14, s[8:11], s41 offen lds
    s_add_u32 m0, s43, 5120
    s_nop 0
    buffer_load_dwordx4 v15, s[8:11], s41 offen lds
    s_add_u32 m0, s43, 6144
    s_nop 0
    buffer_load_dwordx4 v16, s[8:11], s41 offen lds
    s_add_u32 m0, s43, 7168
    s_nop 0
    buffer_load_dwordx4 v17, s[8:11], s41 offen lds
    s_add_u32 s41, s41, 128
    s_add_u32 s43, s43, 8192
    s_cmp_ge_u32 s43, 147456
    s_cselect_b32 s32, 49152, 0
    s_sub_u32 s43, s43, s32
    s_waitcnt vmcnt(16)
    s_add_u32 s28, s28, 1
    s_cmp_lt_u32 s28, 5
    s_cbranch_scc1 L_bl_c_1
    s_mov_b32 s41, 0
    s_mov_b32 s43, 131072
    s_mov_b32 s28, 0
L_bl_c_2:
    s_barrier
    s_mov_b32 m0, s43
    s_nop 0
    buffer_load_dwordx4 v10, s[12:15], s41 offen lds
    s_add_u32 m0, s43, 1024
    s_nop 0
    buffer_load_dwordx4 v11, s[12:15], s41 offen lds
    s_add_u32 m0, s43, 2048
    s_nop 0
    buffer_load_dwordx4 v12, s[12:15], s41 offen lds
    s_add_u32 m0, s43, 3072
    s_nop 0
    buffer_load_dwordx4 v13, s[12:15], s41 offen lds
    s_add_u32 m0, s43, 4096
    s_nop 0
    buffer_load_dwordx4 v14, s[12:15], s41 offen lds
    s_add_u32 m0, s43, 5120
    s_nop 0
    buffer_load_dwordx4 v15, s[12:15], s41 offen lds
    s_add_u32 m0, s43, 6144
    s_nop 0
    buffer_load_dwordx4 v16, s[12:15], s41 offen lds
    s_add_u32 m0, s43, 7168
    s_nop 0
    buffer_load_dwordx4 v17, s[12:15], s41 offen lds
    s_add_u32 s41, s41, 128
    s_add_u32 s43, s43, 8192
    s_cmp_ge_u32 s43, 147456
    s_cselect_b32 s32, 49152, 0
    s_sub_u32 s43, s43, s32
    s_mov_b32 m0, s43
    s_nop 0
    buffer_load_dwordx4 v10, s[12:15], s41 offen lds
    s_add_u32 m0, s43, 1024
    s_nop 0
    buffer_load_dwordx4 v11, s[12:15], s41 offen lds
    s_add_u32 m0, s43, 2048
    s_nop 0
    buffer_load_dwordx4 v12, s[12:15], s41 offen lds
    s_add_u32 m0, s43, 3072
    s_nop 0
    buffer_load_dwordx4 v13, s[12:15], s41 offen lds
    s_add_u32 m0, s43, 4096
    s_nop 0
    buffer_load_dwordx4 v14, s[12:15], s41 offen lds
    s_add_u32 m0, s43, 5120
    s_nop 0
    buffer_load_dwordx4 v15, s[12:15], s41 offen lds
    s_add_u32 m0, s43, 6144
    s_nop 0
    buffer_load_dwordx4 v16, s[12:15], s41 offen lds
    s_add_u32 m0, s43, 7168
    s_nop 0
    buffer_load_dwordx4 v17, s[12:15], s41 offen lds
    s_add_u32 s41, s41, 128
    s_add_u32 s43, s43, 8192
    s_cmp_ge_u32 s43, 147456
    s_cselect_b32 s32, 49152, 0
    s_sub_u32 s43, s43, s32
    s_waitcnt vmcnt(16)
    s_add_u32 s28, s28, 1
    s_cmp_lt_u32 s28, 8
    s_cbranch_scc1 L_bl_c_2
    s_mov_b32 s41, 0
    s_mov_b32 s43, 114688
    s_barrier
    s_mov_b32 m0, s43
    s_nop 0
    buffer_load_dwordx4 v20, s[16:19], s41 offen lds
    s_add_u32 m0, s43, 1024
    s_nop 0
    buffer_load_dwordx4 v21, s[16:19], s41 offen lds
    s_add_u32 m0, s43, 2048
    s_nop 0
    buffer_load_dwordx4 v22, s[16:19], s41 offen lds
    s_add_u32 m0, s43, 3072
    s_nop 0
    buffer_load_dwordx4 v23, s[16:19], s41 offen lds
    s_add_u32 m0, s43, 4096
    s_nop 0
    buffer_load_dwordx4 v24, s[16:19], s41 offen lds
    s_add_u32 m0, s43, 5120
    s_nop 0
    buffer_load_dwordx4 v25, s[16:19], s41 offen lds
    s_add_u32 m0, s43, 6144
    s_nop 0
    buffer_load_dwordx4 v26, s[16:19], s41 offen lds
    s_add_u32 m0, s43, 7168
    s_nop 0
    buffer_load_dwordx4 v27, s[16:19], s41 offen lds
    s_add_u32 s41, s41, 131072
    s_add_u32 s43, s43, 8192
    s_cmp_ge_u32 s43, 147456
    s_cselect_b32 s32, 49152, 0
    s_sub_u32 s43, s43, s32
    s_mov_b32 m0, s43
    s_nop 0
    buffer_load_dwordx4 v20, s[16:19], s41 offen lds
    s_add_u32 m0, s43, 1024
    s_nop 0
    buffer_load_dwordx4 v21, s[16:19], s41 offen lds
    s_add_u32 m0, s43, 2048
    s_nop 0
    buffer_load_dwordx4 v22, s[16:19], s41 offen lds
    s_add_u32 m0, s43, 3072
    s_nop 0
    buffer_load_dwordx4 v23, s[16:19], s41 offen lds
    s_add_u32 m0, s43, 4096
    s_nop 0
    buffer_load_dwordx4 v24, s[16:19], s41 offen lds
    s_add_u32 m0, s43, 5120
    s_nop 0
    buffer_load_dwordx4 v25, s[16:19], s41 offen lds
    s_add_u32 m0, s43, 6144
    s_nop 0
    buffer_load_dwordx4 v26, s[16:19], s41 offen lds
    s_add_u32 m0, s43, 7168
    s_nop 0
    buffer_load_dwordx4 v27, s[16:19], s41 offen lds
    s_add_u32 s41, s41, 131072
    s_add_u32 s43, s43, 8192
    s_cmp_ge_u32 s43, 147456
    s_cselect_b32 s32, 49152, 0
    s_sub_u32 s43, s43, s32
    s_waitcnt vmcnt(16)
    s_mov_b32 s41, 262144
    s_mov_b32 s43, 131072
    s_mov_b32 s28, 0
L_bl_c_3:
    s_barrier
    s_mov_b32 m0, s43
    s_nop 0
    buffer_load_dwordx4 v20, s[16:19], s41 offen lds
    s_add_u32 m0, s43, 1024
    s_nop 0
    buffer_load_dwordx4 v21, s[16:19], s41 offen lds
    s_add_u32 m0, s43, 2048
    s_nop 0
    buffer_load_dwordx4 v22, s[16:19], s41 offen lds
    s_add_u32 m0, s43, 3072
    s_nop 0
    buffer_load_dwordx4 v23, s[16:19], s41 offen lds
    s_add_u32 m0, s43, 4096
    s_nop 0
    buffer_load_dwordx4 v24, s[16:19], s41 offen lds
    s_add_u32 m0, s43, 5120
    s_nop 0
    buffer_load_dwordx4 v25, s[16:19], s41 offen lds
    s_add_u32 m0, s43, 6144
    s_nop 0
    buffer_load_dwordx4 v26, s[16:19], s41 offen lds
    s_add_u32 m0, s43, 7168
    s_nop 0
    buffer_load_dwordx4 v27, s[16:19], s41 offen lds
    s_add_u32 s41, s41, 131072
    s_add_u32 s43, s43, 8192
    s_cmp_ge_u32 s43, 147456
    s_cselect_b32 s32, 49152, 0
    s_sub_u32 s43, s43, s32
    s_mov_b32 m0, s43
    s_nop 0
    buffer_load_dwordx4 v20, s[16:19], s41 offen lds
    s_add_u32 m0, s43, 1024
    s_nop 0
    buffer_load_dwordx4 v21, s[16:19], s41 offen lds
    s_add_u32 m0, s43, 2048
    s_nop 0
    buffer_load_dwordx4 v22, s[16:19], s41 offen lds
    s_add_u32 m0, s43, 3072
    s_nop 0
    buffer_load_dwordx4 v23, s[16:19], s41 offen lds
    s_add_u32 m0, s43, 4096
    s_nop 0
    buffer_load_dwordx4 v24, s[16:19], s41 offen lds
    s_add_u32 m0, s43, 5120
    s_nop 0
    buffer_load_dwordx4 v25, s[16:19], s41 offen lds
    s_add_u32 m0, s43, 6144
    s_nop 0
    buffer_load_dwordx4 v26, s[16:19], s41 offen lds
    s_add_u32 m0, s43, 7168
    s_nop 0
    buffer_load_dwordx4 v27, s[16:19], s41 offen lds
    s_add_u32 s41, s41, 131072
    s_add_u32 s43, s43, 8192
    s_cmp_ge_u32 s43, 147456
    s_cselect_b32 s32, 49152, 0
    s_sub_u32 s43, s43, s32
    s_waitcnt vmcnt(24)
    s_add_u32 s28, s28, 1
    s_cmp_lt_u32 s28, 2
    s_cbranch_scc1 L_bl_c_3
    s_mov_b32 s41, 786432
    s_mov_b32 s43, 114688
    s_barrier
    s_mov_b32 m0, s43
    s_nop 0
    buffer_load_dwordx4 v20, s[16:19], s41 offen lds
    s_add_u32 m0, s43, 1024
    s_nop 0
    buffer_load_dwordx4 v21, s[16:19], s41 offen lds
    s_add_u32 m0, s43, 2048
    s_nop 0
    buffer_load_dwordx4 v22, s[16:19], s41 offen lds
    s_add_u32 m0, s43, 3072
    s_nop 0
    buffer_load_dwordx4 v23, s[16:19], s41 offen lds
    s_add_u32 m0, s43, 4096
    s_nop 0
    buffer_load_dwordx4 v24, s[16:19], s41 offen lds
    s_add_u32 m0, s43, 5120
    s_nop 0
    buffer_load_dwordx4 v25, s[16:19], s41 offen lds
    s_add_u32 m0, s43, 6144
    s_nop 0
    buffer_load_dwordx4 v26, s[16:19], s41 offen lds
    s_add_u32 m0, s43, 7168
    s_nop 0
    buffer_load_dwordx4 v27, s[16:19], s41 offen lds
    s_add_u32 s41, s41, 131072
    s_add_u32 s43, s43, 8192
    s_cmp_ge_u32 s43, 147456
    s_cselect_b32 s32, 49152, 0
    s_sub_u32 s43, s43, s32
    s_waitcnt vmcnt(16)
    s_mov_b32 s41, 917504
    s_mov_b32 s43, 122880
    s_mov_b32 s28, 0
L_bl_c_4:
    s_barrier
    s_mov_b32 m0, s43
    s_nop 0
    buffer_load_dwordx4 v20, s[16:19], s41 offen lds
    s_add_u32 m0, s43, 1024
    s_nop 0
    buffer_load_dwordx4 v21, s[16:19], s41 offen lds
    s_add_u32 m0, s43, 2048
    s_nop 0
    buffer_load_dwordx4 v22, s[16:19], s41 offen lds
    s_add_u32 m0, s43, 3072
    s_nop 0
    buffer_load_dwordx4 v23, s[16:19], s41 offen lds
    s_add_u32 m0, s43, 4096
    s_nop 0
    buffer_load_dwordx4 v24, s[16:19], s41 offen lds
    s_add_u32 m0, s43, 5120
    s_nop 0
    buffer_load_dwordx4 v25, s[16:19], s41 offen lds
    s_add_u32 m0, s43, 6144
    s_nop 0
    buffer_load_dwordx4 v26, s[16:19], s41 offen lds
    s_add_u32 m0, s43, 7168
    s_nop 0
    buffer_load_dwordx4 v27, s[16:19], s41 offen lds
    s_add_u32 s41, s41, 131072
    s_add_u32 s43, s43, 8192
    s_cmp_ge_u32 s43, 147456
    s_cselect_b32 s32, 49152, 0
    s_sub_u32 s43, s43, s32
    s_mov_b32 m0, s43
    s_nop 0
    buffer_load_dwordx4 v20, s[16:19], s41 offen lds
    s_add_u32 m0, s43, 1024
    s_nop 0
    buffer_load_dwordx4 v21, s[16:19], s41 offen lds
    s_add_u32 m0, s43, 2048
    s_nop 0
    buffer_load_dwordx4 v22, s[16:19], s41 offen lds
    s_add_u32 m0, s43, 3072
    s_nop 0
    buffer_load_dwordx4 v23, s[16:19], s41 offen lds
    s_add_u32 m0, s43, 4096
    s_nop 0
    buffer_load_dwordx4 v24, s[16:19], s41 offen lds
    s_add_u32 m0, s43, 5120
    s_nop 0
    buffer_load_dwordx4 v25, s[16:19], s41 offen lds
    s_add_u32 m0, s43, 6144
    s_nop 0
    buffer_load_dwordx4 v26, s[16:19], s41 offen lds
    s_add_u32 m0, s43, 7168
    s_nop 0
    buffer_load_dwordx4 v27, s[16:19], s41 offen lds
    s_add_u32 s41, s41, 131072
    s_add_u32 s43, s43, 8192
    s_cmp_ge_u32 s43, 147456
    s_cselect_b32 s32, 49152, 0
    s_sub_u32 s43, s43, s32
    s_waitcnt vmcnt(16)
    s_add_u32 s28, s28, 1
    s_cmp_lt_u32 s28, 4
    s_cbranch_scc1 L_bl_c_4
    s_mov_b32 s41, 1966080
    s_mov_b32 s43, 139264
    s_barrier
    s_mov_b32 m0, s43
    s_nop 0
    buffer_load_dwordx4 v20, s[16:19], s41 offen lds
    s_add_u32 m0, s43, 1024
    s_nop 0
    buffer_load_dwordx4 v21, s[16:19], s41 offen lds
    s_add_u32 m0, s43, 2048
    s_nop 0
    buffer_load_dwordx4 v22, s[16:19], s41 offen lds
    s_add_u32 m0, s43, 3072
    s_nop 0
    buffer_load_dwordx4 v23, s[16:19], s41 offen lds
    s_add_u32 m0, s43, 4096
    s_nop 0
    buffer_load_dwordx4 v24, s[16:19], s41 offen lds
    s_add_u32 m0, s43, 5120
    s_nop 0
    buffer_load_dwordx4 v25, s[16:19], s41 offen lds
    s_add_u32 m0, s43, 6144
    s_nop 0
    buffer_load_dwordx4 v26, s[16:19], s41 offen lds
    s_add_u32 m0, s43, 7168
    s_nop 0
    buffer_load_dwordx4 v27, s[16:19], s41 offen lds
    s_add_u32 s41, s41, 131072
    s_add_u32 s43, s43, 8192
    s_cmp_ge_u32 s43, 147456
    s_cselect_b32 s32, 49152, 0
    s_sub_u32 s43, s43, s32
    s_waitcnt vmcnt(8)
    s_barrier
    s_waitcnt vmcnt(0)
    s_barrier
    s_barrier
    s_endpgm
L_p2_h3:
    s_lshl_b32 s38, s72, 7
    s_add_u32 s38, s38, 265289760
    s_mul_i32 s39, s72, 4608
    s_add_u32 s39, s39, 264241152
    v_and_b32 v1, 63, v0
    v_lshlrev_b32 v8, 2, v1
    v_add_u32 v9, 4096, v8
    v_and_b32 v6, 15, v0
    v_lshlrev_b32 v6, 2, v6
    s_waitcnt lgkmcnt(0)
    buffer_load_dword v7, v6, s[20:23], s38 offen sc1
    s_barrier
    s_barrier
    s_mov_b32 s36, 0
L_kv_50:
    s_waitcnt vmcnt(0)
    v_cmp_eq_u32 vcc, s68, v7
    s_cmp_eq_u64 vcc, exec
    s_cbranch_scc1 L_kvok_51
    buffer_load_dword v7, v6, s[20:23], s38 offen sc1
    s_add_u32 s36, s36, 1
    s_cmp_lt_u32 s36, 131072
    s_cbranch_scc1 L_kv_50
L_kvok_51:
    v_lshlrev_b32 v10, 4, v1
    s_mov_b32 m0, 157952
    s_add_u32 s37, s39, 0
    buffer_load_dwordx4 v10, s[20:23], s37 offen sc1 lds
    s_mov_b32 m0, 158976
    s_add_u32 s37, s39, 1024
    buffer_load_dwordx4 v10, s[20:23], s37 offen sc1 lds
    s_mov_b32 m0, 160000
    s_add_u32 s37, s39, 2048
    buffer_load_dwordx4 v10, s[20:23], s37 offen sc1 lds
    s_mov_b32 m0, 161024
    s_add_u32 s37, s39, 3072
    buffer_load_dwordx4 v10, s[20:23], s37 offen sc1 lds
    s_mov_b32 m0, 162048
    s_add_u32 s37, s39, 4096
    buffer_load_dwordx4 v10, s[20:23], s37 offen sc1 lds
    s_barrier
    s_waitcnt vmcnt(0)
    v_lshlrev_b32 v10, 2, v1
    v_add_u32 v10, 157952, v10
    ds_read_b32 v16, v10 offset:0
    ds_read_b32 v17, v10 offset:256
    ds_read_b32 v18, v10 offset:512
    ds_read_b32 v19, v10 offset:768
    ds_read_b32 v20, v10 offset:1024
    ds_read_b32 v21, v10 offset:1280
    ds_read_b32 v22, v10 offset:1536
    ds_read_b32 v23, v10 offset:1792
    ds_read_b32 v24, v10 offset:2048
    ds_read_b32 v25, v10 offset:2304
    ds_read_b32 v26, v10 offset:2560
    ds_read_b32 v27, v10 offset:2816
    ds_read_b32 v28, v10 offset:3072
    ds_read_b32 v29, v10 offset:3328
    ds_read_b32 v30, v10 offset:3584
    ds_read_b32 v31, v10 offset:3840
    ds_read_b32 v32, v10 offset:4096
    ds_read_b32 v33, v10 offset:4352
    v_lshlrev_b32 v2, 4, v1
    v_add_u32 v2, 147456, v2
    v_bfe_u32 v4, v0, 4, 2
    v_lshlrev_b32 v4, 5, v4
    v_and_b32 v5, 3, v0
    v_lshlrev_b32 v5, 2, v5
    v_add_u32 v4, v4, v5
    v_add_u32 v4, 149504, v4
    s_waitcnt lgkmcnt(0)
    v_cvt_pk_bf16_f32 v40, v16, v17
    v_cvt_pk_bf16_f32 v41, v18, v19
    v_cvt_pk_bf16_f32 v42, v25, v26
    v_cvt_pk_bf16_f32 v43, v27, v28
    v_cvt_pk_bf16_f32 v44, v20, v21
    v_cvt_pk_bf16_f32 v45, v22, v23
    v_cvt_pk_bf16_f32 v46, v29, v30
    v_cvt_pk_bf16_f32 v47, v31, v32
    ds_write_b128 v2, v[40:43]
    ds_write_b128 v2, v[44:47] offset:1024
    ds_write_b32 v4, v24
    ds_write_b32 v4, v33 offset:16
    s_waitcnt lgkmcnt(0)
    s_barrier
    s_barrier
    v_and_b32 v60, 63, v0
    v_lshlrev_b32 v61, 4, v60
    v_add_u32 v61, 149760, v61
    v_lshrrev_b32 v62, 2, v60
    v_lshrrev_b32 v63, 2, v62
    v_lshlrev_b32 v63, 4, v63
    v_and_b32 v96, 1, v62
    v_lshlrev_b32 v96, 3, v96
    v_add_u32 v63, v63, v96
    v_bfe_u32 v96, v62, 1, 1
    v_add_u32 v63, v63, v96
    v_lshlrev_b32 v63, 11, v63
    v_and_b32 v96, 3, v60
    v_lshlrev_b32 v96, 4, v96
    v_add_u32 v63, v63, v96
    s_lshl_b32 s47, s71, 19
    s_lshl_b32 s34, s72, 6
    s_add_u32 s47, s47, s34
    s_add_u32 s47, s47, 260046848
    ds_read_b128 v[64:67], v61 offset:0
    ds_read_b128 v[68:71], v61 offset:2048
    ds_read_b128 v[72:75], v61 offset:4096
    ds_read_b128 v[76:79], v61 offset:6144
    s_waitcnt lgkmcnt(0)
    s_add_u32 s34, s47, 0
    buffer_store_dwordx4 v[64:67], v63, s[20:23], s34 offen sc1
    s_add_u32 s34, s47, 131072
    buffer_store_dwordx4 v[68:71], v63, s[20:23], s34 offen sc1
    s_add_u32 s34, s47, 262144
    buffer_store_dwordx4 v[72:75], v63, s[20:23], s34 offen sc1
    s_add_u32 s34, s47, 393216
    buffer_store_dwordx4 v[76:79], v63, s[20:23], s34 offen sc1
    s_barrier
    ds_read_b128 v[64:67], v61 offset:1024
    ds_read_b128 v[68:71], v61 offset:3072
    ds_read_b128 v[72:75], v61 offset:5120
    ds_read_b128 v[76:79], v61 offset:7168
    s_waitcnt lgkmcnt(0)
    s_add_u32 s34, s47, 4096
    buffer_store_dwordx4 v[64:67], v63, s[20:23], s34 offen sc1
    s_add_u32 s34, s47, 135168
    buffer_store_dwordx4 v[68:71], v63, s[20:23], s34 offen sc1
    s_add_u32 s34, s47, 266240
    buffer_store_dwordx4 v[72:75], v63, s[20:23], s34 offen sc1
    s_add_u32 s34, s47, 397312
    buffer_store_dwordx4 v[76:79], v63, s[20:23], s34 offen sc1
    s_barrier
    ds_read_b128 v[64:67], v61 offset:0
    ds_read_b128 v[68:71], v61 offset:2048
    ds_read_b128 v[72:75], v61 offset:4096
    ds_read_b128 v[76:79], v61 offset:6144
    s_waitcnt lgkmcnt(0)
    s_add_u32 s34, s47, 8192
    buffer_store_dwordx4 v[64:67], v63, s[20:23], s34 offen sc1
    s_add_u32 s34, s47, 139264
    buffer_store_dwordx4 v[68:71], v63, s[20:23], s34 offen sc1
    s_add_u32 s34, s47, 270336
    buffer_store_dwordx4 v[72:75], v63, s[20:23], s34 offen sc1
    s_add_u32 s34, s47, 401408
    buffer_store_dwordx4 v[76:79], v63, s[20:23], s34 offen sc1
    s_barrier
    ds_read_b128 v[64:67], v61 offset:1024
    ds_read_b128 v[68:71], v61 offset:3072
    ds_read_b128 v[72:75], v61 offset:5120
    ds_read_b128 v[76:79], v61 offset:7168
    s_waitcnt lgkmcnt(0)
    s_add_u32 s34, s47, 12288
    buffer_store_dwordx4 v[64:67], v63, s[20:23], s34 offen sc1
    s_add_u32 s34, s47, 143360
    buffer_store_dwordx4 v[68:71], v63, s[20:23], s34 offen sc1
    s_add_u32 s34, s47, 274432
    buffer_store_dwordx4 v[72:75], v63, s[20:23], s34 offen sc1
    s_add_u32 s34, s47, 405504
    buffer_store_dwordx4 v[76:79], v63, s[20:23], s34 offen sc1
    s_barrier
    s_waitcnt vmcnt(0)
    s_barrier
    s_lshl_b32 s32, s71, 7
    s_lshl_b32 s33, s72, 2
    s_add_u32 s32, s32, s33
    s_add_u32 s32, s32, 266612736
    v_mov_b32 v2, s68
    v_mov_b32 v3, s32
    s_mov_b64 s[74:75], exec
    s_mov_b64 exec, 1
    buffer_store_dword v2, v3, s[20:23], 0 offen sc1
    s_mov_b64 exec, s[74:75]
    s_barrier
    s_getpc_b64 s[32:33]
L_pc_52:
    s_sub_u32 s32, s32, L_pc_52-gated_mix__ssm_conv_s5__linear_attn_block__prompt_kernel
    s_subb_u32 s33, s33, 0
    s_lshl_b32 s34, s31, 4
    v_and_b32 v245, 15, v0
    v_add_u32 v245, s34, v245
    v_lshlrev_b32 v245, 7, v245
    v_min_u32 v245, L_end-gated_mix__ssm_conv_s5__linear_attn_block__prompt_kernel, v245
    global_load_dword v246, v245, s[32:33]
    s_barrier
    s_barrier
    s_barrier
    s_lshl_b32 s39, s3, 7
    s_add_u32 s39, s39, 266612736
    v_and_b32 v2, 31, v0
    v_lshlrev_b32 v2, 2, v2
    buffer_load_dword v3, v2, s[20:23], s39 offen sc1
    s_barrier
    s_mov_b32 s33, 0
L_fp_53:
    s_waitcnt vmcnt(0)
    v_cmp_eq_u32 vcc, s68, v3
    s_cmp_eq_u64 vcc, exec
    s_cbranch_scc1 L_fo_54
    buffer_load_dword v3, v2, s[20:23], s39 offen sc1
    s_add_u32 s33, s33, 1
    s_cmp_lt_u32 s33, 131072
    s_cbranch_scc1 L_fp_53
L_fo_54:
    s_barrier
    s_lshl_b32 s32, s25, 9
    s_add_u32 s32, s32, 266338304
    v_and_b32 v60, 63, v0
    v_lshlrev_b32 v60, 2, v60
    v_add_u32 v61, 256, v60
    s_mov_b32 m0, 147456
    s_nop 0
    buffer_load_dword v60, s[20:23], s32 offen sc1 lds
    s_mov_b32 m0, 147712
    s_nop 0
    buffer_load_dword v61, s[20:23], s32 offen sc1 lds
    s_waitcnt vmcnt(0)
    s_barrier
    s_waitcnt vmcnt(0)
    s_cmp_lg_u32 s3, 7
    s_cbranch_scc1 L_eb_55
    s_cmp_lg_u32 s31, 0
    s_cbranch_scc1 L_eb_55
    v_mov_b32 v122, s68
    v_mov_b32 v123, 266665984
    s_mov_b64 s[74:75], exec
    s_mov_b64 exec, 1
    buffer_store_dword v122, v123, s[20:23], 0 offen
    s_mov_b64 exec, s[74:75]
L_eb_55:
    s_barrier
    s_barrier
    s_barrier
    s_barrier
    s_barrier
    s_barrier
    s_barrier
    s_barrier
    s_barrier
    s_endpgm
L_c2_hk6:
    v_and_b32 v216, 63, v0
    v_lshlrev_b32 v217, 4, v216
    v_add_u32 v217, 147456, v217
    v_bfe_u32 v218, v0, 4, 2
    v_lshlrev_b32 v219, 5, v218
    v_add_u32 v219, 149504, v219
    ds_read_b128 v[176:179], v217
    ds_read_b128 v[180:183], v217 offset:1024
    ds_read_b128 v[184:187], v219
    ds_read_b128 v[188:191], v219 offset:16
    s_lshl_b32 s32, s24, 11
    s_add_u32 s32, s32, 149760
    v_and_b32 v220, 15, v0
    v_lshlrev_b32 v220, 6, v220
    v_lshlrev_b32 v218, 4, v218
    v_add_u32 v220, v220, v218
    v_add_u32 v220, s32, v220
    s_waitcnt lgkmcnt(0)
    v_cvt_pk_bf16_f32 v184, v184, v185
    v_cvt_pk_bf16_f32 v185, v186, v187
    v_cvt_pk_bf16_f32 v186, v188, v189
    v_cvt_pk_bf16_f32 v187, v190, v191
    s_nop 1
    v_mfma_f32_16x16x32_bf16 v[200:203], v[184:187], v[224:227], 0
    v_mfma_f32_16x16x32_bf16 v[192:195], v[176:179], v[224:227], 0
    v_mfma_f32_16x16x32_bf16 v[196:199], v[180:183], v[224:227], 0
    s_nop 5
    v_add_f32 v200, 0x358637bd, v200
    v_rcp_f32 v200, v200
    s_nop 3
    v_pk_mul_f32 v[192:193], v[192:193], v[200:201] op_sel_hi:[1,0]
    v_pk_mul_f32 v[194:195], v[194:195], v[200:201] op_sel_hi:[1,0]
    v_pk_mul_f32 v[196:197], v[196:197], v[200:201] op_sel_hi:[1,0]
    v_pk_mul_f32 v[198:199], v[198:199], v[200:201] op_sel_hi:[1,0]
    v_cvt_pk_bf16_f32 v200, v192, v193
    v_cvt_pk_bf16_f32 v201, v194, v195
    v_cvt_pk_bf16_f32 v202, v196, v197
    v_cvt_pk_bf16_f32 v203, v198, v199
    ds_write_b128 v220, v[200:203] offset:0
    s_branch L_c2_hr0
L_c2_hk12:
    v_mfma_f32_16x16x32_bf16 v[200:203], v[184:187], v[236:239], 0
    v_mfma_f32_16x16x32_bf16 v[192:195], v[176:179], v[236:239], 0
    v_mfma_f32_16x16x32_bf16 v[196:199], v[180:183], v[236:239], 0
    s_nop 5
    v_add_f32 v200, 0x358637bd, v200
    v_rcp_f32 v200, v200
    s_nop 3
    v_pk_mul_f32 v[192:193], v[192:193], v[200:201] op_sel_hi:[1,0]
    v_pk_mul_f32 v[194:195], v[194:195], v[200:201] op_sel_hi:[1,0]
    v_pk_mul_f32 v[196:197], v[196:197], v[200:201] op_sel_hi:[1,0]
    v_pk_mul_f32 v[198:199], v[198:199], v[200:201] op_sel_hi:[1,0]
    v_cvt_pk_bf16_f32 v200, v192, v193
    v_cvt_pk_bf16_f32 v201, v194, v195
    v_cvt_pk_bf16_f32 v202, v196, v197
    v_cvt_pk_bf16_f32 v203, v198, v199
    ds_write_b128 v220, v[200:203] offset:1024
    s_branch L_c2_hr0
L_c2_hk13:
    s_waitcnt vmcnt(0)
    s_branch L_c2_hr1
L_c2_hk8:
    v_mfma_f32_16x16x32_bf16 v[200:203], v[184:187], v[228:231], 0
    v_mfma_f32_16x16x32_bf16 v[192:195], v[176:179], v[228:231], 0
    v_mfma_f32_16x16x32_bf16 v[196:199], v[180:183], v[228:231], 0
    s_nop 5
    v_add_f32 v200, 0x358637bd, v200
    v_rcp_f32 v200, v200
    s_nop 3
    v_pk_mul_f32 v[192:193], v[192:193], v[200:201] op_sel_hi:[1,0]
    v_pk_mul_f32 v[194:195], v[194:195], v[200:201] op_sel_hi:[1,0]
    v_pk_mul_f32 v[196:197], v[196:197], v[200:201] op_sel_hi:[1,0]
    v_pk_mul_f32 v[198:199], v[198:199], v[200:201] op_sel_hi:[1,0]
    v_cvt_pk_bf16_f32 v200, v192, v193
    v_cvt_pk_bf16_f32 v201, v194, v195
    v_cvt_pk_bf16_f32 v202, v196, v197
    v_cvt_pk_bf16_f32 v203, v198, v199
    ds_write_b128 v220, v[200:203] offset:1024
    s_branch L_c2_hr2
L_c2_hk10:
    v_mfma_f32_16x16x32_bf16 v[200:203], v[184:187], v[232:235], 0
    v_mfma_f32_16x16x32_bf16 v[192:195], v[176:179], v[232:235], 0
    v_mfma_f32_16x16x32_bf16 v[196:199], v[180:183], v[232:235], 0
    s_nop 5
    v_add_f32 v200, 0x358637bd, v200
    v_rcp_f32 v200, v200
    s_nop 3
    v_pk_mul_f32 v[192:193], v[192:193], v[200:201] op_sel_hi:[1,0]
    v_pk_mul_f32 v[194:195], v[194:195], v[200:201] op_sel_hi:[1,0]
    v_pk_mul_f32 v[196:197], v[196:197], v[200:201] op_sel_hi:[1,0]
    v_pk_mul_f32 v[198:199], v[198:199], v[200:201] op_sel_hi:[1,0]
    v_cvt_pk_bf16_f32 v200, v192, v193
    v_cvt_pk_bf16_f32 v201, v194, v195
    v_cvt_pk_bf16_f32 v202, v196, v197
    v_cvt_pk_bf16_f32 v203, v198, v199
    ds_write_b128 v220, v[200:203] offset:0
    s_branch L_c2_hr4
L_end:
    s_endpgm
.section .rodata,"a"
.p2align 6
.amdhsa_kernel gated_mix__ssm_conv_s5__linear_attn_block__prompt_kernel
  .amdhsa_next_free_vgpr 256
  .amdhsa_next_free_sgpr 102
  .amdhsa_accum_offset 256
  .amdhsa_group_segment_fixed_size 0
  .amdhsa_kernarg_size 128
  .amdhsa_user_sgpr_count 2
  .amdhsa_user_sgpr_kernarg_segment_ptr 1
  .amdhsa_system_sgpr_workgroup_id_x 1
  .amdhsa_float_denorm_mode_32 3
.end_amdhsa_kernel
```
